```python
import torch

def _softmax(x, axis=-1):
    return torch.softmax(x, dim=axis)
def _gelu(x):
    return torch.nn.functional.gelu(x, approximate="tanh")
def _silu(x):
    return torch.nn.functional.silu(x)
def _sigmoid(x):
    return torch.sigmoid(x)
def _layernorm(x, axis=-1, eps=1e-5):
    m = x.mean(dim=axis, keepdim=True)
    v = x.var(dim=axis, keepdim=True, unbiased=False)
    return (x - m) / torch.sqrt(v + eps)
def _scatter_add(tgt, idx, src, axis=0):
    return tgt.clone().index_add_(axis, idx, src)
def _segment_sum(src, seg, n):
    out = torch.zeros((n,) + src.shape[1:], dtype=src.dtype)
    return out.index_add_(0, seg, src)
def _pad(x, pw):
    flat = tuple(v for pair in reversed(pw) for v in pair)
    return torch.nn.functional.pad(x, flat)

kernel_name = 'interleave_layers__sliding_block__dense_activation_relu__prompt'

def setup_inputs():

    _w = (lambda a: (lambda t: t.to(torch.bfloat16) if t.is_floating_point() else t)(torch.as_tensor(a)))
    def _A_setup():
        B, S, D = 1, 2048, 448
        return {
            "x": _w((lambda *s: torch.randn(*s, dtype=torch.bfloat16) * 0.05)(B, S, D)),
            "wqkv": _w((lambda *s: torch.randn(*s, dtype=torch.bfloat16) * 0.05)(D, 3 * D)),
            "wo": _w((lambda *s: torch.randn(*s, dtype=torch.bfloat16) * 0.05)(D, D)),
        }
    _A_in = _A_setup()

    def _B_setup():
        B, S, D, Dff = 1, 2048, 448, 1792
        return {
            "x": _w((lambda *s: torch.randn(*s, dtype=torch.bfloat16) * 0.05)(B, S, D)),
            "w1": _w((lambda *s: torch.randn(*s, dtype=torch.bfloat16) * 0.05)(D, Dff)),
            "w2": _w((lambda *s: torch.randn(*s, dtype=torch.bfloat16) * 0.05)(Dff, D)),
        }
    _B_in = _B_setup()

    return {
        "A_x": _A_in["x"],
        "A_wqkv": _A_in["wqkv"],
        "A_wo": _A_in["wo"],
        "B_x": _B_in["x"],
        "B_w1": _B_in["w1"],
        "B_w2": _B_in["w2"],
    }

def reference(A_x, A_wqkv, A_wo, B_x, B_w1, B_w2):
    def _A_ref(x, wqkv, wo):
        B, S, D = x.shape
        H = 16; Dh = D // H; W = 256
        qkv = (lambda x, *d: x.permute(*d))((x @ wqkv).reshape(B, S, 3, H, Dh), 2, 0, 3, 1, 4)
        q, k, v = qkv[0], qkv[1], qkv[2]
        scores = torch.einsum("bhqd,bhkd->bhqk", q, k) * (Dh ** -0.5)
        idx = torch.arange(S)
        mask = (idx[:, None] - idx[None, :] >= 0) & (idx[:, None] - idx[None, :] < W)
        scores = torch.where(mask[None, None], scores, -1e9)
        p = _softmax(scores, axis=-1)
        o = torch.einsum("bhqk,bhkd->bhqd", p, v)
        return (lambda x, *d: x.permute(*d))(o, 0, 2, 1, 3).reshape(B, S, D) @ wo

    def _B_ref(x, w1, w2):
        h = torch.einsum("bsd,df->bsf", x, w1)
        zero = torch.zeros_like(h)
        h = torch.maximum(h, zero)
        return torch.einsum("bsf,fd->bsd", h, w2)

    x = A_x
    x = x + _A_ref(_layernorm(x, axis=-1), A_wqkv, A_wo)
    x = x + _B_ref(_layernorm(x, axis=-1), B_w1, B_w2)
    x = x + _A_ref(_layernorm(x, axis=-1), A_wqkv, A_wo)
    x = x + _B_ref(_layernorm(x, axis=-1), B_w1, B_w2)
    return x
```

```asm
; @launch grid=(256,1,1) block=(256,1,1) lds=163840
.amdgcn_target "amdgcn-amd-amdhsa--gfx950"
.text
.globl interleave_layers__sliding_block__dense_activation_relu__prompt_kernel
.p2align 8
.type interleave_layers__sliding_block__dense_activation_relu__prompt_kernel,@function
interleave_layers__sliding_block__dense_activation_relu__prompt_kernel:
    s_cmp_ge_u32 s2, 256
    s_cbranch_scc1 L_end
    s_load_dwordx16 s[80:95], s[0:1], 0
    s_load_dwordx2 s[36:37], s[0:1], 64
    s_getpc_b64 s[60:61]
L_pc:
    v_lshrrev_b32 v18, 4, v0
    s_lshr_b32 s62, s2, 3
    s_lshl_b32 s62, s62, 4
    v_add_u32 v18, s62, v18
    v_lshlrev_b32 v18, 7, v18
    v_min_u32 v18, L_codeend-L_pc, v18
    s_mov_b32 exec_lo, 0x10001
    s_mov_b32 exec_hi, 0x10001
    global_load_dword a255, v18, s[60:61]
    s_mov_b64 exec, -1
    v_lshrrev_b32 v16, 6, v0
    v_and_b32 v0, 63, v0
    v_readfirstlane_b32 s44, v16
    s_lshr_b32 s41, s2, 3
    s_and_b32 s40, s2, 7
    s_lshr_b32 s60, s40, 1
    s_and_b32 s60, s60, 2
    s_xor_b32 s40, s40, s60
    s_mul_i32 s45, s41, 37
    s_lshr_b32 s45, s45, 8
    s_mul_i32 s60, s45, 7
    s_sub_u32 s46, s41, s60
    s_lshr_b32 s58, s44, 1
    s_and_b32 s59, s44, 1
    s_lshl_b32 s60, s40, 2
    s_add_u32 s60, s60, s45
    s_lshl_b32 s61, s60, 1
    s_add_u32 s61, s61, s58
    s_mul_i32 s53, s61, 28672
    s_lshl_b32 s61, s46, 7
    s_add_u32 s53, s53, s61
    s_lshl_b32 s61, s59, 6
    s_add_u32 s53, s53, s61
    v_and_b32 v19, 31, v0
    v_mul_u32_u24 v19, 896, v19
    v_lshrrev_b32 v29, 5, v0
    v_lshl_add_u32 v19, v29, 4, v19
    s_and_b32 s43, s41, 15
    s_lshr_b32 s42, s41, 4
    s_bfm_b32 s62, s43, 0
    s_andn2_b32 s62, s62, 0
    s_bcnt1_i32_b32 s62, s62
    s_mul_i32 s63, s42, 16
    s_add_u32 s62, s62, s63
    s_lshl_b32 s62, s62, 2
    s_add_u32 s62, s62, s44
    s_bitcmp1_b32 0, s43
    s_cselect_b32 s64, 0x10000000, 0
    s_mul_i32 s63, s62, 49
    s_add_u32 s61, s63, 0
    v_add_u32 v18, s61, v0
    v_mul_u32_u24 v30, 74899, v18
    v_lshrrev_b32 v30, 20, v30
    v_mul_u32_u24 v30, 7, v30
    v_add_u32 v30, v30, v18
    v_lshlrev_b32 v30, 7, v30
    s_waitcnt lgkmcnt(0)
    s_mov_b32 s8, s80
    s_and_b32 s9, s81, 0xffff
    s_mov_b32 s10, 1835008
    s_mov_b32 s11, 0x20000
    s_mov_b32 s12, s82
    s_and_b32 s13, s83, 0xffff
    s_mov_b32 s14, 1204224
    s_mov_b32 s15, 0x20000
    buffer_load_dwordx4 v[96:99], v19, s[8:11], s53 offen offset:0
    buffer_load_dwordx4 v[100:103], v19, s[8:11], s53 offen offset:32
    s_mov_b32 exec_hi, 0x1ffff
    buffer_load_dword a255, v30, s[12:15], s64 offen offset:896
    s_mov_b64 exec, -1
    s_load_dwordx2 s[48:49], s[36:37], 0
    s_mov_b32 s16, s84
    s_and_b32 s17, s85, 0xffff
    s_mov_b32 s18, 401408
    s_mov_b32 s19, 0x20000
    s_mov_b32 s20, s88
    s_and_b32 s21, s89, 0xffff
    s_mov_b32 s22, 1605632
    s_mov_b32 s23, 0x20000
    s_mov_b32 s24, s90
    s_and_b32 s25, s91, 0xffff
    s_mov_b32 s26, 1605632
    s_mov_b32 s27, 0x20000
    s_mov_b32 s28, s92
    s_and_b32 s29, s93, 0xffff
    s_mov_b32 s30, 1835008
    s_mov_b32 s31, 0x20000
    s_mov_b32 s32, s36
    s_and_b32 s33, s37, 0xffff
    s_mov_b32 s34, 42991616
    s_mov_b32 s35, 0x20000
    s_mul_i32 s63, s62, 25
    v_add_u32 v18, s63, v0
    v_mul_u32_u24 v31, 149797, v18
    v_lshrrev_b32 v31, 20, v31
    v_mul_u32_u24 v31, 14, v31
    v_add_u32 v31, v31, v18
    v_lshlrev_b32 v31, 7, v31
    v_add_u32 v31, s64, v31
    v_lshrrev_b32 v16, 2, v0
    v_and_b32 v17, 3, v0
    v_lshlrev_b32 v19, 3, v17
    v_lshlrev_b32 v17, 4, v17
    v_mul_u32_u24 v26, 2688, v16
    v_min_u32 v18, 40, v17
    v_add_u32 v26, v26, v18
    s_mul_i32 s76, s44, 301056
    s_mul_i32 s61, s43, 56
    s_add_u32 s76, s76, s61
    s_mul_i32 s77, s44, 7168
    s_add_u32 m0, s77, 0
    s_add_u32 s65, s76, 896
    buffer_load_dwordx4 v26, s[12:15], s65 offen offset:0  lds
    s_add_u32 m0, s77, 1024
    s_add_u32 s65, s76, 43904
    buffer_load_dwordx4 v26, s[12:15], s65 offen offset:0  lds
    s_add_u32 m0, s77, 2048
    s_add_u32 s65, s76, 86912
    buffer_load_dwordx4 v26, s[12:15], s65 offen offset:0  lds
    s_mul_i32 s47, s40, 4587520
    s_add_u32 s47, s47, 6291456
    s_mov_b32 s71, s47
    v_lshlrev_b32 v1, 4, v0
    v_lshlrev_b32 v3, 3, v0
    s_mov_b32 s57, 0x3f803f80
    s_mov_b32 s50, 1
    s_mov_b64 s[54:55], 0
    s_lshl_b32 s60, s45, 1
    s_add_u32 s60, s60, s58
    s_lshl_b32 s61, s46, 1
    s_add_u32 s61, s61, s59
    s_mul_i32 s62, s60, 14
    s_add_u32 s62, s62, s61
    s_add_u32 s63, s47, 1015808
    s_add_u32 s64, s71, 1015808
    s_cmp_lg_u32 s50, 0
    s_cselect_b32 s63, s64, s63
    s_mul_i32 s68, s62, 2048
    s_add_u32 s68, s68, s63
    s_mul_i32 s69, s62, 256
    s_add_u32 s69, s69, s47
    s_add_u32 s69, s69, 1277952
    s_lshl_b32 s60, s60, 4
    s_add_u32 s60, s60, s61
    s_mul_i32 s70, s60, 8
    s_add_u32 s70, s70, s47
    s_add_u32 s70, s70, 1329152
    s_cmp_ge_u32 s41, 28
    s_cselect_b32 s68, 4096, s68
    s_cselect_b32 s69, 4096, s69
    s_cselect_b32 s70, 4096, s70
    s_lshl_b32 s80, s40, 1
    s_add_u32 s80, s80, s42
    s_lshl_b32 s81, s44, 13
    s_add_u32 s81, s81, 112640
    s_mov_b32 s84, 0
    s_cmp_ge_u32 s44, 2
    s_cbranch_scc1 L_jobA_1
    s_xor_b32 s60, s44, 1
    s_add_u32 s86, s43, s60
    s_lshr_b32 s61, 10836, s86
    s_and_b32 s61, s61, 1
    s_cmp_lg_u32 s61, s60
    s_cbranch_scc1 L_jobA_3
    s_cmp_ge_u32 s80, 14
    s_cbranch_scc1 L_jobA_3
    v_bfe_u32 v20, v0, 1, 3
    v_bfe_u32 v18, v0, 4, 1
    v_lshl_add_u32 v20, v18, 4, v20
    v_bfe_u32 v18, v0, 5, 1
    v_lshl_add_u32 v20, v18, 3, v20
    v_mul_u32_u24 v20, 3584, v20
    v_and_b32 v18, 1, v0
    v_lshl_add_u32 v20, v18, 4, v20
    s_mul_i32 s60, s80, 114688
    s_mul_i32 s61, s86, 224
    s_add_u32 s60, s60, s61
    s_add_u32 m0, s81, 0
    s_add_u32 s65, s60, 0
    buffer_load_dwordx4 v20, s[20:23], s65 offen offset:0  lds
    s_add_u32 m0, s81, 1024
    s_add_u32 s65, s60, 32
    buffer_load_dwordx4 v20, s[20:23], s65 offen offset:0  lds
    s_add_u32 m0, s81, 2048
    s_add_u32 s65, s60, 64
    buffer_load_dwordx4 v20, s[20:23], s65 offen offset:0  lds
    s_add_u32 m0, s81, 3072
    s_add_u32 s65, s60, 96
    buffer_load_dwordx4 v20, s[20:23], s65 offen offset:0  lds
    s_add_u32 m0, s81, 4096
    s_add_u32 s65, s60, 128
    buffer_load_dwordx4 v20, s[20:23], s65 offen offset:0  lds
    s_add_u32 m0, s81, 5120
    s_add_u32 s65, s60, 160
    buffer_load_dwordx4 v20, s[20:23], s65 offen offset:0  lds
    s_add_u32 m0, s81, 6144
    s_add_u32 s65, s60, 192
    buffer_load_dwordx4 v20, s[20:23], s65 offen offset:0  lds
    s_mov_b32 s84, 2
    s_branch L_jobA_4
L_jobA_1:
    v_mul_u32_u24 v20, 896, v16
    v_add_u32 v20, v20, v17
    s_cmp_ge_u32 s41, 28
    s_cbranch_scc1 L_jobA_2
    s_lshl_b32 s62, s40, 2
    s_add_u32 s62, s62, s45
    s_lshr_b32 s63, s62, 1
    s_and_b32 s64, s62, 1
    s_mul_i32 s60, s63, 100352
    s_mul_i32 s61, s64, 57344
    s_add_u32 s60, s60, s61
    s_lshl_b32 s61, s46, 7
    s_add_u32 s60, s60, s61
    s_lshl_b32 s61, s59, 6
    s_add_u32 s60, s60, s61
    s_add_u32 m0, s81, 0
    s_add_u32 s65, s60, 0
    buffer_load_dwordx4 v20, s[24:27], s65 offen offset:0  lds
    s_add_u32 m0, s81, 1024
    s_add_u32 s65, s60, 14336
    buffer_load_dwordx4 v20, s[24:27], s65 offen offset:0  lds
    s_add_u32 m0, s81, 2048
    s_add_u32 s65, s60, 28672
    buffer_load_dwordx4 v20, s[24:27], s65 offen offset:0  lds
    s_add_u32 m0, s81, 3072
    s_add_u32 s65, s60, 43008
    buffer_load_dwordx4 v20, s[24:27], s65 offen offset:0  lds
    s_add_u32 s84, s64, 3
    s_branch L_jobA_4
L_jobA_2:
    s_cmp_eq_u32 s40, 7
    s_cbranch_scc1 L_jobA_3
    s_mul_i32 s60, s46, 100352
    s_lshl_b32 s61, s40, 7
    s_add_u32 s60, s60, s61
    s_lshl_b32 s61, s59, 6
    s_add_u32 s60, s60, s61
    s_add_u32 m0, s81, 0
    s_add_u32 s65, s60, 0
    buffer_load_dwordx4 v20, s[16:19], s65 offen offset:0  lds
    s_add_u32 m0, s81, 1024
    s_add_u32 s65, s60, 14336
    buffer_load_dwordx4 v20, s[16:19], s65 offen offset:0  lds
    s_add_u32 m0, s81, 2048
    s_add_u32 s65, s60, 28672
    buffer_load_dwordx4 v20, s[16:19], s65 offen offset:0  lds
    s_add_u32 m0, s81, 3072
    s_add_u32 s65, s60, 43008
    buffer_load_dwordx4 v20, s[16:19], s65 offen offset:0  lds
    s_add_u32 m0, s81, 4096
    s_add_u32 s65, s60, 57344
    buffer_load_dwordx4 v20, s[16:19], s65 offen offset:0  lds
    s_add_u32 m0, s81, 5120
    s_add_u32 s65, s60, 71680
    buffer_load_dwordx4 v20, s[16:19], s65 offen offset:0  lds
    s_add_u32 m0, s81, 6144
    s_add_u32 s65, s60, 86016
    buffer_load_dwordx4 v20, s[16:19], s65 offen offset:0  lds
    s_add_u32 m0, s81, 7168
    s_add_u32 s65, s60, 100352
    buffer_load_dwordx4 v20, s[16:19], s65 offen offset:0  lds
    s_mov_b32 s84, 5
L_jobA_3:
L_jobA_4:
    s_cmp_eq_u32 s44, 1
    s_cbranch_scc1 L_walkb1
    s_cmp_eq_u32 s44, 2
    s_cbranch_scc1 L_walkb2
    s_cmp_eq_u32 s44, 3
    s_cbranch_scc1 L_walkb3
    s_call_b64 s[98:99], L_pad2
    s_call_b64 s[98:99], L_pad3
    s_call_b64 s[98:99], L_pad4
    s_call_b64 s[98:99], L_pad5
    s_call_b64 s[98:99], L_pad6
    s_call_b64 s[98:99], L_pad7
    s_call_b64 s[98:99], L_pad8
    s_call_b64 s[98:99], L_pad9
    s_call_b64 s[98:99], L_pad10
    s_call_b64 s[98:99], L_pad11
    s_branch L_walkbend
L_walkb1:
    s_call_b64 s[98:99], L_pad7
    s_call_b64 s[98:99], L_pad8
    s_call_b64 s[98:99], L_pad9
    s_call_b64 s[98:99], L_pad10
    s_call_b64 s[98:99], L_pad11
    s_call_b64 s[98:99], L_pad12
    s_call_b64 s[98:99], L_pad13
    s_call_b64 s[98:99], L_pad14
    s_call_b64 s[98:99], L_pad15
    s_call_b64 s[98:99], L_pad16
    s_branch L_walkbend
L_walkb2:
    s_call_b64 s[98:99], L_pad12
    s_call_b64 s[98:99], L_pad13
    s_call_b64 s[98:99], L_pad14
    s_call_b64 s[98:99], L_pad15
    s_call_b64 s[98:99], L_pad16
    s_call_b64 s[98:99], L_pad17
    s_call_b64 s[98:99], L_pad18
    s_call_b64 s[98:99], L_pad19
    s_call_b64 s[98:99], L_pad0
    s_call_b64 s[98:99], L_pad1
    s_branch L_walkbend
L_walkb3:
    s_call_b64 s[98:99], L_pad17
    s_call_b64 s[98:99], L_pad18
    s_call_b64 s[98:99], L_pad19
    s_call_b64 s[98:99], L_pad0
    s_call_b64 s[98:99], L_pad1
    s_call_b64 s[98:99], L_pad2
    s_call_b64 s[98:99], L_pad3
    s_call_b64 s[98:99], L_pad4
    s_call_b64 s[98:99], L_pad5
    s_call_b64 s[98:99], L_pad6
L_walkbend:
    s_cmp_eq_u32 s84, 2
    s_cbranch_scc1 L_xw_5
    s_cmp_eq_u32 s84, 0
    s_cbranch_scc1 L_xw_6
    s_waitcnt vmcnt(8)
    s_branch L_xw_7
L_xw_5:
    s_waitcnt vmcnt(11)
    s_branch L_xw_7
L_xw_6:
    s_waitcnt vmcnt(4)
L_xw_7:
    v_permlane32_swap_b32 v96, v98
    v_permlane32_swap_b32 v97, v99
    v_permlane32_swap_b32 v100, v102
    v_permlane32_swap_b32 v101, v103
    s_cmp_ge_u32 s41, 28
    s_cselect_b32 s70, -1, s70
    s_cbranch_scc1 L_p0skip_8
    buffer_store_dwordx4 v[96:99], v1, s[32:35], s68 offen offset:0 sc1
    buffer_store_dwordx4 v[100:103], v1, s[32:35], s68 offen offset:1024 sc1
    v_mov_b32 v24, s57
    v_dot2_f32_bf16 v22, v96, v24, 0
    v_dot2_f32_bf16 v23, v96, v96, 0
    v_dot2_f32_bf16 v22, v97, v24, v22
    v_dot2_f32_bf16 v23, v97, v97, v23
    v_dot2_f32_bf16 v22, v98, v24, v22
    v_dot2_f32_bf16 v23, v98, v98, v23
    v_dot2_f32_bf16 v22, v99, v24, v22
    v_dot2_f32_bf16 v23, v99, v99, v23
    v_dot2_f32_bf16 v22, v100, v24, v22
    v_dot2_f32_bf16 v23, v100, v100, v23
    v_dot2_f32_bf16 v22, v101, v24, v22
    v_dot2_f32_bf16 v23, v101, v101, v23
    v_dot2_f32_bf16 v22, v102, v24, v22
    v_dot2_f32_bf16 v23, v102, v102, v23
    v_dot2_f32_bf16 v22, v103, v24, v22
    v_dot2_f32_bf16 v23, v103, v103, v23
    s_nop 1
    v_mov_b32 v24, v22
    v_mov_b32 v25, v23
    s_nop 0
    v_permlane32_swap_b32 v22, v24
    v_permlane32_swap_b32 v23, v25
    v_add_f32 v22, v22, v24
    v_add_f32 v23, v23, v25
    s_mov_b32 exec_hi, 0
    buffer_store_dwordx2 v[22:23], v3, s[32:35], s69 offen sc1
    s_mov_b64 exec, -1
L_p0skip_8:
    s_lshl_b32 s52, s42, 2
    s_add_u32 s52, s52, s44
    s_add_u32 m0, s77, 3072
    s_add_u32 s65, s76, 129920
    buffer_load_dwordx4 v26, s[12:15], s65 offen offset:0  lds
    s_add_u32 m0, s77, 4096
    s_add_u32 s65, s76, 172928
    buffer_load_dwordx4 v26, s[12:15], s65 offen offset:0  lds
    s_add_u32 m0, s77, 5120
    s_add_u32 s65, s76, 215936
    buffer_load_dwordx4 v26, s[12:15], s65 offen offset:0  lds
    s_add_u32 m0, s77, 6144
    s_add_u32 s65, s76, 258944
    buffer_load_dwordx4 v26, s[12:15], s65 offen offset:0  lds
    s_add_u32 m0, s77, 28672
    s_add_u32 s65, s76, 1792
    buffer_load_dwordx4 v26, s[12:15], s65 offen offset:0  lds
    s_add_u32 m0, s77, 29696
    s_add_u32 s65, s76, 44800
    buffer_load_dwordx4 v26, s[12:15], s65 offen offset:0  lds
    s_add_u32 m0, s77, 30720
    s_add_u32 s65, s76, 87808
    buffer_load_dwordx4 v26, s[12:15], s65 offen offset:0  lds
    s_add_u32 m0, s77, 31744
    s_add_u32 s65, s76, 130816
    buffer_load_dwordx4 v26, s[12:15], s65 offen offset:0  lds
    s_add_u32 m0, s77, 32768
    s_add_u32 s65, s76, 173824
    buffer_load_dwordx4 v26, s[12:15], s65 offen offset:0  lds
    s_add_u32 m0, s77, 33792
    s_add_u32 s65, s76, 216832
    buffer_load_dwordx4 v26, s[12:15], s65 offen offset:0  lds
    s_add_u32 m0, s77, 34816
    s_add_u32 s65, s76, 259840
    buffer_load_dwordx4 v26, s[12:15], s65 offen offset:0  lds
    s_mov_b64 exec, 0x1ffffff
    buffer_load_dword a255, v31, s[12:15], 0 offen
    s_mov_b64 exec, -1
    v_bfe_u32 v18, v0, 4, 1
    v_lshl_add_u32 v18, v18, 5, v19
    v_bfe_u32 v21, v0, 2, 2
    v_lshl_add_u32 v18, v21, 6, v18
    v_lshl_add_u32 v27, v29, 8, v18
    v_add_u32 v21, s81, v27
    v_add_u32 v18, s81, v18
    v_lshl_add_u32 v29, v29, 9, v18
    v_add_u32 v27, s77, v27
    v_and_b32 v18, 18, v0
    v_cmp_eq_u32 vcc, 18, v18
    v_xor_b32 v18, 8, v27
    s_nop 0
    v_cndmask_b32 v27, v27, v18, vcc
    v_add_u32 v28, s77, v1
    s_mov_b32 s56, 0x07060302
    v_add_u32 v2, 57344, v1
    v_and_b32 v4, 31, v0
    v_lshlrev_b32 v4, 3, v4
    v_lshrrev_b32 v22, 5, v0
    v_mul_u32_u24 v23, 1792, v22
    v_add_u32 v4, v4, v23
    v_lshrrev_b32 v5, 2, v0
    v_lshlrev_b32 v5, 7, v5
    v_and_b32 v23, 3, v0
    v_lshl_add_u32 v5, v23, 3, v5
    s_xor_b32 s60, s44, 1
    s_mul_i32 s60, s60, 12288
    s_add_u32 s60, s60, 112640
    v_add_u32 v6, s60, v1
    s_xor_b32 s60, s44, 2
    s_mul_i32 s60, s60, 12288
    s_add_u32 s60, s60, 116736
    v_add_u32 v7, s60, v1
    s_xor_b32 s60, s44, 3
    s_mul_i32 s60, s60, 12288
    s_add_u32 s60, s60, 120832
    v_add_u32 v8, s60, v1
    s_mul_i32 s60, s44, 12288
    s_add_u32 s60, s60, 112640
    v_add_u32 v9, s60, v1
    v_bfe_u32 v10, v0, 4, 1
    v_lshlrev_b32 v10, 10, v10
    v_lshl_add_u32 v10, v22, 8, v10
    v_and_b32 v23, 15, v0
    v_lshl_add_u32 v10, v23, 4, v10
    v_mov_b32 v107, s57
    v_lshlrev_b32 v240, 16, v96
    v_and_b32 v241, 0xffff0000, v96
    v_lshlrev_b32 v242, 16, v97
    v_and_b32 v243, 0xffff0000, v97
    v_lshlrev_b32 v244, 16, v98
    v_and_b32 v245, 0xffff0000, v98
    v_lshlrev_b32 v246, 16, v99
    v_and_b32 v247, 0xffff0000, v99
    v_lshlrev_b32 v248, 16, v100
    v_and_b32 v249, 0xffff0000, v100
    v_lshlrev_b32 v250, 16, v101
    v_and_b32 v251, 0xffff0000, v101
    v_lshlrev_b32 v252, 16, v102
    v_and_b32 v253, 0xffff0000, v102
    v_lshlrev_b32 v254, 16, v103
    v_and_b32 v255, 0xffff0000, v103
    s_waitcnt lgkmcnt(0)
    s_add_u32 s48, s48, 1
    s_addc_u32 s49, s49, 0
    v_mov_b32 v12, s48
    v_mov_b32 v13, s49
    s_waitcnt vmcnt(12)
    s_cmp_eq_u32 s70, -1
    s_cbranch_scc1 L_noflag_9
    s_mov_b64 exec, 1
    buffer_store_dwordx2 v[12:13], off, s[32:35], s70 sc1
    s_mov_b64 exec, -1
L_noflag_9:
    s_getreg_b32 s60, hwreg(HW_REG_XCC_ID)
    s_and_b32 s60, s60, 15
    s_lshl_b32 s60, s60, 28
    s_xor_b32 s60, s60, s49
    v_mov_b32 v22, s48
    v_mov_b32 v23, s60
    s_lshl_b32 s61, s40, 8
    s_lshl_b32 s62, s41, 3
    s_add_u32 s61, s61, s62
    s_add_u32 s61, s61, 4096
    s_cmp_lg_u32 s44, 0
    s_cbranch_scc1 L_noxcc_10
    s_mov_b64 exec, 1
    buffer_store_dwordx2 v[22:23], off, s[32:35], s61 sc1
    s_mov_b64 exec, -1
L_noxcc_10:
    ds_read_b64_tr_b16 v[128:129], v27 offset:0
    ds_read_b64_tr_b16 v[130:131], v27 offset:512
    ds_read_b64_tr_b16 v[132:133], v27 offset:1024
    ds_read_b64_tr_b16 v[134:135], v27 offset:1536
    s_waitcnt lgkmcnt(2)
    ds_write_b128 v28, v[128:131] offset:0
    v_dot2_f32_bf16 v104, v128, v107, 0
    v_dot2_f32_bf16 v104, v129, v107, v104
    v_dot2_f32_bf16 v104, v130, v107, v104
    v_dot2_f32_bf16 v104, v131, v107, v104
    ds_read_b64_tr_b16 v[136:137], v27 offset:2048
    ds_read_b64_tr_b16 v[138:139], v27 offset:2560
    s_waitcnt lgkmcnt(3)
    ds_write_b128 v28, v[132:135] offset:1024
    v_dot2_f32_bf16 v104, v132, v107, v104
    v_dot2_f32_bf16 v104, v133, v107, v104
    v_dot2_f32_bf16 v104, v134, v107, v104
    v_dot2_f32_bf16 v104, v135, v107, v104
    s_waitcnt vmcnt(11)
    ds_read_b64_tr_b16 v[140:141], v27 offset:3072
    ds_read_b64_tr_b16 v[142:143], v27 offset:3584
    s_waitcnt lgkmcnt(3)
    ds_write_b128 v28, v[136:139] offset:2048
    v_dot2_f32_bf16 v104, v136, v107, v104
    v_dot2_f32_bf16 v104, v137, v107, v104
    v_dot2_f32_bf16 v104, v138, v107, v104
    v_dot2_f32_bf16 v104, v139, v107, v104
    s_waitcnt vmcnt(10)
    ds_read_b64_tr_b16 v[144:145], v27 offset:4096
    ds_read_b64_tr_b16 v[146:147], v27 offset:4608
    s_waitcnt lgkmcnt(3)
    ds_write_b128 v28, v[140:143] offset:3072
    v_dot2_f32_bf16 v104, v140, v107, v104
    v_dot2_f32_bf16 v104, v141, v107, v104
    v_dot2_f32_bf16 v104, v142, v107, v104
    v_dot2_f32_bf16 v104, v143, v107, v104
    s_waitcnt vmcnt(9)
    ds_read_b64_tr_b16 v[148:149], v27 offset:5120
    ds_read_b64_tr_b16 v[150:151], v27 offset:5632
    s_waitcnt lgkmcnt(3)
    ds_write_b128 v28, v[144:147] offset:4096
    v_dot2_f32_bf16 v104, v144, v107, v104
    v_dot2_f32_bf16 v104, v145, v107, v104
    v_dot2_f32_bf16 v104, v146, v107, v104
    v_dot2_f32_bf16 v104, v147, v107, v104
    s_waitcnt vmcnt(8)
    ds_read_b64_tr_b16 v[152:153], v27 offset:6144
    ds_read_b64_tr_b16 v[154:155], v27 offset:6656
    s_waitcnt lgkmcnt(3)
    ds_write_b128 v28, v[148:151] offset:5120
    v_dot2_f32_bf16 v104, v148, v107, v104
    v_dot2_f32_bf16 v104, v149, v107, v104
    v_dot2_f32_bf16 v104, v150, v107, v104
    v_dot2_f32_bf16 v104, v151, v107, v104
    s_waitcnt lgkmcnt(1)
    ds_write_b128 v28, v[152:155] offset:6144
    v_dot2_f32_bf16 v104, v152, v107, v104
    v_dot2_f32_bf16 v104, v153, v107, v104
    v_dot2_f32_bf16 v104, v154, v107, v104
    v_dot2_f32_bf16 v104, v155, v107, v104
    s_cmp_eq_u32 s44, 1
    s_cbranch_scc1 L_walk1
    s_cmp_eq_u32 s44, 2
    s_cbranch_scc1 L_walk2
    s_cmp_eq_u32 s44, 3
    s_cbranch_scc1 L_walk3
    s_call_b64 s[98:99], L_pad0
    s_call_b64 s[98:99], L_pad4
    s_call_b64 s[98:99], L_pad8
    s_call_b64 s[98:99], L_pad12
    s_call_b64 s[98:99], L_pad16
    s_branch L_walkend
L_walk1:
    s_call_b64 s[98:99], L_pad1
    s_call_b64 s[98:99], L_pad5
    s_call_b64 s[98:99], L_pad9
    s_call_b64 s[98:99], L_pad13
    s_call_b64 s[98:99], L_pad17
    s_branch L_walkend
L_walk2:
    s_call_b64 s[98:99], L_pad2
    s_call_b64 s[98:99], L_pad6
    s_call_b64 s[98:99], L_pad10
    s_call_b64 s[98:99], L_pad14
    s_call_b64 s[98:99], L_pad18
    s_branch L_walkend
L_walk3:
    s_call_b64 s[98:99], L_pad3
    s_call_b64 s[98:99], L_pad7
    s_call_b64 s[98:99], L_pad11
    s_call_b64 s[98:99], L_pad15
    s_call_b64 s[98:99], L_pad19
L_walkend:
    s_waitcnt vmcnt(7)
    ds_read_b64_tr_b16 v[160:161], v27 offset:28672
    ds_read_b64_tr_b16 v[162:163], v27 offset:29184
    s_waitcnt vmcnt(6)
    ds_read_b64_tr_b16 v[164:165], v27 offset:29696
    ds_read_b64_tr_b16 v[166:167], v27 offset:30208
    s_waitcnt lgkmcnt(2)
    ds_write_b128 v28, v[160:163] offset:28672
    v_dot2_f32_bf16 v105, v160, v107, 0
    v_dot2_f32_bf16 v105, v161, v107, v105
    v_dot2_f32_bf16 v105, v162, v107, v105
    v_dot2_f32_bf16 v105, v163, v107, v105
    s_waitcnt vmcnt(5)
    ds_read_b64_tr_b16 v[168:169], v27 offset:30720
    ds_read_b64_tr_b16 v[170:171], v27 offset:31232
    s_waitcnt lgkmcnt(3)
    ds_write_b128 v28, v[164:167] offset:29696
    v_dot2_f32_bf16 v105, v164, v107, v105
    v_dot2_f32_bf16 v105, v165, v107, v105
    v_dot2_f32_bf16 v105, v166, v107, v105
    v_dot2_f32_bf16 v105, v167, v107, v105
    s_waitcnt vmcnt(4)
    ds_read_b64_tr_b16 v[172:173], v27 offset:31744
    ds_read_b64_tr_b16 v[174:175], v27 offset:32256
    s_waitcnt lgkmcnt(3)
    ds_write_b128 v28, v[168:171] offset:30720
    v_dot2_f32_bf16 v105, v168, v107, v105
    v_dot2_f32_bf16 v105, v169, v107, v105
    v_dot2_f32_bf16 v105, v170, v107, v105
    v_dot2_f32_bf16 v105, v171, v107, v105
    s_waitcnt vmcnt(3)
    ds_read_b64_tr_b16 v[176:177], v27 offset:32768
    ds_read_b64_tr_b16 v[178:179], v27 offset:33280
    s_waitcnt lgkmcnt(3)
    ds_write_b128 v28, v[172:175] offset:31744
    v_dot2_f32_bf16 v105, v172, v107, v105
    v_dot2_f32_bf16 v105, v173, v107, v105
    v_dot2_f32_bf16 v105, v174, v107, v105
    v_dot2_f32_bf16 v105, v175, v107, v105
    s_waitcnt vmcnt(2)
    ds_read_b64_tr_b16 v[180:181], v27 offset:33792
    ds_read_b64_tr_b16 v[182:183], v27 offset:34304
    s_waitcnt lgkmcnt(3)
    ds_write_b128 v28, v[176:179] offset:32768
    v_dot2_f32_bf16 v105, v176, v107, v105
    v_dot2_f32_bf16 v105, v177, v107, v105
    v_dot2_f32_bf16 v105, v178, v107, v105
    v_dot2_f32_bf16 v105, v179, v107, v105
    s_waitcnt vmcnt(1)
    ds_read_b64_tr_b16 v[184:185], v27 offset:34816
    ds_read_b64_tr_b16 v[186:187], v27 offset:35328
    s_waitcnt lgkmcnt(3)
    ds_write_b128 v28, v[180:183] offset:33792
    v_dot2_f32_bf16 v105, v180, v107, v105
    v_dot2_f32_bf16 v105, v181, v107, v105
    v_dot2_f32_bf16 v105, v182, v107, v105
    v_dot2_f32_bf16 v105, v183, v107, v105
    s_waitcnt lgkmcnt(1)
    ds_write_b128 v28, v[184:187] offset:34816
    v_dot2_f32_bf16 v105, v184, v107, v105
    v_dot2_f32_bf16 v105, v185, v107, v105
    v_dot2_f32_bf16 v105, v186, v107, v105
    v_dot2_f32_bf16 v105, v187, v107, v105
    v_mov_b32 v22, v104
    s_nop 1
    v_permlane32_swap_b32 v104, v22
    v_add_f32 v104, v104, v22
    v_mov_b32 v22, v105
    s_nop 1
    v_permlane32_swap_b32 v105, v22
    v_add_f32 v105, v105, v22
    v_and_b32 v22, 31, v0
    v_lshlrev_b32 v22, 2, v22
    s_lshl_b32 s60, s44, 8
    s_add_u32 s60, s60, 162816
    v_add_u32 v23, s60, v22
    ds_write_b32 v23, v104 offset:0
    ds_write_b32 v23, v105 offset:128
    s_mov_b32 s67, -1
    s_cmp_eq_u32 s84, 0
    s_cbranch_scc1 L_jobB_14
    s_cmp_eq_u32 s84, 5
    s_cbranch_scc1 L_jobB_13
    s_cmp_ge_u32 s84, 3
    s_cbranch_scc1 L_jobB_11
    v_lshl_add_u32 v21, v16, 5, v19
    v_add_u32 v21, s81, v21
    ds_read_b64_tr_b16 v[32:33], v21 offset:0
    ds_read_b64_tr_b16 v[34:35], v21 offset:512
    ds_read_b64_tr_b16 v[36:37], v21 offset:1024
    ds_read_b64_tr_b16 v[38:39], v21 offset:1536
    ds_read_b64_tr_b16 v[40:41], v21 offset:2048
    ds_read_b64_tr_b16 v[42:43], v21 offset:2560
    ds_read_b64_tr_b16 v[44:45], v21 offset:3072
    ds_read_b64_tr_b16 v[46:47], v21 offset:3584
    ds_read_b64_tr_b16 v[48:49], v21 offset:4096
    ds_read_b64_tr_b16 v[50:51], v21 offset:4608
    ds_read_b64_tr_b16 v[52:53], v21 offset:5120
    ds_read_b64_tr_b16 v[54:55], v21 offset:5632
    ds_read_b64_tr_b16 v[56:57], v21 offset:6144
    ds_read_b64_tr_b16 v[58:59], v21 offset:6656
    s_mul_i32 s83, s86, 100352
    s_add_u32 s83, s83, 2424832
    s_mul_i32 s85, s80, 3072
    s_add_u32 s85, s85, s83
    s_add_u32 s85, s85, 57344
    s_lshl_b32 s60, s80, 12
    s_add_u32 s83, s83, s60
    s_lshl_b32 s67, s86, 4
    s_add_u32 s67, s67, s80
    s_lshl_b32 s67, s67, 3
    s_add_u32 s67, s67, 10240
    s_add_u32 s65, s83, 0
    s_waitcnt lgkmcnt(12)
    buffer_store_dwordx4 v[32:35], v1, s[32:35], s65 offen offset:0 sc1
    s_waitcnt lgkmcnt(10)
    buffer_store_dwordx4 v[36:39], v1, s[32:35], s65 offen offset:1024 sc1
    s_waitcnt lgkmcnt(8)
    buffer_store_dwordx4 v[40:43], v1, s[32:35], s65 offen offset:2048 sc1
    s_waitcnt lgkmcnt(6)
    buffer_store_dwordx4 v[44:47], v1, s[32:35], s65 offen offset:3072 sc1
    s_waitcnt lgkmcnt(4)
    buffer_store_dwordx4 v[48:51], v1, s[32:35], s85 offen offset:0 sc1
    s_waitcnt lgkmcnt(2)
    buffer_store_dwordx4 v[52:55], v1, s[32:35], s85 offen offset:1024 sc1
    s_waitcnt lgkmcnt(0)
    buffer_store_dwordx4 v[56:59], v1, s[32:35], s85 offen offset:2048 sc1
    s_branch L_jobB_14
L_jobB_11:
    ds_read_b64_tr_b16 v[32:33], v21 offset:0
    ds_read_b64_tr_b16 v[34:35], v21 offset:1024
    ds_read_b64_tr_b16 v[36:37], v21 offset:512
    ds_read_b64_tr_b16 v[38:39], v21 offset:1536
    s_lshl_b32 s62, s40, 2
    s_add_u32 s62, s62, s45
    s_lshr_b32 s63, s62, 1
    s_and_b32 s64, s62, 1
    s_mul_i32 s83, s46, 229376
    s_mul_i32 s60, s63, 14336
    s_add_u32 s83, s83, s60
    s_lshl_b32 s60, s64, 13
    s_add_u32 s83, s83, s60
    s_lshl_b32 s60, s59, 10
    s_add_u32 s83, s83, s60
    s_add_u32 s83, s83, 4489216
    s_lshl_b32 s67, s46, 5
    s_add_u32 s67, s67, s62
    s_lshl_b32 s67, s67, 1
    s_add_u32 s67, s67, s59
    s_lshl_b32 s67, s67, 3
    s_add_u32 s67, s67, 12288
    s_cmp_eq_u32 s84, 4
    s_cbranch_scc1 L_jobB_12
    ds_read_b64_tr_b16 v[40:41], v21 offset:2048
    ds_read_b64_tr_b16 v[42:43], v21 offset:3072
    ds_read_b64_tr_b16 v[44:45], v21 offset:2560
    ds_read_b64_tr_b16 v[46:47], v21 offset:3584
    s_add_u32 s65, s83, 0
    s_waitcnt lgkmcnt(6)
    buffer_store_dwordx4 v[32:35], v1, s[32:35], s65 offen offset:0 sc1
    s_waitcnt lgkmcnt(4)
    buffer_store_dwordx4 v[36:39], v1, s[32:35], s65 offen offset:2048 sc1
    s_add_u32 s65, s83, 4096
    s_waitcnt lgkmcnt(2)
    buffer_store_dwordx4 v[40:43], v1, s[32:35], s65 offen offset:0 sc1
    s_waitcnt lgkmcnt(0)
    buffer_store_dwordx4 v[44:47], v1, s[32:35], s65 offen offset:2048 sc1
    s_branch L_jobB_14
L_jobB_12:
    ds_read_b64_tr_b16 v[40:41], v29 offset:2048
    ds_read_b64_tr_b16 v[42:43], v29 offset:2304
    s_waitcnt lgkmcnt(0)
    s_add_u32 s65, s83, 0
    buffer_store_dwordx4 v[32:35], v1, s[32:35], s65 offen offset:0 sc1
    buffer_store_dwordx4 v[36:39], v1, s[32:35], s65 offen offset:2048 sc1
    s_add_u32 s65, s83, 4096
    buffer_store_dwordx4 v[40:43], v1, s[32:35], s65 offen offset:0 sc1
    s_branch L_jobB_14
L_jobB_13:
    ds_read_b64_tr_b16 v[32:33], v21 offset:0
    ds_read_b64_tr_b16 v[34:35], v21 offset:512
    ds_read_b64_tr_b16 v[36:37], v21 offset:1024
    ds_read_b64_tr_b16 v[38:39], v21 offset:1536
    ds_read_b64_tr_b16 v[40:41], v21 offset:1792
    ds_read_b64_tr_b16 v[42:43], v21 offset:2304
    ds_read_b64_tr_b16 v[44:45], v21 offset:2816
    ds_read_b64_tr_b16 v[46:47], v21 offset:3328
    ds_read_b64_tr_b16 v[48:49], v21 offset:3584
    ds_read_b64_tr_b16 v[50:51], v21 offset:4096
    ds_read_b64_tr_b16 v[52:53], v21 offset:4608
    ds_read_b64_tr_b16 v[54:55], v21 offset:5120
    ds_read_b64_tr_b16 v[56:57], v21 offset:5376
    ds_read_b64_tr_b16 v[58:59], v21 offset:5888
    ds_read_b64_tr_b16 v[60:61], v21 offset:6400
    ds_read_b64_tr_b16 v[62:63], v21 offset:6912
    s_lshl_b32 s67, s40, 2
    s_add_u32 s67, s67, s46
    s_lshl_b32 s83, s67, 14
    s_lshl_b32 s60, s59, 10
    s_add_u32 s83, s83, s60
    s_add_u32 s83, s83, 4030464
    s_lshl_b32 s67, s67, 1
    s_add_u32 s67, s67, s59
    s_lshl_b32 s67, s67, 3
    s_add_u32 s67, s67, 16384
    s_waitcnt lgkmcnt(0)
    s_mov_b32 exec_lo, 0
    v_mov_b32 v38, 0
    v_mov_b32 v39, 0
    v_mov_b32 v46, 0
    v_mov_b32 v47, 0
    v_mov_b32 v54, 0
    v_mov_b32 v55, 0
    v_mov_b32 v62, 0
    v_mov_b32 v63, 0
    s_mov_b64 exec, -1
    s_add_u32 s65, s83, 0
    buffer_store_dwordx4 v[32:35], v1, s[32:35], s65 offen offset:0 sc1
    buffer_store_dwordx4 v[36:39], v1, s[32:35], s65 offen offset:2048 sc1
    s_add_u32 s65, s83, 4096
    buffer_store_dwordx4 v[40:43], v1, s[32:35], s65 offen offset:0 sc1
    buffer_store_dwordx4 v[44:47], v1, s[32:35], s65 offen offset:2048 sc1
    s_add_u32 s65, s83, 8192
    buffer_store_dwordx4 v[48:51], v1, s[32:35], s65 offen offset:0 sc1
    buffer_store_dwordx4 v[52:55], v1, s[32:35], s65 offen offset:2048 sc1
    s_add_u32 s65, s83, 12288
    buffer_store_dwordx4 v[56:59], v1, s[32:35], s65 offen offset:0 sc1
    buffer_store_dwordx4 v[60:63], v1, s[32:35], s65 offen offset:2048 sc1
L_jobB_14:
    s_waitcnt lgkmcnt(0)
    s_barrier
    v_add_u32 v23, 162816, v22
    ds_read_b32 v108, v23 offset:0
    ds_read_b32 v109, v23 offset:256
    ds_read_b32 v110, v23 offset:512
    ds_read_b32 v111, v23 offset:768
    ds_read_b32 v112, v23 offset:128
    ds_read_b32 v113, v23 offset:384
    ds_read_b32 v114, v23 offset:640
    ds_read_b32 v115, v23 offset:896
    v_add_u32 v23, 161792, v22
    s_waitcnt lgkmcnt(6)
    v_add_f32 v108, v108, v109
    s_waitcnt lgkmcnt(4)
    v_add_f32 v110, v110, v111
    v_add_f32 v108, v108, v110
    ds_write_b32 v23, v108 offset:0
    s_waitcnt lgkmcnt(3)
    v_add_f32 v112, v112, v113
    s_waitcnt lgkmcnt(1)
    v_add_f32 v114, v114, v115
    v_add_f32 v112, v112, v114
    ds_write_b32 v23, v112 offset:128
    s_waitcnt lgkmcnt(0)
    s_mul_i32 s88, s52, 128
    s_add_u32 s88, s88, s47
    s_add_u32 s88, s88, 1329152
    s_add_u32 s63, s47, 1015808
    s_add_u32 s64, s71, 1015808
    s_cmp_lg_u32 s50, 0
    s_cselect_b32 s63, s64, s63
    s_mul_i32 s80, s52, 28672
    s_add_u32 s80, s80, s63
    s_add_u32 s81, s80, 4096
    s_add_u32 s82, s80, 8192
    s_add_u32 s83, s80, 12288
    s_add_u32 s84, s80, 16384
    s_add_u32 s85, s80, 20480
    s_add_u32 s86, s80, 24576
    s_mul_i32 s87, s52, 3584
    s_add_u32 s87, s87, s47
    s_add_u32 s87, s87, 1277952
    s_lshl_b32 s60, s43, 3
    s_add_u32 s60, s60, s52
    s_mul_i32 s89, s60, 4096
    s_add_u32 s89, s89, s47
    s_add_u32 s89, s89, 0
    s_mul_i32 s90, s60, 128
    s_add_u32 s90, s90, s47
    s_add_u32 s90, s90, 1310720
    v_lshrrev_b32 v11, 5, v0
    v_lshlrev_b32 v11, 4, v11
    v_add_u32 v11, 161792, v11
    v_lshrrev_b32 v238, 2, v0
    v_mul_u32_u24 v238, 2688, v238
    v_and_b32 v239, 3, v0
    v_lshlrev_b32 v239, 4, v239
    v_min_u32 v239, 40, v239
    v_add_u32 v238, v238, v239
    ds_read_b128 v[192:195], v1 offset:0
    ds_read_b128 v[196:199], v1 offset:28672
    ds_read_b128 v[200:203], v1 offset:1024
    ds_read_b128 v[204:207], v1 offset:29696
    ds_read_b128 v[208:211], v1 offset:2048
    ds_read_b128 v[212:215], v1 offset:30720
    s_branch L_padskip0
L_pad0:
    s_setpc_b64 s[98:99]
L_padskip0:
    v_min_u32 v144, 104, v3
    v_add_u32 v144, s88, v144
    s_lshl_b32 s60, s40, 8
    s_add_u32 s60, s60, 3840
    v_add_u32 v145, s60, v3
    v_cmp_le_u32 vcc, 32, v0
    s_nop 1
    v_cndmask_b32 v144, v144, v145, vcc
    s_mov_b32 s66, 0
L_pur_15:
    buffer_load_dwordx2 v[146:147], v144, s[32:35], 0 offen sc1
    s_add_u32 s66, s66, 1
    s_cmp_gt_u32 s66, 65536
    s_cbranch_scc1 L_purout_16
    s_waitcnt vmcnt(0)
    v_xor_b32 v147, s49, v147
    v_xor_b32 v146, s48, v146
    v_and_b32 v145, 0x0fffffff, v147
    v_or_b32 v146, v146, v145
    v_cmp_ne_u32 vcc, 0, v146
    s_nop 0
    s_cbranch_vccnz L_pur_15
L_purout_16:
    buffer_load_dwordx4 v[32:35], v1, s[32:35], s80 offen offset:0 sc1
    buffer_load_dwordx4 v[36:39], v1, s[32:35], s80 offen offset:1024 sc1
    buffer_load_dwordx4 v[40:43], v1, s[32:35], s80 offen offset:2048 sc1
    buffer_load_dwordx4 v[44:47], v1, s[32:35], s80 offen offset:3072 sc1
    buffer_load_dwordx4 v[48:51], v1, s[32:35], s81 offen offset:0 sc1
    buffer_load_dwordx4 v[52:55], v1, s[32:35], s81 offen offset:1024 sc1
    buffer_load_dwordx4 v[56:59], v1, s[32:35], s81 offen offset:2048 sc1
    buffer_load_dwordx4 v[60:63], v1, s[32:35], s81 offen offset:3072 sc1
    s_cmp_eq_u32 s67, -1
    s_cbranch_scc1 L_noflag_17
    s_mov_b64 exec, 1
    buffer_store_dwordx2 v[12:13], off, s[32:35], s67 sc1
    s_mov_b64 exec, -1
L_noflag_17:
    v_readlane_b32 s61, v147, 32
    s_nop 1
    v_cmp_ne_u32 vcc, s61, v147
    s_nop 0
    s_cmp_eq_u32 vcc_hi, 0
    s_cselect_b32 s50, 1, 0
    s_cmp_eq_u32 s50, 0
    s_cselect_b64 s[54:55], -1, 0
    s_waitcnt vmcnt(7) lgkmcnt(4)
    v_mfma_f32_32x32x16_bf16 v[144:159], v[192:195], v[32:35], 0
    ds_read_b128 v[216:219], v1 offset:3072
    buffer_load_dwordx4 v[64:67], v1, s[32:35], s82 offen offset:0 sc1
    v_mfma_f32_32x32x16_bf16 v[160:175], v[196:199], v[32:35], 0
    ds_read_b128 v[220:223], v1 offset:31744
    s_waitcnt vmcnt(7) lgkmcnt(4)
    v_mfma_f32_32x32x16_bf16 v[144:159], v[200:203], v[36:39], v[144:159]
    ds_read_b128 v[192:195], v1 offset:4096
    buffer_load_dwordx4 v[68:71], v1, s[32:35], s82 offen offset:1024 sc1
    v_mfma_f32_32x32x16_bf16 v[160:175], v[204:207], v[36:39], v[160:175]
    ds_read_b128 v[196:199], v1 offset:32768
    s_waitcnt vmcnt(7) lgkmcnt(4)
    v_mfma_f32_32x32x16_bf16 v[144:159], v[208:211], v[40:43], v[144:159]
    ds_read_b128 v[200:203], v1 offset:5120
    buffer_load_dwordx4 v[72:75], v1, s[32:35], s82 offen offset:2048 sc1
    v_mfma_f32_32x32x16_bf16 v[160:175], v[212:215], v[40:43], v[160:175]
    ds_read_b128 v[204:207], v1 offset:33792
    s_waitcnt vmcnt(7) lgkmcnt(4)
    v_mfma_f32_32x32x16_bf16 v[144:159], v[216:219], v[44:47], v[144:159]
    ds_read_b128 v[208:211], v1 offset:6144
    buffer_load_dwordx4 v[76:79], v1, s[32:35], s82 offen offset:3072 sc1
    v_mfma_f32_32x32x16_bf16 v[160:175], v[220:223], v[44:47], v[160:175]
    ds_read_b128 v[212:215], v1 offset:34816
    s_waitcnt vmcnt(7) lgkmcnt(4)
    v_mfma_f32_32x32x16_bf16 v[144:159], v[192:195], v[48:51], v[144:159]
    ds_read_b128 v[216:219], v1 offset:7168
    buffer_load_dwordx4 v[80:83], v1, s[32:35], s83 offen offset:0 sc1
    v_mfma_f32_32x32x16_bf16 v[160:175], v[196:199], v[48:51], v[160:175]
    ds_read_b128 v[220:223], v1 offset:35840
    s_waitcnt vmcnt(7) lgkmcnt(4)
    v_mfma_f32_32x32x16_bf16 v[144:159], v[200:203], v[52:55], v[144:159]
    ds_read_b128 v[192:195], v1 offset:8192
    buffer_load_dwordx4 v[84:87], v1, s[32:35], s83 offen offset:1024 sc1
    v_mfma_f32_32x32x16_bf16 v[160:175], v[204:207], v[52:55], v[160:175]
    ds_read_b128 v[196:199], v1 offset:36864
    s_waitcnt vmcnt(7) lgkmcnt(4)
    v_mfma_f32_32x32x16_bf16 v[144:159], v[208:211], v[56:59], v[144:159]
    ds_read_b128 v[200:203], v1 offset:9216
    buffer_load_dwordx4 v[88:91], v1, s[32:35], s83 offen offset:2048 sc1
    v_mfma_f32_32x32x16_bf16 v[160:175], v[212:215], v[56:59], v[160:175]
    ds_read_b128 v[204:207], v1 offset:37888
    s_waitcnt vmcnt(7) lgkmcnt(4)
    v_mfma_f32_32x32x16_bf16 v[144:159], v[216:219], v[60:63], v[144:159]
    ds_read_b128 v[208:211], v1 offset:10240
    buffer_load_dwordx4 v[92:95], v1, s[32:35], s83 offen offset:3072 sc1
    v_mfma_f32_32x32x16_bf16 v[160:175], v[220:223], v[60:63], v[160:175]
    ds_read_b128 v[212:215], v1 offset:38912
    s_waitcnt vmcnt(7) lgkmcnt(4)
    v_mfma_f32_32x32x16_bf16 v[144:159], v[192:195], v[64:67], v[144:159]
    ds_read_b128 v[216:219], v1 offset:11264
    buffer_load_dwordx4 v[96:99], v1, s[32:35], s84 offen offset:0 sc1
    v_mfma_f32_32x32x16_bf16 v[160:175], v[196:199], v[64:67], v[160:175]
    ds_read_b128 v[220:223], v1 offset:39936
    s_waitcnt vmcnt(7) lgkmcnt(4)
    v_mfma_f32_32x32x16_bf16 v[144:159], v[200:203], v[68:71], v[144:159]
    ds_read_b128 v[192:195], v1 offset:12288
    buffer_load_dwordx4 v[100:103], v1, s[32:35], s84 offen offset:1024 sc1
    v_mfma_f32_32x32x16_bf16 v[160:175], v[204:207], v[68:71], v[160:175]
    ds_read_b128 v[196:199], v1 offset:40960
    s_waitcnt vmcnt(7) lgkmcnt(4)
    v_mfma_f32_32x32x16_bf16 v[144:159], v[208:211], v[72:75], v[144:159]
    ds_read_b128 v[200:203], v1 offset:13312
    buffer_load_dwordx4 v[104:107], v1, s[32:35], s84 offen offset:2048 sc1
    v_mfma_f32_32x32x16_bf16 v[160:175], v[212:215], v[72:75], v[160:175]
    ds_read_b128 v[204:207], v1 offset:41984
    s_waitcnt vmcnt(7) lgkmcnt(4)
    v_mfma_f32_32x32x16_bf16 v[144:159], v[216:219], v[76:79], v[144:159]
    ds_read_b128 v[208:211], v1 offset:14336
    buffer_load_dwordx4 v[108:111], v1, s[32:35], s84 offen offset:3072 sc1
    v_mfma_f32_32x32x16_bf16 v[160:175], v[220:223], v[76:79], v[160:175]
    ds_read_b128 v[212:215], v1 offset:43008
    s_waitcnt vmcnt(7) lgkmcnt(4)
    v_mfma_f32_32x32x16_bf16 v[144:159], v[192:195], v[80:83], v[144:159]
    ds_read_b128 v[216:219], v1 offset:15360
    buffer_load_dwordx4 v[112:115], v1, s[32:35], s85 offen offset:0 sc1
    v_mfma_f32_32x32x16_bf16 v[160:175], v[196:199], v[80:83], v[160:175]
    ds_read_b128 v[220:223], v1 offset:44032
    s_waitcnt vmcnt(7) lgkmcnt(4)
    v_mfma_f32_32x32x16_bf16 v[144:159], v[200:203], v[84:87], v[144:159]
    ds_read_b128 v[192:195], v1 offset:16384
    buffer_load_dwordx4 v[116:119], v1, s[32:35], s85 offen offset:1024 sc1
    v_mfma_f32_32x32x16_bf16 v[160:175], v[204:207], v[84:87], v[160:175]
    ds_read_b128 v[196:199], v1 offset:45056
    buffer_load_dwordx2 v[224:225], v4, s[32:35], s87 offen offset:0 sc1
    s_waitcnt vmcnt(8) lgkmcnt(4)
    v_mfma_f32_32x32x16_bf16 v[144:159], v[208:211], v[88:91], v[144:159]
    ds_read_b128 v[200:203], v1 offset:17408
    buffer_load_dwordx4 v[120:123], v1, s[32:35], s85 offen offset:2048 sc1
    v_mfma_f32_32x32x16_bf16 v[160:175], v[212:215], v[88:91], v[160:175]
    ds_read_b128 v[204:207], v1 offset:46080
    buffer_load_dwordx2 v[226:227], v4, s[32:35], s87 offen offset:256 sc1
    s_waitcnt vmcnt(9) lgkmcnt(4)
    v_mfma_f32_32x32x16_bf16 v[144:159], v[216:219], v[92:95], v[144:159]
    ds_read_b128 v[208:211], v1 offset:18432
    buffer_load_dwordx4 v[124:127], v1, s[32:35], s85 offen offset:3072 sc1
    s_mov_b32 s79, 0
    s_lshl_b32 s60, s44, 1
    s_add_u32 s60, s60, 0
    s_lshl_b32 s93, s60, 12
    v_mfma_f32_32x32x16_bf16 v[160:175], v[220:223], v[92:95], v[160:175]
    ds_read_b128 v[212:215], v1 offset:47104
    buffer_load_dwordx2 v[228:229], v4, s[32:35], s87 offen offset:512 sc1
    s_add_u32 s93, s93, 112640
    s_lshl_b32 s61, s42, 2
    s_add_u32 s60, s60, s61
    s_waitcnt vmcnt(10) lgkmcnt(4)
    v_mfma_f32_32x32x16_bf16 v[144:159], v[192:195], v[96:99], v[144:159]
    ds_read_b128 v[216:219], v1 offset:19456
    buffer_load_dwordx4 v[128:131], v1, s[32:35], s86 offen offset:0 sc1
    s_cmp_lt_u32 s60, 8
    s_cselect_b32 s61, 4587520, 0
    s_sub_u32 s61, s47, s61
    s_and_b32 s60, s60, 7
    v_mfma_f32_32x32x16_bf16 v[160:175], v[196:199], v[96:99], v[160:175]
    ds_read_b128 v[220:223], v1 offset:48128
    buffer_load_dwordx2 v[230:231], v4, s[32:35], s87 offen offset:768 sc1
    s_waitcnt vmcnt(11) lgkmcnt(4)
    v_mfma_f32_32x32x16_bf16 v[144:159], v[200:203], v[100:103], v[144:159]
    ds_read_b128 v[192:195], v1 offset:20480
    buffer_load_dwordx4 v[132:135], v1, s[32:35], s86 offen offset:1024 sc1
    s_cmp_lt_i32 s61, 6291456
    s_cselect_b32 s62, 1, 0
    s_cselect_b32 s61, s47, s61
    s_cselect_b32 s60, s52, s60
    v_mfma_f32_32x32x16_bf16 v[160:175], v[204:207], v[100:103], v[160:175]
    ds_read_b128 v[196:199], v1 offset:49152
    buffer_load_dwordx2 v[232:233], v4, s[32:35], s87 offen offset:1024 sc1
    s_or_b32 s79, s79, s62
    s_lshl_b32 s62, s43, 3
    s_add_u32 s60, s60, s62
    s_waitcnt vmcnt(12) lgkmcnt(4)
    v_mfma_f32_32x32x16_bf16 v[144:159], v[208:211], v[104:107], v[144:159]
    ds_read_b128 v[200:203], v1 offset:21504
    buffer_load_dwordx4 v[136:139], v1, s[32:35], s86 offen offset:2048 sc1
    s_lshl_b32 s91, s60, 12
    s_add_u32 s91, s91, s61
    s_lshl_b32 s60, s60, 7
    s_add_u32 s60, s60, s61
    v_mfma_f32_32x32x16_bf16 v[160:175], v[212:215], v[104:107], v[160:175]
    ds_read_b128 v[204:207], v1 offset:50176
    buffer_load_dwordx2 v[234:235], v4, s[32:35], s87 offen offset:1280 sc1
    s_add_u32 s95, s60, 1310720
    s_lshl_b32 s60, s44, 1
    s_add_u32 s60, s60, 1
    s_waitcnt vmcnt(13) lgkmcnt(4)
    v_mfma_f32_32x32x16_bf16 v[144:159], v[216:219], v[108:111], v[144:159]
    ds_read_b128 v[208:211], v1 offset:22528
    buffer_load_dwordx4 v[140:143], v1, s[32:35], s86 offen offset:3072 sc1
    s_lshl_b32 s94, s60, 12
    s_add_u32 s94, s94, 112640
    s_lshl_b32 s61, s42, 2
    s_add_u32 s60, s60, s61
    v_mfma_f32_32x32x16_bf16 v[160:175], v[220:223], v[108:111], v[160:175]
    ds_read_b128 v[212:215], v1 offset:51200
    buffer_load_dwordx2 v[236:237], v4, s[32:35], s87 offen offset:1536 sc1
    s_cmp_lt_u32 s60, 8
    s_cselect_b32 s61, 4587520, 0
    s_sub_u32 s61, s47, s61
    s_waitcnt vmcnt(14) lgkmcnt(4)
    v_mfma_f32_32x32x16_bf16 v[144:159], v[192:195], v[112:115], v[144:159]
    ds_read_b128 v[216:219], v1 offset:23552
    s_add_u32 m0, s77, 57344
    s_add_u32 s65, s76, 0
    buffer_load_dwordx4 v238, s[12:15], s65 offen offset:0  lds
    s_and_b32 s60, s60, 7
    v_mfma_f32_32x32x16_bf16 v[160:175], v[196:199], v[112:115], v[160:175]
    ds_read_b128 v[220:223], v1 offset:52224
    s_cmp_lt_i32 s61, 6291456
    s_cselect_b32 s62, 2, 0
    s_cselect_b32 s61, s47, s61
    s_cselect_b32 s60, s52, s60
    s_waitcnt vmcnt(14) lgkmcnt(4)
    v_mfma_f32_32x32x16_bf16 v[144:159], v[200:203], v[116:119], v[144:159]
    ds_read_b128 v[192:195], v1 offset:24576
    s_add_u32 m0, s77, 58368
    s_add_u32 s65, s76, 43008
    buffer_load_dwordx4 v238, s[12:15], s65 offen offset:0  lds
    s_or_b32 s79, s79, s62
    s_lshl_b32 s62, s43, 3
    v_mfma_f32_32x32x16_bf16 v[160:175], v[204:207], v[116:119], v[160:175]
    ds_read_b128 v[196:199], v1 offset:53248
    s_add_u32 s60, s60, s62
    s_lshl_b32 s92, s60, 12
    s_add_u32 s92, s92, s61
    s_lshl_b32 s60, s60, 7
    s_waitcnt vmcnt(13) lgkmcnt(4)
    v_mfma_f32_32x32x16_bf16 v[144:159], v[208:211], v[120:123], v[144:159]
    ds_read_b128 v[200:203], v1 offset:25600
    s_add_u32 m0, s77, 59392
    s_add_u32 s65, s76, 86016
    buffer_load_dwordx4 v238, s[12:15], s65 offen offset:0  lds
    s_add_u32 s60, s60, s61
    s_add_u32 s78, s60, 1310720
    v_mfma_f32_32x32x16_bf16 v[160:175], v[212:215], v[120:123], v[160:175]
    ds_read_b128 v[204:207], v1 offset:54272
    ds_read_b128 v[176:179], v11 offset:128
    ds_read_b128 v[180:183], v11 offset:160
    ds_read_b128 v[184:187], v11 offset:192
    ds_read_b128 v[188:191], v11 offset:224
    s_waitcnt vmcnt(12) lgkmcnt(8)
    v_mfma_f32_32x32x16_bf16 v[144:159], v[216:219], v[124:127], v[144:159]
    ds_read_b128 v[208:211], v1 offset:26624
    s_add_u32 m0, s77, 60416
    s_add_u32 s65, s76, 129024
    buffer_load_dwordx4 v238, s[12:15], s65 offen offset:0  lds
    ds_read_b128 v[16:19], v11 offset:0
    ds_read_b128 v[20:23], v11 offset:32
    v_mfma_f32_32x32x16_bf16 v[160:175], v[220:223], v[124:127], v[160:175]
    ds_read_b128 v[212:215], v1 offset:55296
    ds_read_b128 v[24:27], v11 offset:64
    ds_read_b128 v[28:31], v11 offset:96
    v_add_f32 v224, v224, v226
    v_add_f32 v225, v225, v227
    s_waitcnt vmcnt(11) lgkmcnt(12)
    v_mfma_f32_32x32x16_bf16 v[144:159], v[192:195], v[128:131], v[144:159]
    ds_read_b128 v[216:219], v1 offset:27648
    s_add_u32 m0, s77, 61440
    s_add_u32 s65, s76, 172032
    buffer_load_dwordx4 v238, s[12:15], s65 offen offset:0  lds
    v_add_f32 v224, v224, v228
    v_add_f32 v225, v225, v229
    v_mfma_f32_32x32x16_bf16 v[160:175], v[196:199], v[128:131], v[160:175]
    ds_read_b128 v[220:223], v1 offset:56320
    s_waitcnt vmcnt(11)
    v_add_f32 v224, v224, v230
    v_add_f32 v225, v225, v231
    s_waitcnt vmcnt(9)
    v_add_f32 v224, v224, v232
    v_add_f32 v225, v225, v233
    s_waitcnt lgkmcnt(12)
    v_mfma_f32_32x32x16_bf16 v[144:159], v[200:203], v[132:135], v[144:159]
    s_add_u32 m0, s77, 62464
    s_add_u32 s65, s76, 215040
    buffer_load_dwordx4 v238, s[12:15], s65 offen offset:0  lds
    s_waitcnt vmcnt(8)
    v_add_f32 v224, v224, v234
    v_add_f32 v225, v225, v235
    s_waitcnt vmcnt(6)
    v_add_f32 v224, v224, v236
    v_mfma_f32_32x32x16_bf16 v[160:175], v[204:207], v[132:135], v[160:175]
    v_add_f32 v225, v225, v237
    v_mov_b32 v226, v224
    v_mov_b32 v227, v225
    s_nop 0
    s_waitcnt lgkmcnt(4)
    v_mfma_f32_32x32x16_bf16 v[144:159], v[208:211], v[136:139], v[144:159]
    s_add_u32 m0, s77, 63488
    s_add_u32 s65, s76, 258048
    buffer_load_dwordx4 v238, s[12:15], s65 offen offset:0  lds
    v_permlane32_swap_b32 v224, v226
    v_mfma_f32_32x32x16_bf16 v[160:175], v[212:215], v[136:139], v[160:175]
    v_permlane32_swap_b32 v225, v227
    v_add_f32 v224, v224, v226
    v_add_f32 v225, v225, v227
    v_mul_f32 v14, 0xbb124925, v224
    s_waitcnt lgkmcnt(0)
    v_mfma_f32_32x32x16_bf16 v[144:159], v[216:219], v[140:143], v[144:159]
    v_mul_f32 v225, 0x3b124925, v225
    v_fma_f32 v225, -v14, v14, v225
    v_max_f32 v225, 0, v225
    v_add_f32 v225, 0x3727c5ac, v225
    v_rsq_f32 v15, v225
    v_mfma_f32_32x32x16_bf16 v[160:175], v[220:223], v[140:143], v[160:175]
    s_nop 5
    v_pk_fma_f32 v[144:145], v[16:17], v[14:15], v[144:145] op_sel:[0,0,0] op_sel_hi:[1,0,1]
    v_pk_fma_f32 v[146:147], v[18:19], v[14:15], v[146:147] op_sel:[0,0,0] op_sel_hi:[1,0,1]
    v_pk_fma_f32 v[148:149], v[20:21], v[14:15], v[148:149] op_sel:[0,0,0] op_sel_hi:[1,0,1]
    v_pk_fma_f32 v[150:151], v[22:23], v[14:15], v[150:151] op_sel:[0,0,0] op_sel_hi:[1,0,1]
    v_pk_fma_f32 v[152:153], v[24:25], v[14:15], v[152:153] op_sel:[0,0,0] op_sel_hi:[1,0,1]
    v_pk_fma_f32 v[154:155], v[26:27], v[14:15], v[154:155] op_sel:[0,0,0] op_sel_hi:[1,0,1]
    v_pk_fma_f32 v[156:157], v[28:29], v[14:15], v[156:157] op_sel:[0,0,0] op_sel_hi:[1,0,1]
    v_pk_fma_f32 v[158:159], v[30:31], v[14:15], v[158:159] op_sel:[0,0,0] op_sel_hi:[1,0,1]
    v_pk_mul_f32 v[144:145], v[144:145], v[14:15] op_sel:[0,1] op_sel_hi:[1,1]
    v_cvt_pk_bf16_f32 v16, v144, v145
    v_pk_mul_f32 v[146:147], v[146:147], v[14:15] op_sel:[0,1] op_sel_hi:[1,1]
    v_cvt_pk_bf16_f32 v17, v146, v147
    v_pk_mul_f32 v[148:149], v[148:149], v[14:15] op_sel:[0,1] op_sel_hi:[1,1]
    v_cvt_pk_bf16_f32 v18, v148, v149
    v_pk_mul_f32 v[150:151], v[150:151], v[14:15] op_sel:[0,1] op_sel_hi:[1,1]
    v_cvt_pk_bf16_f32 v19, v150, v151
    v_pk_mul_f32 v[152:153], v[152:153], v[14:15] op_sel:[0,1] op_sel_hi:[1,1]
    v_cvt_pk_bf16_f32 v20, v152, v153
    v_pk_mul_f32 v[154:155], v[154:155], v[14:15] op_sel:[0,1] op_sel_hi:[1,1]
    v_cvt_pk_bf16_f32 v21, v154, v155
    v_pk_mul_f32 v[156:157], v[156:157], v[14:15] op_sel:[0,1] op_sel_hi:[1,1]
    v_cvt_pk_bf16_f32 v22, v156, v157
    v_pk_mul_f32 v[158:159], v[158:159], v[14:15] op_sel:[0,1] op_sel_hi:[1,1]
    v_cvt_pk_bf16_f32 v23, v158, v159
    s_mov_b32 exec_lo, 0
    v_mov_b32 v22, 0x3f803f80
    v_mov_b32 v23, 0x3f80
    s_mov_b64 exec, -1
    buffer_store_dwordx4 v[16:19], v1, s[32:35], s89 offen offset:0 sc1
    buffer_store_dwordx4 v[20:23], v1, s[32:35], s89 offen offset:1024 sc1
    v_pk_fma_f32 v[160:161], v[176:177], v[14:15], v[160:161] op_sel:[0,0,0] op_sel_hi:[1,0,1]
    v_pk_fma_f32 v[162:163], v[178:179], v[14:15], v[162:163] op_sel:[0,0,0] op_sel_hi:[1,0,1]
    v_pk_fma_f32 v[164:165], v[180:181], v[14:15], v[164:165] op_sel:[0,0,0] op_sel_hi:[1,0,1]
    v_pk_fma_f32 v[166:167], v[182:183], v[14:15], v[166:167] op_sel:[0,0,0] op_sel_hi:[1,0,1]
    v_pk_fma_f32 v[168:169], v[184:185], v[14:15], v[168:169] op_sel:[0,0,0] op_sel_hi:[1,0,1]
    v_pk_fma_f32 v[170:171], v[186:187], v[14:15], v[170:171] op_sel:[0,0,0] op_sel_hi:[1,0,1]
    v_pk_fma_f32 v[172:173], v[188:189], v[14:15], v[172:173] op_sel:[0,0,0] op_sel_hi:[1,0,1]
    v_pk_fma_f32 v[174:175], v[190:191], v[14:15], v[174:175] op_sel:[0,0,0] op_sel_hi:[1,0,1]
    v_pk_mul_f32 v[160:161], v[160:161], v[14:15] op_sel:[0,1] op_sel_hi:[1,1]
    v_cvt_pk_bf16_f32 v24, v160, v161
    v_pk_mul_f32 v[162:163], v[162:163], v[14:15] op_sel:[0,1] op_sel_hi:[1,1]
    v_cvt_pk_bf16_f32 v25, v162, v163
    v_pk_mul_f32 v[164:165], v[164:165], v[14:15] op_sel:[0,1] op_sel_hi:[1,1]
    v_cvt_pk_bf16_f32 v26, v164, v165
    v_pk_mul_f32 v[166:167], v[166:167], v[14:15] op_sel:[0,1] op_sel_hi:[1,1]
    v_cvt_pk_bf16_f32 v27, v166, v167
    v_pk_mul_f32 v[168:169], v[168:169], v[14:15] op_sel:[0,1] op_sel_hi:[1,1]
    v_cvt_pk_bf16_f32 v28, v168, v169
    v_pk_mul_f32 v[170:171], v[170:171], v[14:15] op_sel:[0,1] op_sel_hi:[1,1]
    v_cvt_pk_bf16_f32 v29, v170, v171
    v_pk_mul_f32 v[172:173], v[172:173], v[14:15] op_sel:[0,1] op_sel_hi:[1,1]
    v_cvt_pk_bf16_f32 v30, v172, v173
    v_pk_mul_f32 v[174:175], v[174:175], v[14:15] op_sel:[0,1] op_sel_hi:[1,1]
    v_cvt_pk_bf16_f32 v31, v174, v175
    s_mov_b32 exec_lo, 0
    v_mov_b32 v30, 0x3f80
    v_mov_b32 v31, 0x0
    s_mov_b64 exec, -1
    buffer_store_dwordx4 v[24:27], v1, s[32:35], s89 offen offset:2048 sc1
    buffer_store_dwordx4 v[28:31], v1, s[32:35], s89 offen offset:3072 sc1
    v_and_b32 v225, 3, v0
    v_lshlrev_b32 v225, 3, v225
    v_bfe_u32 v226, v0, 4, 1
    v_lshl_add_u32 v225, v226, 5, v225
    v_bfe_u32 v226, v0, 2, 2
    v_lshl_add_u32 v225, v226, 6, v225
    v_lshrrev_b32 v226, 5, v0
    v_lshl_add_u32 v225, v226, 8, v225
    v_add_u32 v225, s77, v225
    v_and_b32 v226, 18, v0
    v_cmp_eq_u32 vcc, 18, v226
    v_xor_b32 v226, 8, v225
    s_nop 0
    v_cndmask_b32 v225, v225, v226, vcc
    v_add_u32 v226, s77, v1
    v_mov_b32 v173, s57
    s_waitcnt vmcnt(10)
    ds_read_b64_tr_b16 v[144:145], v225 offset:57344
    ds_read_b64_tr_b16 v[146:147], v225 offset:57856
    s_waitcnt vmcnt(9)
    ds_read_b64_tr_b16 v[148:149], v225 offset:58368
    ds_read_b64_tr_b16 v[150:151], v225 offset:58880
    s_waitcnt lgkmcnt(2)
    ds_write_b128 v226, v[144:147] offset:57344
    v_dot2_f32_bf16 v172, v144, v173, 0
    v_dot2_f32_bf16 v172, v145, v173, v172
    v_dot2_f32_bf16 v172, v146, v173, v172
    v_dot2_f32_bf16 v172, v147, v173, v172
    s_waitcnt vmcnt(8)
    ds_read_b64_tr_b16 v[152:153], v225 offset:59392
    ds_read_b64_tr_b16 v[154:155], v225 offset:59904
    s_waitcnt lgkmcnt(3)
    ds_write_b128 v226, v[148:151] offset:58368
    v_dot2_f32_bf16 v172, v148, v173, v172
    v_dot2_f32_bf16 v172, v149, v173, v172
    v_dot2_f32_bf16 v172, v150, v173, v172
    v_dot2_f32_bf16 v172, v151, v173, v172
    s_waitcnt vmcnt(7)
    ds_read_b64_tr_b16 v[156:157], v225 offset:60416
    ds_read_b64_tr_b16 v[158:159], v225 offset:60928
    s_waitcnt lgkmcnt(3)
    ds_write_b128 v226, v[152:155] offset:59392
    v_dot2_f32_bf16 v172, v152, v173, v172
    v_dot2_f32_bf16 v172, v153, v173, v172
    v_dot2_f32_bf16 v172, v154, v173, v172
    v_dot2_f32_bf16 v172, v155, v173, v172
    s_waitcnt vmcnt(6)
    ds_read_b64_tr_b16 v[160:161], v225 offset:61440
    ds_read_b64_tr_b16 v[162:163], v225 offset:61952
    s_waitcnt lgkmcnt(3)
    ds_write_b128 v226, v[156:159] offset:60416
    v_dot2_f32_bf16 v172, v156, v173, v172
    v_dot2_f32_bf16 v172, v157, v173, v172
    v_dot2_f32_bf16 v172, v158, v173, v172
    v_dot2_f32_bf16 v172, v159, v173, v172
    s_waitcnt vmcnt(5)
    ds_read_b64_tr_b16 v[164:165], v225 offset:62464
    ds_read_b64_tr_b16 v[166:167], v225 offset:62976
    s_waitcnt lgkmcnt(3)
    ds_write_b128 v226, v[160:163] offset:61440
    v_dot2_f32_bf16 v172, v160, v173, v172
    v_dot2_f32_bf16 v172, v161, v173, v172
    v_dot2_f32_bf16 v172, v162, v173, v172
    v_dot2_f32_bf16 v172, v163, v173, v172
    s_waitcnt vmcnt(4)
    ds_read_b64_tr_b16 v[168:169], v225 offset:63488
    ds_read_b64_tr_b16 v[170:171], v225 offset:64000
    s_waitcnt lgkmcnt(3)
    ds_write_b128 v226, v[164:167] offset:62464
    v_dot2_f32_bf16 v172, v164, v173, v172
    v_dot2_f32_bf16 v172, v165, v173, v172
    v_dot2_f32_bf16 v172, v166, v173, v172
    v_dot2_f32_bf16 v172, v167, v173, v172
    s_waitcnt lgkmcnt(1)
    ds_write_b128 v226, v[168:171] offset:63488
    v_dot2_f32_bf16 v172, v168, v173, v172
    v_dot2_f32_bf16 v172, v169, v173, v172
    v_dot2_f32_bf16 v172, v170, v173, v172
    v_dot2_f32_bf16 v172, v171, v173, v172
    s_waitcnt vmcnt(0)
    s_mov_b64 exec, 1
    buffer_store_dwordx2 v[12:13], off, s[32:35], s90 sc1
    s_mov_b64 exec, -1
    v_accvgpr_write_b32 a224, v144
    v_accvgpr_write_b32 a225, v145
    v_accvgpr_write_b32 a226, v146
    v_accvgpr_write_b32 a227, v147
    v_accvgpr_write_b32 a228, v148
    v_accvgpr_write_b32 a229, v149
    v_accvgpr_write_b32 a230, v150
    v_accvgpr_write_b32 a231, v151
    v_accvgpr_write_b32 a232, v152
    v_accvgpr_write_b32 a233, v153
    v_accvgpr_write_b32 a234, v154
    v_accvgpr_write_b32 a235, v155
    v_accvgpr_write_b32 a236, v156
    v_accvgpr_write_b32 a237, v157
    v_accvgpr_write_b32 a238, v158
    v_accvgpr_write_b32 a239, v159
    v_accvgpr_write_b32 a240, v160
    v_accvgpr_write_b32 a241, v161
    v_accvgpr_write_b32 a242, v162
    v_accvgpr_write_b32 a243, v163
    v_accvgpr_write_b32 a244, v164
    v_accvgpr_write_b32 a245, v165
    v_accvgpr_write_b32 a246, v166
    v_accvgpr_write_b32 a247, v167
    v_accvgpr_write_b32 a248, v168
    v_accvgpr_write_b32 a249, v169
    v_accvgpr_write_b32 a250, v170
    v_accvgpr_write_b32 a251, v171
    v_mov_b32 v174, v172
    s_nop 1
    v_permlane32_swap_b32 v172, v174
    v_add_f32 v172, v172, v174
    v_and_b32 v174, 31, v0
    v_lshlrev_b32 v174, 2, v174
    s_lshl_b32 s60, s44, 8
    s_add_u32 s60, s60, 162816
    v_add_u32 v175, s60, v174
    ds_write_b32 v175, v172 offset:0
    s_waitcnt lgkmcnt(0)
    s_barrier
    v_add_u32 v175, 162816, v174
    ds_read_b32 v144, v175 offset:0
    ds_read_b32 v145, v175 offset:256
    ds_read_b32 v146, v175 offset:512
    ds_read_b32 v147, v175 offset:768
    v_add_u32 v175, 161792, v174
    s_waitcnt lgkmcnt(2)
    v_add_f32 v144, v144, v145
    s_waitcnt lgkmcnt(0)
    v_add_f32 v146, v146, v147
    v_add_f32 v144, v144, v146
    ds_write_b32 v175, v144 offset:256
    s_waitcnt lgkmcnt(0)
    ds_read_b128 v[192:195], v2 offset:0
    ds_read_b128 v[196:199], v2 offset:1024
    ds_read_b128 v[200:203], v2 offset:2048
    ds_read_b128 v[204:207], v2 offset:3072
    ds_read_b128 v[208:211], v2 offset:4096
    ds_read_b128 v[212:215], v2 offset:5120
    s_lshl_b32 s60, s43, 7
    s_add_u32 s60, s60, 10240
    s_lshl_b32 s61, s46, 6
    s_add_u32 s61, s61, 16272
    s_lshl_b32 s62, s46, 9
    s_lshl_b32 s63, s44, 7
    s_add_u32 s62, s62, s63
    s_add_u32 s62, s62, 12112
    v_mov_b32 v236, s60
    v_mov_b32 v237, s61
    v_cmp_le_u32 vcc, 14, v0
    s_nop 1
    v_cndmask_b32 v236, v236, v237, vcc
    v_mov_b32 v237, s62
    v_cmp_le_u32 vcc, 22, v0
    s_nop 1
    v_cndmask_b32 v236, v236, v237, vcc
    v_add_u32 v236, v236, v3
    s_waitcnt lgkmcnt(4)
    v_mfma_f32_32x32x16_bf16 v[176:191], v[192:195], v[32:35], 0
    ds_read_b128 v[216:219], v2 offset:6144
    s_lshl_b32 s60, s44, 12
    s_add_u32 s60, s60, 145408
    v_add_u32 v224, s60, v1
    v_mfma_f32_32x32x16_bf16 v[176:191], v[196:199], v[36:39], v[176:191]
    ds_read_b128 v[220:223], v2 offset:7168
    ds_write_b128 v224, v[16:19]
    ds_write_b128 v224, v[20:23] offset:1024
    v_and_b32 v225, 31, v0
    v_lshlrev_b32 v225, 6, v225
    s_waitcnt lgkmcnt(6)
    v_mfma_f32_32x32x16_bf16 v[176:191], v[200:203], v[40:43], v[176:191]
    ds_read_b128 v[192:195], v2 offset:8192
    v_lshrrev_b32 v224, 5, v0
    v_lshl_add_u32 v225, v224, 4, v225
    v_add_u32 v224, s60, v225
    v_mfma_f32_32x32x16_bf16 v[176:191], v[204:207], v[44:47], v[176:191]
    ds_read_b128 v[196:199], v2 offset:9216
    ds_write_b128 v224, v[24:27] offset:2048
    ds_write_b128 v224, v[28:31] offset:2080
    v_mul_f32 v15, 0x3e8b97f6, v15
    s_waitcnt lgkmcnt(8)
    v_mfma_f32_32x32x16_bf16 v[176:191], v[208:211], v[48:51], v[176:191]
    ds_read_b128 v[200:203], v2 offset:10240
    s_mov_b32 exec_hi, 0x3f
    buffer_load_dwordx2 v[30:31], v236, s[32:35], 0 offen offset:0 sc1
    s_mov_b64 exec, -1
    v_mfma_f32_32x32x16_bf16 v[176:191], v[212:215], v[52:55], v[176:191]
    ds_read_b128 v[204:207], v2 offset:11264
    s_waitcnt lgkmcnt(8)
    v_mfma_f32_32x32x16_bf16 v[176:191], v[216:219], v[56:59], v[176:191]
    ds_read_b128 v[208:211], v2 offset:12288
    v_mfma_f32_32x32x16_bf16 v[176:191], v[220:223], v[60:63], v[176:191]
    ds_read_b128 v[212:215], v2 offset:13312
    s_waitcnt lgkmcnt(6)
    v_mfma_f32_32x32x16_bf16 v[176:191], v[192:195], v[64:67], v[176:191]
    ds_read_b128 v[216:219], v2 offset:14336
    v_mfma_f32_32x32x16_bf16 v[176:191], v[196:199], v[68:71], v[176:191]
    ds_read_b128 v[220:223], v2 offset:15360
    s_waitcnt vmcnt(0)
    s_mov_b32 exec_hi, 0x3f
    v_cmp_ne_u64 vcc, s[48:49], v[30:31]
    s_mov_b64 exec, -1
    s_or_b64 vcc, vcc, vcc
    s_cbranch_scc1 L_peek_18
L_peekback_19:
    v_bfe_u32 v16, v0, 1, 1
    v_lshlrev_b32 v16, 10, v16
    v_and_b32 v17, 1, v0
    v_lshl_add_u32 v16, v17, 9, v16
    v_lshrrev_b32 v17, 2, v0
    v_lshl_add_u32 v16, v17, 4, v16
    s_waitcnt lgkmcnt(0)
    s_mov_b32 s66, 0
L_kvpoll_23:
    s_buffer_load_dwordx2 s[72:73], s[32:35], s95 glc
    s_buffer_load_dwordx2 s[74:75], s[32:35], s78 glc
    s_add_u32 s66, s66, 1
    s_cmp_gt_u32 s66, 65536
    s_cbranch_scc1 L_kvpollout_24
    s_waitcnt lgkmcnt(0)
    s_cmp_eq_u64 s[72:73], s[48:49]
    s_cbranch_scc0 L_kvpoll_23
    s_cmp_eq_u64 s[74:75], s[48:49]
    s_cbranch_scc0 L_kvpoll_23
L_kvpollout_24:
    s_bitcmp1_b32 s79, 0
    s_cbranch_scc1 L_null_25
    s_mov_b32 m0, s93
    s_sub_u32 s65, s91, 768
    buffer_load_dwordx4 v1, s[32:35], s91 offen sc1 lds
    buffer_load_dwordx4 v1, s[32:35], s91 offen offset:1024 sc1 lds
    buffer_load_dwordx4 v16, s[32:35], s91 offen offset:2048 sc1 lds
    buffer_load_dwordx4 v16, s[32:35], s65 offen offset:3072 sc1 lds
L_nullback_26:
    s_bitcmp1_b32 s79, 1
    s_cbranch_scc1 L_null_27
    s_mov_b32 m0, s94
    s_sub_u32 s65, s92, 768
    buffer_load_dwordx4 v1, s[32:35], s92 offen sc1 lds
    buffer_load_dwordx4 v1, s[32:35], s92 offen offset:1024 sc1 lds
    buffer_load_dwordx4 v16, s[32:35], s92 offen offset:2048 sc1 lds
    buffer_load_dwordx4 v16, s[32:35], s65 offen offset:3072 sc1 lds
L_nullback_28:
    v_mfma_f32_32x32x16_bf16 v[176:191], v[200:203], v[72:75], v[176:191]
    ds_read_b128 v[192:195], v2 offset:16384
    v_and_b32 v238, 31, v0
    v_lshrrev_b32 v239, 5, v0
    v_lshlrev_b32 v239, 2, v239
    v_sub_u32 v238, v238, v239
    v_mov_b32 v239, 0xf149f2ca
    v_mfma_f32_32x32x16_bf16 v[176:191], v[204:207], v[76:79], v[176:191]
    ds_read_b128 v[196:199], v2 offset:17408
    v_cmp_le_i32 vcc, 0, v238
    v_cmp_le_i32 s[4:5], 1, v238
    s_nop 0
    v_cndmask_b32_e64 v160, v239, 0, vcc
    v_cndmask_b32_e64 v161, v239, 0, s[4:5]
    v_mfma_f32_32x32x16_bf16 v[176:191], v[208:211], v[80:83], v[176:191]
    ds_read_b128 v[200:203], v2 offset:18432
    v_cndmask_b32_e64 v144, 0, v239, vcc
    v_cndmask_b32_e64 v145, 0, v239, s[4:5]
    v_cmp_le_i32 vcc, 2, v238
    v_cmp_le_i32 s[4:5], 3, v238
    s_nop 0
    v_cndmask_b32_e64 v162, v239, 0, vcc
    v_mfma_f32_32x32x16_bf16 v[176:191], v[212:215], v[84:87], v[176:191]
    ds_read_b128 v[204:207], v2 offset:19456
    v_cndmask_b32_e64 v163, v239, 0, s[4:5]
    v_cndmask_b32_e64 v146, 0, v239, vcc
    v_cndmask_b32_e64 v147, 0, v239, s[4:5]
    v_mfma_f32_32x32x16_bf16 v[176:191], v[216:219], v[88:91], v[176:191]
    ds_read_b128 v[208:211], v2 offset:20480
    v_cmp_le_i32 vcc, 8, v238
    v_cmp_le_i32 s[4:5], 9, v238
    s_nop 0
    v_cndmask_b32_e64 v164, v239, 0, vcc
    v_cndmask_b32_e64 v165, v239, 0, s[4:5]
    v_cndmask_b32_e64 v148, 0, v239, vcc
    v_mfma_f32_32x32x16_bf16 v[176:191], v[220:223], v[92:95], v[176:191]
    ds_read_b128 v[212:215], v2 offset:21504
    v_cndmask_b32_e64 v149, 0, v239, s[4:5]
    v_cmp_le_i32 vcc, 10, v238
    v_cmp_le_i32 s[4:5], 11, v238
    s_nop 0
    v_cndmask_b32_e64 v166, v239, 0, vcc
    s_waitcnt lgkmcnt(4)
    v_mfma_f32_32x32x16_bf16 v[176:191], v[192:195], v[96:99], v[176:191]
    ds_read_b128 v[216:219], v2 offset:22528
    v_cndmask_b32_e64 v167, v239, 0, s[4:5]
    v_cndmask_b32_e64 v150, 0, v239, vcc
    v_cndmask_b32_e64 v151, 0, v239, s[4:5]
    v_cmp_le_i32 vcc, 16, v238
    v_cmp_le_i32 s[4:5], 17, v238
    v_mfma_f32_32x32x16_bf16 v[176:191], v[196:199], v[100:103], v[176:191]
    ds_read_b128 v[220:223], v2 offset:23552
    v_cndmask_b32_e64 v168, v239, 0, vcc
    v_cndmask_b32_e64 v169, v239, 0, s[4:5]
    v_cndmask_b32_e64 v152, 0, v239, vcc
    v_cndmask_b32_e64 v153, 0, v239, s[4:5]
    s_waitcnt lgkmcnt(4)
    v_mfma_f32_32x32x16_bf16 v[176:191], v[200:203], v[104:107], v[176:191]
    ds_read_b128 v[192:195], v2 offset:24576
    v_cmp_le_i32 vcc, 18, v238
    v_cmp_le_i32 s[4:5], 19, v238
    s_nop 0
    v_cndmask_b32_e64 v170, v239, 0, vcc
    v_cndmask_b32_e64 v171, v239, 0, s[4:5]
    v_cndmask_b32_e64 v154, 0, v239, vcc
    v_mfma_f32_32x32x16_bf16 v[176:191], v[204:207], v[108:111], v[176:191]
    ds_read_b128 v[196:199], v2 offset:25600
    v_cndmask_b32_e64 v155, 0, v239, s[4:5]
    v_cmp_le_i32 vcc, 24, v238
    v_cmp_le_i32 s[4:5], 25, v238
    s_nop 0
    v_cndmask_b32_e64 v172, v239, 0, vcc
    s_waitcnt lgkmcnt(4)
    v_mfma_f32_32x32x16_bf16 v[176:191], v[208:211], v[112:115], v[176:191]
    ds_read_b128 v[200:203], v2 offset:26624
    v_cndmask_b32_e64 v173, v239, 0, s[4:5]
    v_cndmask_b32_e64 v156, 0, v239, vcc
    v_cndmask_b32_e64 v157, 0, v239, s[4:5]
    v_cmp_le_i32 vcc, 26, v238
    v_cmp_le_i32 s[4:5], 27, v238
    v_mfma_f32_32x32x16_bf16 v[176:191], v[212:215], v[116:119], v[176:191]
    ds_read_b128 v[204:207], v2 offset:27648
    v_cndmask_b32_e64 v174, v239, 0, vcc
    v_cndmask_b32_e64 v175, v239, 0, s[4:5]
    v_cndmask_b32_e64 v158, 0, v239, vcc
    v_cndmask_b32_e64 v159, 0, v239, s[4:5]
    s_waitcnt lgkmcnt(4)
    v_mfma_f32_32x32x16_bf16 v[176:191], v[216:219], v[120:123], v[176:191]
    ds_read_b128 v[224:227], v11 offset:256
    ds_read_b128 v[228:231], v11 offset:288
    ds_read_b128 v[232:235], v11 offset:320
    ds_read_b128 v[236:239], v11 offset:352
    v_mfma_f32_32x32x16_bf16 v[176:191], v[220:223], v[124:127], v[176:191]
    s_waitcnt lgkmcnt(6)
    v_mfma_f32_32x32x16_bf16 v[176:191], v[192:195], v[128:131], v[176:191]
    v_mfma_f32_32x32x16_bf16 v[176:191], v[196:199], v[132:135], v[176:191]
    s_waitcnt lgkmcnt(4)
    v_mfma_f32_32x32x16_bf16 v[176:191], v[200:203], v[136:139], v[176:191]
    v_mfma_f32_32x32x16_bf16 v[176:191], v[204:207], v[140:143], v[176:191]
    s_waitcnt lgkmcnt(3)
    s_nop 10
    v_pk_fma_f32 v[176:177], v[224:225], v[14:15], v[176:177] op_sel:[0,0,0] op_sel_hi:[1,0,1]
    v_pk_fma_f32 v[178:179], v[226:227], v[14:15], v[178:179] op_sel:[0,0,0] op_sel_hi:[1,0,1]
    s_waitcnt lgkmcnt(2)
    v_pk_fma_f32 v[180:181], v[228:229], v[14:15], v[180:181] op_sel:[0,0,0] op_sel_hi:[1,0,1]
    v_pk_fma_f32 v[182:183], v[230:231], v[14:15], v[182:183] op_sel:[0,0,0] op_sel_hi:[1,0,1]
    s_waitcnt lgkmcnt(1)
    v_pk_fma_f32 v[184:185], v[232:233], v[14:15], v[184:185] op_sel:[0,0,0] op_sel_hi:[1,0,1]
    v_pk_fma_f32 v[186:187], v[234:235], v[14:15], v[186:187] op_sel:[0,0,0] op_sel_hi:[1,0,1]
    s_waitcnt lgkmcnt(0)
    v_pk_fma_f32 v[188:189], v[236:237], v[14:15], v[188:189] op_sel:[0,0,0] op_sel_hi:[1,0,1]
    v_pk_fma_f32 v[190:191], v[238:239], v[14:15], v[190:191] op_sel:[0,0,0] op_sel_hi:[1,0,1]
    v_pk_mul_f32 v[176:177], v[176:177], v[14:15] op_sel:[0,1] op_sel_hi:[1,1]
    v_cvt_pk_bf16_f32 v136, v176, v177
    v_pk_mul_f32 v[178:179], v[178:179], v[14:15] op_sel:[0,1] op_sel_hi:[1,1]
    v_cvt_pk_bf16_f32 v137, v178, v179
    v_pk_mul_f32 v[180:181], v[180:181], v[14:15] op_sel:[0,1] op_sel_hi:[1,1]
    v_cvt_pk_bf16_f32 v138, v180, v181
    v_pk_mul_f32 v[182:183], v[182:183], v[14:15] op_sel:[0,1] op_sel_hi:[1,1]
    v_cvt_pk_bf16_f32 v139, v182, v183
    v_pk_mul_f32 v[184:185], v[184:185], v[14:15] op_sel:[0,1] op_sel_hi:[1,1]
    v_cvt_pk_bf16_f32 v140, v184, v185
    v_pk_mul_f32 v[186:187], v[186:187], v[14:15] op_sel:[0,1] op_sel_hi:[1,1]
    v_cvt_pk_bf16_f32 v141, v186, v187
    v_pk_mul_f32 v[188:189], v[188:189], v[14:15] op_sel:[0,1] op_sel_hi:[1,1]
    v_cvt_pk_bf16_f32 v142, v188, v189
    v_pk_mul_f32 v[190:191], v[190:191], v[14:15] op_sel:[0,1] op_sel_hi:[1,1]
    v_cvt_pk_bf16_f32 v143, v190, v191
    s_mov_b32 exec_lo, 0
    v_mov_b32 v142, 0x0
    v_mov_b32 v143, 0x3f800000
    s_mov_b64 exec, -1
    s_branch L_padskip1
L_pad1:
    s_setpc_b64 s[98:99]
L_padskip1:
    s_barrier
    s_lshl_b32 s60, s44, 12
    s_add_u32 s60, s60, 112640
    v_add_u32 v16, s60, v1
    v_lshrrev_b32 v106, 5, v0
    v_bfe_u32 v107, v0, 2, 2
    v_lshl_add_u32 v106, v106, 2, v107
    v_lshlrev_b32 v17, 6, v106
    v_bfe_u32 v106, v0, 4, 1
    v_lshl_add_u32 v17, v106, 5, v17
    v_and_b32 v106, 1, v0
    v_lshl_add_u32 v17, v106, 4, v17
    v_bfe_u32 v106, v0, 1, 1
    v_lshl_add_u32 v17, v106, 3, v17
    v_add_u32 v17, s60, v17
    s_lshl_b32 s60, s52, 4
    s_add_u32 s60, s60, s43
    s_cmp_lg_u32 s50, 0
    s_cselect_b32 s63, s71, s47
    s_mul_i32 s80, s60, 2048
    s_add_u32 s80, s80, s63
    s_add_u32 s80, s80, 524288
    s_mul_i32 s81, s60, 8
    s_add_u32 s81, s81, s47
    s_add_u32 s81, s81, 1327104
    s_lshl_b32 s82, s46, 2
    s_add_u32 s82, s82, s44
    s_lshl_b32 s82, s82, 14
    s_add_u32 s82, s82, 4030464
    s_add_u32 s83, s82, 4096
    s_add_u32 s84, s82, 8192
    s_add_u32 s85, s82, 12288
    v_lshlrev_b32 v28, 7, v0
    v_add_u32 v28, s80, v28
    s_lshl_b32 s60, s52, 7
    s_lshl_b32 s61, s45, 8
    s_lshl_b32 s62, s58, 7
    s_add_u32 s62, s62, s61
    s_mul_i32 s63, s62, 28
    s_lshl_b32 s64, s46, 9
    s_add_u32 s63, s63, s64
    s_lshl_b32 s64, s59, 8
    s_add_u32 s63, s63, s64
    s_add_u32 s64, s60, 1327104
    s_add_u32 s64, s64, s47
    v_writelane_b32 v28, s64, 16
    s_add_u32 s64, s61, 1327104
    s_add_u32 s64, s64, s47
    v_writelane_b32 v28, s64, 17
    s_add_u32 s64, s61, 1327232
    s_add_u32 s64, s64, s47
    v_writelane_b32 v28, s64, 18
    s_add_u32 s64, s60, 1328128
    s_add_u32 s64, s64, s47
    v_writelane_b32 v28, s64, 19
    s_add_u32 s64, s62, 1328128
    s_add_u32 s64, s64, s47
    v_writelane_b32 v28, s64, 20
    s_add_u32 s64, s63, 1245184
    s_add_u32 s64, s64, s47
    v_writelane_b32 v28, s64, 21
    s_add_u32 s64, s63, 1245312
    s_add_u32 s64, s64, s47
    v_writelane_b32 v28, s64, 22
    s_add_u32 s64, s60, 1331200
    s_add_u32 s64, s64, s47
    v_writelane_b32 v28, s64, 23
    s_add_u32 s64, s61, 1331200
    s_add_u32 s64, s64, s47
    v_writelane_b32 v28, s64, 24
    s_add_u32 s64, s61, 1331328
    s_add_u32 s64, s64, s47
    v_writelane_b32 v28, s64, 25
    s_add_u32 s64, s60, 1332224
    s_add_u32 s64, s64, s47
    v_writelane_b32 v28, s64, 26
    s_add_u32 s64, s61, 1332224
    s_add_u32 s64, s64, s47
    v_writelane_b32 v28, s64, 27
    s_add_u32 s64, s61, 1332352
    s_add_u32 s64, s64, s47
    v_writelane_b32 v28, s64, 28
    s_add_u32 s4, s63, 3571712
    s_add_u32 s4, s4, s47
    s_add_u32 s5, s63, 3571840
    s_add_u32 s5, s5, s47
    s_add_u32 s6, s62, 3622912
    s_add_u32 s6, s6, s47
    s_add_u32 s7, s60, 3622912
    s_add_u32 s7, s7, s47
    s_lshl_b32 s60, s59, 10
    v_xor_b32 v24, s60, v1
    v_xor_b32 v25, 1024, v24
    v_lshlrev_b32 v23, 7, v0
    s_lshl_b32 s60, s45, 1
    s_add_u32 s60, s60, s58
    s_lshl_b32 s61, s46, 1
    s_add_u32 s61, s61, s59
    s_mul_i32 s62, s60, 14
    s_add_u32 s62, s62, s61
    s_add_u32 s63, s47, 786432
    s_add_u32 s64, s71, 1015808
    s_cmp_lg_u32 s50, 0
    s_cselect_b32 s63, s64, s63
    s_mul_i32 s68, s62, 2048
    s_add_u32 s68, s68, s63
    s_mul_i32 s69, s62, 256
    s_add_u32 s69, s69, s47
    s_add_u32 s69, s69, 1245184
    s_lshl_b32 s60, s60, 4
    s_add_u32 s60, s60, s61
    s_mul_i32 s70, s60, 8
    s_add_u32 s70, s70, s47
    s_add_u32 s70, s70, 1328128
    s_cmp_ge_u32 s41, 28
    s_cselect_b32 s68, 4096, s68
    s_cselect_b32 s69, 4096, s69
    s_cselect_b32 s70, 4096, s70
    s_sub_u32 s60, s68, 3712
    v_add_u32 v106, s60, v23
    v_cmp_lt_u32 vcc, 28, v0
    s_nop 1
    v_cndmask_b32 v28, v28, v106, vcc
    v_writelane_b32 v28, s4, 45
    v_writelane_b32 v28, s5, 46
    v_writelane_b32 v28, s6, 47
    v_writelane_b32 v28, s7, 48
    s_lshl_b32 s60, s46, 2
    s_add_u32 s60, s60, s45
    s_lshl_b32 s86, s60, 14
    s_lshl_b32 s62, s44, 12
    s_add_u32 s86, s86, s62
    s_add_u32 s86, s86, 4030464
    s_mul_i32 s72, s43, 100352
    s_mul_i32 s73, s44, 13312
    s_add_u32 s72, s72, s73
    s_lshl_b32 s87, s46, 2
    s_add_u32 s87, s87, s44
    s_mul_i32 s87, s87, 57344
    s_lshl_b32 s61, s59, 10
    v_xor_b32 v26, s61, v1
    v_xor_b32 v27, 1024, v26
    s_add_u32 s63, 0, 0
    s_and_b32 s63, s63, 3
    s_mul_i32 s63, s63, 14336
    s_add_u32 s63, s63, s87
    s_add_u32 s64, s63, 4489216
    buffer_load_dwordx4 a[0:3], v26, s[32:35], s64 offen sc1
    buffer_load_dwordx4 a[4:7], v27, s[32:35], s64 offen sc1
    s_add_u32 s64, s63, 4491264
    buffer_load_dwordx4 a[8:11], v26, s[32:35], s64 offen sc1
    buffer_load_dwordx4 a[12:15], v27, s[32:35], s64 offen sc1
    s_add_u32 s64, s63, 4493312
    buffer_load_dwordx4 a[16:19], v26, s[32:35], s64 offen sc1
    buffer_load_dwordx4 a[20:23], v27, s[32:35], s64 offen sc1
    s_add_u32 s64, s63, 4495360
    buffer_load_dwordx4 a[24:27], v26, s[32:35], s64 offen sc1
    buffer_load_dwordx4 a[28:31], v27, s[32:35], s64 offen sc1
    s_add_u32 s64, s63, 4497408
    buffer_load_dwordx4 a[32:35], v26, s[32:35], s64 offen sc1
    buffer_load_dwordx4 a[36:39], v27, s[32:35], s64 offen sc1
    s_add_u32 s64, s63, 4499456
    buffer_load_dwordx4 a[40:43], v26, s[32:35], s64 offen sc1
    buffer_load_dwordx4 a[44:47], v27, s[32:35], s64 offen sc1
    s_add_u32 s64, s63, 4501504
    buffer_load_dwordx4 a[48:51], v26, s[32:35], s64 offen sc1
    buffer_load_dwordx4 a[52:55], v27, s[32:35], s64 offen sc1
    s_add_u32 s63, 0, 1
    s_and_b32 s63, s63, 3
    s_mul_i32 s63, s63, 14336
    s_add_u32 s63, s63, s87
    s_add_u32 s64, s63, 4489216
    buffer_load_dwordx4 a[56:59], v26, s[32:35], s64 offen sc1
    buffer_load_dwordx4 a[60:63], v27, s[32:35], s64 offen sc1
    s_add_u32 s64, s63, 4491264
    buffer_load_dwordx4 a[64:67], v26, s[32:35], s64 offen sc1
    buffer_load_dwordx4 a[68:71], v27, s[32:35], s64 offen sc1
    s_add_u32 s64, s63, 4493312
    buffer_load_dwordx4 a[72:75], v26, s[32:35], s64 offen sc1
    buffer_load_dwordx4 a[76:79], v27, s[32:35], s64 offen sc1
    s_branch L_padskip2
L_pad2:
    s_setpc_b64 s[98:99]
L_padskip2:
    s_waitcnt vmcnt(20) lgkmcnt(0)
    s_barrier
    s_mov_b32 exec_hi, 0
    buffer_load_dword a255, v23, s[32:35], s86 offen sc1
    s_mov_b32 exec_hi, 0x1ffff
    buffer_load_dword a255, v28, s[32:35], 0 offen sc1
    s_mov_b64 exec, -1
    ds_read_b128 v[32:35], v16 offset:0
    ds_read_b128 v[36:39], v16 offset:1024
    ds_read_b128 v[40:43], v16 offset:4096
    ds_read_b128 v[44:47], v16 offset:5120
    ds_read_b128 v[48:51], v16 offset:8192
    ds_read_b128 v[52:55], v16 offset:9216
    ds_read_b128 v[56:59], v16 offset:12288
    ds_read_b128 v[60:63], v16 offset:13312
    s_waitcnt lgkmcnt(7)
    v_mfma_f32_32x32x16_bf16 v[104:119], v[32:35], v[136:139], v[144:159]
    ds_read_b128 v[64:67], v16 offset:16384
    ds_read_b128 v[68:71], v16 offset:17408
    s_waitcnt lgkmcnt(8)
    v_mfma_f32_32x32x16_bf16 v[104:119], v[36:39], v[140:143], v[104:119]
    ds_read_b128 v[72:75], v16 offset:20480
    ds_read_b128 v[76:79], v16 offset:21504
    s_waitcnt lgkmcnt(9)
    v_mfma_f32_32x32x16_bf16 v[120:135], v[40:43], v[136:139], 0
    ds_read_b128 v[80:83], v16 offset:24576
    ds_read_b128 v[84:87], v16 offset:25600
    s_add_u32 s64, s63, 4495360
    buffer_load_dwordx4 a[80:83], v26, s[32:35], s64 offen sc1
    s_waitcnt lgkmcnt(10)
    v_mfma_f32_32x32x16_bf16 v[120:135], v[44:47], v[140:143], v[120:135]
    ds_read_b128 v[88:91], v16 offset:28672
    ds_read_b128 v[92:95], v16 offset:29696
    buffer_load_dwordx4 a[84:87], v27, s[32:35], s64 offen sc1
    s_waitcnt lgkmcnt(11)
    v_mfma_f32_32x32x16_bf16 v[176:191], v[48:51], v[136:139], 0
    ds_read_b128 v[96:99], v16 offset:32768
    ds_read_b128 v[100:103], v16 offset:33792
    s_add_u32 s64, s63, 4497408
    buffer_load_dwordx4 a[88:91], v26, s[32:35], s64 offen sc1
    v_max_f32 v18, v104, v105
    v_max_f32 v19, v106, v107
    v_max3_f32 v18, v108, v109, v18
    v_max3_f32 v19, v110, v111, v19
    s_waitcnt lgkmcnt(12)
    v_mfma_f32_32x32x16_bf16 v[176:191], v[52:55], v[140:143], v[176:191]
    buffer_load_dwordx4 a[92:95], v27, s[32:35], s64 offen sc1
    v_max3_f32 v18, v112, v113, v18
    v_max3_f32 v19, v114, v115, v19
    v_max3_f32 v18, v116, v117, v18
    v_max3_f32 v19, v118, v119, v19
    s_waitcnt lgkmcnt(11)
    v_mfma_f32_32x32x16_bf16 v[104:119], v[56:59], v[136:139], 0
    s_add_u32 m0, s73, 57344
    s_add_u32 s65, s72, 2424832
    buffer_load_dwordx4 v1, s[32:35], s65 offen offset:0 sc1 lds
    s_add_u32 s64, s63, 4499456
    buffer_load_dwordx4 a[96:99], v26, s[32:35], s64 offen sc1
    v_max3_f32 v18, v120, v121, v18
    v_max3_f32 v19, v122, v123, v19
    v_max3_f32 v18, v124, v125, v18
    v_max3_f32 v19, v126, v127, v19
    s_waitcnt lgkmcnt(10)
    v_mfma_f32_32x32x16_bf16 v[104:119], v[60:63], v[140:143], v[104:119]
    buffer_load_dwordx4 a[100:103], v27, s[32:35], s64 offen sc1
    v_max3_f32 v18, v128, v129, v18
    v_max3_f32 v19, v130, v131, v19
    v_max3_f32 v18, v132, v133, v18
    v_max3_f32 v19, v134, v135, v19
    s_waitcnt lgkmcnt(9)
    v_mfma_f32_32x32x16_bf16 v[120:135], v[64:67], v[136:139], 0
    s_add_u32 s64, s63, 4501504
    buffer_load_dwordx4 a[104:107], v26, s[32:35], s64 offen sc1
    v_max3_f32 v18, v176, v177, v18
    v_max3_f32 v19, v178, v179, v19
    v_max3_f32 v18, v180, v181, v18
    v_max3_f32 v19, v182, v183, v19
    s_waitcnt lgkmcnt(8)
    v_mfma_f32_32x32x16_bf16 v[120:135], v[68:71], v[140:143], v[120:135]
    buffer_load_dwordx4 a[108:111], v27, s[32:35], s64 offen sc1
    v_max3_f32 v18, v184, v185, v18
    v_max3_f32 v19, v186, v187, v19
    v_max3_f32 v18, v188, v189, v18
    v_max3_f32 v19, v190, v191, v19
    s_waitcnt lgkmcnt(7)
    v_mfma_f32_32x32x16_bf16 v[176:191], v[72:75], v[136:139], 0
    buffer_load_dwordx4 v1, s[32:35], s65 offen offset:1024 sc1 lds
    s_add_u32 s63, 0, 2
    s_and_b32 s63, s63, 3
    s_mul_i32 s63, s63, 14336
    s_add_u32 s63, s63, s87
    s_add_u32 s64, s63, 4489216
    buffer_load_dwordx4 a[112:115], v26, s[32:35], s64 offen sc1
    v_max3_f32 v18, v104, v105, v18
    v_max3_f32 v19, v106, v107, v19
    v_max3_f32 v18, v108, v109, v18
    v_max3_f32 v19, v110, v111, v19
    s_waitcnt lgkmcnt(6)
    v_mfma_f32_32x32x16_bf16 v[176:191], v[76:79], v[140:143], v[176:191]
    buffer_load_dwordx4 a[116:119], v27, s[32:35], s64 offen sc1
    v_max3_f32 v18, v112, v113, v18
    v_max3_f32 v19, v114, v115, v19
    v_max3_f32 v18, v116, v117, v18
    v_max3_f32 v19, v118, v119, v19
    s_waitcnt lgkmcnt(5)
    v_mfma_f32_32x32x16_bf16 v[104:119], v[80:83], v[136:139], 0
    s_add_u32 s64, s63, 4491264
    buffer_load_dwordx4 a[120:123], v26, s[32:35], s64 offen sc1
    v_max3_f32 v18, v120, v121, v18
    v_max3_f32 v19, v122, v123, v19
    v_max3_f32 v18, v124, v125, v18
    v_max3_f32 v19, v126, v127, v19
    s_waitcnt lgkmcnt(4)
    v_mfma_f32_32x32x16_bf16 v[104:119], v[84:87], v[140:143], v[104:119]
    buffer_load_dwordx4 a[124:127], v27, s[32:35], s64 offen sc1
    v_max3_f32 v18, v128, v129, v18
    v_max3_f32 v19, v130, v131, v19
    v_max3_f32 v18, v132, v133, v18
    v_max3_f32 v19, v134, v135, v19
    s_waitcnt lgkmcnt(3)
    v_mfma_f32_32x32x16_bf16 v[120:135], v[88:91], v[136:139], 0
    ds_read_b64_tr_b16 v[224:225], v17 offset:2048
    ds_read_b64_tr_b16 v[226:227], v17 offset:2560
    buffer_load_dwordx4 v1, s[32:35], s65 offen offset:2048 sc1 lds
    s_add_u32 s64, s63, 4493312
    buffer_load_dwordx4 a[128:131], v26, s[32:35], s64 offen sc1
    v_max3_f32 v18, v176, v177, v18
    v_max3_f32 v19, v178, v179, v19
    v_max3_f32 v18, v180, v181, v18
    v_max3_f32 v19, v182, v183, v19
    s_waitcnt lgkmcnt(4)
    v_mfma_f32_32x32x16_bf16 v[120:135], v[92:95], v[140:143], v[120:135]
    buffer_load_dwordx4 a[132:135], v27, s[32:35], s64 offen sc1
    v_max3_f32 v18, v184, v185, v18
    v_max3_f32 v19, v186, v187, v19
    v_max3_f32 v18, v188, v189, v18
    v_max3_f32 v19, v190, v191, v19
    s_waitcnt lgkmcnt(3)
    v_mfma_f32_32x32x16_bf16 v[176:191], v[96:99], v[136:139], v[160:175]
    ds_read_b64_tr_b16 v[228:229], v17 offset:3072
    ds_read_b64_tr_b16 v[230:231], v17 offset:3584
    s_add_u32 s64, s63, 4495360
    buffer_load_dwordx4 a[136:139], v26, s[32:35], s64 offen sc1
    v_max3_f32 v18, v104, v105, v18
    v_max3_f32 v19, v106, v107, v19
    v_max3_f32 v18, v108, v109, v18
    v_max3_f32 v19, v110, v111, v19
    s_waitcnt lgkmcnt(4)
    v_mfma_f32_32x32x16_bf16 v[176:191], v[100:103], v[140:143], v[176:191]
    buffer_load_dwordx4 a[140:143], v27, s[32:35], s64 offen sc1
    v_max3_f32 v18, v112, v113, v18
    v_max3_f32 v19, v114, v115, v19
    v_max3_f32 v18, v116, v117, v18
    v_max3_f32 v19, v118, v119, v19
    v_max3_f32 v18, v120, v121, v18
    v_max3_f32 v19, v122, v123, v19
    v_max3_f32 v18, v124, v125, v18
    v_max3_f32 v19, v126, v127, v19
    v_max3_f32 v18, v128, v129, v18
    v_max3_f32 v19, v130, v131, v19
    v_max3_f32 v18, v132, v133, v18
    v_max3_f32 v19, v134, v135, v19
    v_max3_f32 v18, v176, v177, v18
    v_max3_f32 v19, v178, v179, v19
    v_max3_f32 v18, v180, v181, v18
    v_max3_f32 v19, v182, v183, v19
    v_max3_f32 v18, v184, v185, v18
    v_max3_f32 v19, v186, v187, v19
    v_max3_f32 v18, v188, v189, v18
    v_max3_f32 v19, v190, v191, v19
    v_max_f32 v18, v18, v19
    v_mov_b32 v20, v18
    s_nop 1
    v_permlane32_swap_b32 v18, v20
    v_max_f32 v18, v18, v20
    v_xor_b32 v18, 0x80000000, v18
    v_and_b32 v20, 0xffff0000, v18
    v_sub_f32 v22, v18, v20
    v_and_b32 v20, 0xffff0000, v22
    v_sub_f32 v21, v22, v20
    s_mov_b32 exec_lo, 0
    v_perm_b32 v142, v22, v18, s56
    v_perm_b32 v143, 1.0, v21, s56
    s_mov_b64 exec, -1
    s_branch L_padskip3
L_pad3:
    s_setpc_b64 s[98:99]
L_padskip3:
    v_mfma_f32_32x32x16_bf16 v[104:119], v[32:35], v[136:139], v[144:159]
    v_mfma_f32_32x32x16_bf16 v[104:119], v[36:39], v[140:143], v[104:119]
    v_mfma_f32_32x32x16_bf16 v[120:135], v[40:43], v[136:139], 0
    v_mfma_f32_32x32x16_bf16 v[120:135], v[44:47], v[140:143], v[120:135]
    s_nop 9
    v_exp_f32 v104, v104
    v_exp_f32 v105, v105
    v_exp_f32 v106, v106
    v_mfma_f32_32x32x16_bf16 v[176:191], v[48:51], v[136:139], 0
    ds_read_b64_tr_b16 v[232:233], v17 offset:6144
    ds_read_b64_tr_b16 v[234:235], v17 offset:6656
    buffer_load_dwordx4 v1, s[32:35], s65 offen offset:3072 sc1 lds
    s_add_u32 s64, s63, 4497408
    buffer_load_dwordx4 a[144:147], v26, s[32:35], s64 offen sc1
    buffer_load_dwordx4 a[148:151], v27, s[32:35], s64 offen sc1
    v_exp_f32 v107, v107
    v_cvt_pk_bf16_f32 v208, v104, v105
    v_exp_f32 v108, v108
    v_exp_f32 v109, v109
    v_cvt_pk_bf16_f32 v209, v106, v107
    v_mfma_f32_32x32x16_bf16 v[176:191], v[52:55], v[140:143], v[176:191]
    ds_read_b64_tr_b16 v[236:237], v17 offset:7168
    ds_read_b64_tr_b16 v[238:239], v17 offset:7680
    s_add_u32 m0, s73, 61440
    s_add_u32 s65, s72, 2428928
    buffer_load_dwordx4 v1, s[32:35], s65 offen offset:0 sc1 lds
    s_add_u32 s64, s63, 4499456
    buffer_load_dwordx4 a[152:155], v26, s[32:35], s64 offen sc1
    buffer_load_dwordx4 a[156:159], v27, s[32:35], s64 offen sc1
    v_exp_f32 v110, v110
    v_exp_f32 v111, v111
    v_cvt_pk_bf16_f32 v210, v108, v109
    v_exp_f32 v112, v112
    v_exp_f32 v113, v113
    v_cvt_pk_bf16_f32 v211, v110, v111
    v_exp_f32 v114, v114
    v_exp_f32 v115, v115
    v_cvt_pk_bf16_f32 v212, v112, v113
    v_exp_f32 v116, v116
    v_exp_f32 v117, v117
    v_cvt_pk_bf16_f32 v213, v114, v115
    v_exp_f32 v118, v118
    v_exp_f32 v119, v119
    v_cvt_pk_bf16_f32 v214, v116, v117
    v_cvt_pk_bf16_f32 v215, v118, v119
    v_exp_f32 v120, v120
    v_exp_f32 v121, v121
    v_exp_f32 v122, v122
    s_waitcnt lgkmcnt(6)
    v_mfma_f32_32x32x16_bf16 v[192:207], v[224:227], v[208:211], 0
    buffer_load_dwordx4 v1, s[32:35], s65 offen offset:1024 sc1 lds
    s_add_u32 s64, s63, 4501504
    buffer_load_dwordx4 a[160:163], v26, s[32:35], s64 offen sc1
    v_exp_f32 v123, v123
    v_cvt_pk_bf16_f32 v216, v120, v121
    v_exp_f32 v124, v124
    v_exp_f32 v125, v125
    v_cvt_pk_bf16_f32 v217, v122, v123
    s_waitcnt lgkmcnt(4)
    v_mfma_f32_32x32x16_bf16 v[192:207], v[228:231], v[212:215], v[192:207]
    ds_read_b64_tr_b16 v[224:225], v17 offset:10240
    ds_read_b64_tr_b16 v[226:227], v17 offset:10752
    buffer_load_dwordx4 a[164:167], v27, s[32:35], s64 offen sc1
    s_add_u32 s63, 0, 3
    s_and_b32 s63, s63, 3
    s_mul_i32 s63, s63, 14336
    s_add_u32 s63, s63, s87
    s_add_u32 s64, s63, 4489216
    buffer_load_dwordx4 a[168:171], v26, s[32:35], s64 offen sc1
    v_exp_f32 v126, v126
    v_exp_f32 v127, v127
    v_cvt_pk_bf16_f32 v218, v124, v125
    v_exp_f32 v128, v128
    v_exp_f32 v129, v129
    v_mfma_f32_32x32x16_bf16 v[104:119], v[56:59], v[136:139], 0
    ds_read_b64_tr_b16 v[228:229], v17 offset:11264
    ds_read_b64_tr_b16 v[230:231], v17 offset:11776
    buffer_load_dwordx4 a[172:175], v27, s[32:35], s64 offen sc1
    v_cvt_pk_bf16_f32 v219, v126, v127
    v_exp_f32 v130, v130
    v_exp_f32 v131, v131
    v_cvt_pk_bf16_f32 v220, v128, v129
    v_exp_f32 v132, v132
    v_mfma_f32_32x32x16_bf16 v[104:119], v[60:63], v[140:143], v[104:119]
    buffer_load_dwordx4 v1, s[32:35], s65 offen offset:2048 sc1 lds
    s_add_u32 s64, s63, 4491264
    buffer_load_dwordx4 a[176:179], v26, s[32:35], s64 offen sc1
    buffer_load_dwordx4 a[180:183], v27, s[32:35], s64 offen sc1
    v_exp_f32 v133, v133
    v_cvt_pk_bf16_f32 v221, v130, v131
    v_exp_f32 v134, v134
    v_exp_f32 v135, v135
    v_cvt_pk_bf16_f32 v222, v132, v133
    v_cvt_pk_bf16_f32 v223, v134, v135
    v_exp_f32 v176, v176
    v_exp_f32 v177, v177
    v_exp_f32 v178, v178
    s_waitcnt lgkmcnt(6)
    v_mfma_f32_32x32x16_bf16 v[192:207], v[232:235], v[216:219], v[192:207]
    buffer_load_dwordx4 v1, s[32:35], s65 offen offset:3072 sc1 lds
    s_add_u32 s64, s63, 4493312
    buffer_load_dwordx4 a[184:187], v26, s[32:35], s64 offen sc1
    v_exp_f32 v179, v179
    v_cvt_pk_bf16_f32 v208, v176, v177
    v_exp_f32 v180, v180
    v_exp_f32 v181, v181
    v_cvt_pk_bf16_f32 v209, v178, v179
    s_waitcnt lgkmcnt(4)
    v_mfma_f32_32x32x16_bf16 v[192:207], v[236:239], v[220:223], v[192:207]
    ds_read_b64_tr_b16 v[232:233], v17 offset:14336
    ds_read_b64_tr_b16 v[234:235], v17 offset:14848
    buffer_load_dwordx4 a[188:191], v27, s[32:35], s64 offen sc1
    s_add_u32 s64, s63, 4495360
    buffer_load_dwordx4 a[192:195], v26, s[32:35], s64 offen sc1
    v_exp_f32 v182, v182
    v_exp_f32 v183, v183
    v_cvt_pk_bf16_f32 v210, v180, v181
    v_exp_f32 v184, v184
    v_exp_f32 v185, v185
    v_mfma_f32_32x32x16_bf16 v[120:135], v[64:67], v[136:139], 0
    ds_read_b64_tr_b16 v[236:237], v17 offset:15360
    ds_read_b64_tr_b16 v[238:239], v17 offset:15872
    buffer_load_dwordx4 a[196:199], v27, s[32:35], s64 offen sc1
    v_cvt_pk_bf16_f32 v211, v182, v183
    v_exp_f32 v186, v186
    v_exp_f32 v187, v187
    v_cvt_pk_bf16_f32 v212, v184, v185
    v_exp_f32 v188, v188
    v_mfma_f32_32x32x16_bf16 v[120:135], v[68:71], v[140:143], v[120:135]
    s_add_u32 m0, s73, 65536
    s_add_u32 s65, s72, 2433024
    buffer_load_dwordx4 v1, s[32:35], s65 offen offset:0 sc1 lds
    s_add_u32 s64, s63, 4497408
    buffer_load_dwordx4 a[200:203], v26, s[32:35], s64 offen sc1
    buffer_load_dwordx4 a[204:207], v27, s[32:35], s64 offen sc1
    v_exp_f32 v189, v189
    v_cvt_pk_bf16_f32 v213, v186, v187
    v_exp_f32 v190, v190
    v_exp_f32 v191, v191
    v_cvt_pk_bf16_f32 v214, v188, v189
    v_cvt_pk_bf16_f32 v215, v190, v191
    v_exp_f32 v104, v104
    v_exp_f32 v105, v105
    v_exp_f32 v106, v106
    s_waitcnt lgkmcnt(6)
    v_mfma_f32_32x32x16_bf16 v[192:207], v[224:227], v[208:211], v[192:207]
    buffer_load_dwordx4 v1, s[32:35], s65 offen offset:1024 sc1 lds
    s_add_u32 s64, s63, 4499456
    buffer_load_dwordx4 a[208:211], v26, s[32:35], s64 offen sc1
    v_exp_f32 v107, v107
    v_cvt_pk_bf16_f32 v216, v104, v105
    v_exp_f32 v108, v108
    v_exp_f32 v109, v109
    v_cvt_pk_bf16_f32 v217, v106, v107
    s_waitcnt lgkmcnt(4)
    v_mfma_f32_32x32x16_bf16 v[192:207], v[228:231], v[212:215], v[192:207]
    ds_read_b64_tr_b16 v[224:225], v17 offset:18432
    ds_read_b64_tr_b16 v[226:227], v17 offset:18944
    buffer_load_dwordx4 a[212:215], v27, s[32:35], s64 offen sc1
    s_add_u32 s64, s63, 4501504
    buffer_load_dwordx4 a[216:219], v26, s[32:35], s64 offen sc1
    v_exp_f32 v110, v110
    v_exp_f32 v111, v111
    v_cvt_pk_bf16_f32 v218, v108, v109
    v_exp_f32 v112, v112
    v_exp_f32 v113, v113
    v_mfma_f32_32x32x16_bf16 v[176:191], v[72:75], v[136:139], 0
    ds_read_b64_tr_b16 v[228:229], v17 offset:19456
    ds_read_b64_tr_b16 v[230:231], v17 offset:19968
    buffer_load_dwordx4 a[220:223], v27, s[32:35], s64 offen sc1
    v_cvt_pk_bf16_f32 v219, v110, v111
    v_exp_f32 v114, v114
    v_exp_f32 v115, v115
    v_cvt_pk_bf16_f32 v220, v112, v113
    v_exp_f32 v116, v116
    v_mfma_f32_32x32x16_bf16 v[176:191], v[76:79], v[140:143], v[176:191]
    buffer_load_dwordx4 v1, s[32:35], s65 offen offset:2048 sc1 lds
    v_exp_f32 v117, v117
    v_cvt_pk_bf16_f32 v221, v114, v115
    v_exp_f32 v118, v118
    v_exp_f32 v119, v119
    v_cvt_pk_bf16_f32 v222, v116, v117
    v_cvt_pk_bf16_f32 v223, v118, v119
    v_exp_f32 v120, v120
    v_exp_f32 v121, v121
    v_exp_f32 v122, v122
    s_waitcnt lgkmcnt(6)
    v_mfma_f32_32x32x16_bf16 v[192:207], v[232:235], v[216:219], v[192:207]
    buffer_load_dwordx4 v1, s[32:35], s65 offen offset:3072 sc1 lds
    v_exp_f32 v123, v123
    v_cvt_pk_bf16_f32 v208, v120, v121
    v_exp_f32 v124, v124
    v_exp_f32 v125, v125
    v_cvt_pk_bf16_f32 v209, v122, v123
    s_waitcnt lgkmcnt(4)
    v_mfma_f32_32x32x16_bf16 v[192:207], v[236:239], v[220:223], v[192:207]
    ds_read_b64_tr_b16 v[232:233], v17 offset:22528
    ds_read_b64_tr_b16 v[234:235], v17 offset:23040
    v_exp_f32 v126, v126
    v_exp_f32 v127, v127
    v_cvt_pk_bf16_f32 v210, v124, v125
    v_exp_f32 v128, v128
    v_exp_f32 v129, v129
    v_mfma_f32_32x32x16_bf16 v[104:119], v[80:83], v[136:139], 0
    ds_read_b64_tr_b16 v[236:237], v17 offset:23552
    ds_read_b64_tr_b16 v[238:239], v17 offset:24064
    v_cvt_pk_bf16_f32 v211, v126, v127
    v_exp_f32 v130, v130
    v_exp_f32 v131, v131
    v_cvt_pk_bf16_f32 v212, v128, v129
    v_exp_f32 v132, v132
    v_mfma_f32_32x32x16_bf16 v[104:119], v[84:87], v[140:143], v[104:119]
    s_add_u32 m0, s73, 69632
    s_add_u32 s65, s72, 2437120
    buffer_load_dwordx4 v1, s[32:35], s65 offen offset:0 sc1 lds
    v_exp_f32 v133, v133
    v_cvt_pk_bf16_f32 v213, v130, v131
    v_exp_f32 v134, v134
    v_exp_f32 v135, v135
    v_cvt_pk_bf16_f32 v214, v132, v133
    v_cvt_pk_bf16_f32 v215, v134, v135
    v_exp_f32 v176, v176
    v_exp_f32 v177, v177
    v_exp_f32 v178, v178
    s_waitcnt lgkmcnt(6)
    v_mfma_f32_32x32x16_bf16 v[192:207], v[224:227], v[208:211], v[192:207]
    s_sub_u32 s72, s72, s73
    s_lshl_b32 s73, s59, 10
    s_add_u32 s72, s72, s73
    s_add_u32 m0, s73, 110592
    s_add_u32 s65, s72, 2478080
    buffer_load_dwordx4 v1, s[32:35], s65 offen offset:0 sc1 lds
    v_exp_f32 v179, v179
    v_cvt_pk_bf16_f32 v216, v176, v177
    v_exp_f32 v180, v180
    v_exp_f32 v181, v181
    v_cvt_pk_bf16_f32 v217, v178, v179
    s_waitcnt lgkmcnt(4)
    v_mfma_f32_32x32x16_bf16 v[192:207], v[228:231], v[212:215], v[192:207]
    ds_read_b64_tr_b16 v[224:225], v17 offset:26624
    ds_read_b64_tr_b16 v[226:227], v17 offset:27136
    v_exp_f32 v182, v182
    v_exp_f32 v183, v183
    v_cvt_pk_bf16_f32 v218, v180, v181
    v_exp_f32 v184, v184
    v_exp_f32 v185, v185
    v_mfma_f32_32x32x16_bf16 v[120:135], v[88:91], v[136:139], 0
    ds_read_b64_tr_b16 v[228:229], v17 offset:27648
    ds_read_b64_tr_b16 v[230:231], v17 offset:28160
    v_cvt_pk_bf16_f32 v219, v182, v183
    v_exp_f32 v186, v186
    v_exp_f32 v187, v187
    v_cvt_pk_bf16_f32 v220, v184, v185
    v_exp_f32 v188, v188
    v_mfma_f32_32x32x16_bf16 v[120:135], v[92:95], v[140:143], v[120:135]
    v_exp_f32 v189, v189
    v_cvt_pk_bf16_f32 v221, v186, v187
    v_exp_f32 v190, v190
    v_exp_f32 v191, v191
    v_cvt_pk_bf16_f32 v222, v188, v189
    v_cvt_pk_bf16_f32 v223, v190, v191
    v_exp_f32 v104, v104
    v_exp_f32 v105, v105
    v_exp_f32 v106, v106
    s_waitcnt lgkmcnt(6)
    v_mfma_f32_32x32x16_bf16 v[192:207], v[232:235], v[216:219], v[192:207]
    v_exp_f32 v107, v107
    v_cvt_pk_bf16_f32 v208, v104, v105
    v_exp_f32 v108, v108
    v_exp_f32 v109, v109
    v_cvt_pk_bf16_f32 v209, v106, v107
    s_waitcnt lgkmcnt(4)
    v_mfma_f32_32x32x16_bf16 v[192:207], v[236:239], v[220:223], v[192:207]
    ds_read_b64_tr_b16 v[232:233], v17 offset:30720
    ds_read_b64_tr_b16 v[234:235], v17 offset:31232
    v_exp_f32 v110, v110
    v_exp_f32 v111, v111
    v_cvt_pk_bf16_f32 v210, v108, v109
    v_exp_f32 v112, v112
    v_exp_f32 v113, v113
    v_mfma_f32_32x32x16_bf16 v[176:191], v[96:99], v[136:139], v[160:175]
    ds_read_b64_tr_b16 v[236:237], v17 offset:31744
    ds_read_b64_tr_b16 v[238:239], v17 offset:32256
    v_cvt_pk_bf16_f32 v211, v110, v111
    v_exp_f32 v114, v114
    v_exp_f32 v115, v115
    v_cvt_pk_bf16_f32 v212, v112, v113
    v_exp_f32 v116, v116
    v_mfma_f32_32x32x16_bf16 v[176:191], v[100:103], v[140:143], v[176:191]
    v_exp_f32 v117, v117
    v_cvt_pk_bf16_f32 v213, v114, v115
    v_exp_f32 v118, v118
    v_exp_f32 v119, v119
    v_cvt_pk_bf16_f32 v214, v116, v117
    v_cvt_pk_bf16_f32 v215, v118, v119
    v_exp_f32 v120, v120
    v_exp_f32 v121, v121
    v_exp_f32 v122, v122
    s_waitcnt lgkmcnt(6)
    v_mfma_f32_32x32x16_bf16 v[192:207], v[224:227], v[208:211], v[192:207]
    buffer_load_dwordx4 v[32:35], v24, s[32:35], s82 offen offset:0 sc1
    buffer_load_dwordx4 v[36:39], v25, s[32:35], s82 offen offset:0 sc1
    buffer_load_dwordx4 v[40:43], v24, s[32:35], s82 offen offset:2048 sc1
    buffer_load_dwordx4 v[44:47], v25, s[32:35], s82 offen offset:2048 sc1
    v_exp_f32 v123, v123
    v_cvt_pk_bf16_f32 v216, v120, v121
    v_exp_f32 v124, v124
    v_exp_f32 v125, v125
    v_cvt_pk_bf16_f32 v217, v122, v123
    s_waitcnt lgkmcnt(4)
    v_mfma_f32_32x32x16_bf16 v[192:207], v[228:231], v[212:215], v[192:207]
    ds_read_b64_tr_b16 v[224:225], v17 offset:34816
    ds_read_b64_tr_b16 v[226:227], v17 offset:35328
    buffer_load_dwordx4 v[48:51], v24, s[32:35], s83 offen offset:0 sc1
    buffer_load_dwordx4 v[52:55], v25, s[32:35], s83 offen offset:0 sc1
    buffer_load_dwordx4 v[56:59], v24, s[32:35], s83 offen offset:2048 sc1
    buffer_load_dwordx4 v[60:63], v25, s[32:35], s83 offen offset:2048 sc1
    v_exp_f32 v126, v126
    v_exp_f32 v127, v127
    v_cvt_pk_bf16_f32 v218, v124, v125
    v_exp_f32 v128, v128
    v_exp_f32 v129, v129
    v_cvt_pk_bf16_f32 v219, v126, v127
    v_exp_f32 v130, v130
    v_exp_f32 v131, v131
    v_cvt_pk_bf16_f32 v220, v128, v129
    v_exp_f32 v132, v132
    v_exp_f32 v133, v133
    v_cvt_pk_bf16_f32 v221, v130, v131
    v_exp_f32 v134, v134
    ds_read_b64_tr_b16 v[228:229], v17 offset:35840
    ds_read_b64_tr_b16 v[230:231], v17 offset:36352
    v_exp_f32 v135, v135
    v_cvt_pk_bf16_f32 v222, v132, v133
    v_cvt_pk_bf16_f32 v223, v134, v135
    v_exp_f32 v176, v176
    v_exp_f32 v177, v177
    v_exp_f32 v178, v178
    s_waitcnt lgkmcnt(6)
    v_mfma_f32_32x32x16_bf16 v[192:207], v[232:235], v[216:219], v[192:207]
    buffer_load_dwordx4 v[64:67], v24, s[32:35], s84 offen offset:0 sc1
    buffer_load_dwordx4 v[68:71], v25, s[32:35], s84 offen offset:0 sc1
    buffer_load_dwordx4 v[72:75], v24, s[32:35], s84 offen offset:2048 sc1
    buffer_load_dwordx4 v[76:79], v25, s[32:35], s84 offen offset:2048 sc1
    v_exp_f32 v179, v179
    v_cvt_pk_bf16_f32 v208, v176, v177
    v_exp_f32 v180, v180
    v_exp_f32 v181, v181
    v_cvt_pk_bf16_f32 v209, v178, v179
    s_waitcnt lgkmcnt(4)
    v_mfma_f32_32x32x16_bf16 v[192:207], v[236:239], v[220:223], v[192:207]
    buffer_load_dwordx4 v[80:83], v24, s[32:35], s85 offen offset:0 sc1
    buffer_load_dwordx4 v[84:87], v25, s[32:35], s85 offen offset:0 sc1
    buffer_load_dwordx4 v[88:91], v24, s[32:35], s85 offen offset:2048 sc1
    buffer_load_dwordx4 v[92:95], v25, s[32:35], s85 offen offset:2048 sc1
    v_exp_f32 v182, v182
    v_exp_f32 v183, v183
    v_cvt_pk_bf16_f32 v210, v180, v181
    v_exp_f32 v184, v184
    v_exp_f32 v185, v185
    v_cvt_pk_bf16_f32 v211, v182, v183
    v_exp_f32 v186, v186
    v_exp_f32 v187, v187
    v_cvt_pk_bf16_f32 v212, v184, v185
    v_exp_f32 v188, v188
    v_exp_f32 v189, v189
    v_cvt_pk_bf16_f32 v213, v186, v187
    v_exp_f32 v190, v190
    v_exp_f32 v191, v191
    v_cvt_pk_bf16_f32 v214, v188, v189
    v_cvt_pk_bf16_f32 v215, v190, v191
    s_waitcnt lgkmcnt(2)
    v_mfma_f32_32x32x16_bf16 v[192:207], v[224:227], v[208:211], v[192:207]
    s_waitcnt lgkmcnt(0)
    v_mfma_f32_32x32x16_bf16 v[192:207], v[228:231], v[212:215], v[192:207]
    s_nop 11
    v_mov_b32 v20, v204
    v_mov_b32 v21, v204
    s_nop 1
    v_permlane32_swap_b32 v20, v21
    v_rcp_f32 v21, v21
    s_nop 0
    v_pk_mul_f32 v[192:193], v[192:193], v[20:21] op_sel:[0,1] op_sel_hi:[1,1]
    v_cvt_pk_bf16_f32 v208, v192, v193
    v_pk_mul_f32 v[194:195], v[194:195], v[20:21] op_sel:[0,1] op_sel_hi:[1,1]
    v_cvt_pk_bf16_f32 v209, v194, v195
    v_pk_mul_f32 v[196:197], v[196:197], v[20:21] op_sel:[0,1] op_sel_hi:[1,1]
    v_cvt_pk_bf16_f32 v210, v196, v197
    v_pk_mul_f32 v[198:199], v[198:199], v[20:21] op_sel:[0,1] op_sel_hi:[1,1]
    v_cvt_pk_bf16_f32 v211, v198, v199
    buffer_store_dwordx4 v[208:211], v1, s[32:35], s80 offen offset:0
    v_pk_mul_f32 v[200:201], v[200:201], v[20:21] op_sel:[0,1] op_sel_hi:[1,1]
    v_cvt_pk_bf16_f32 v212, v200, v201
    v_pk_mul_f32 v[202:203], v[202:203], v[20:21] op_sel:[0,1] op_sel_hi:[1,1]
    v_cvt_pk_bf16_f32 v213, v202, v203
    v_pk_mul_f32 v[204:205], v[204:205], v[20:21] op_sel:[0,1] op_sel_hi:[1,1]
    v_cvt_pk_bf16_f32 v214, v204, v205
    v_pk_mul_f32 v[206:207], v[206:207], v[20:21] op_sel:[0,1] op_sel_hi:[1,1]
    v_cvt_pk_bf16_f32 v215, v206, v207
    buffer_store_dwordx4 v[212:215], v1, s[32:35], s80 offen offset:1024
    s_waitcnt vmcnt(0)
    s_mov_b64 exec, 1
    s_cmp_lg_u32 s50, 0
    s_cbranch_scc0 L_pubslow_29
    buffer_store_dwordx2 v[12:13], off, s[32:35], s81 offset:0
L_pubback_30:
    s_mov_b64 exec, -1
    s_branch L_padskip4
L_pad4:
    s_setpc_b64 s[98:99]
L_padskip4:
    s_barrier
    s_cmp_ge_u32 s41, 28
    s_cbranch_scc1 L_p3idle_32
    s_lshl_b32 s60, s45, 3
    s_add_u32 s60, s60, s44
    s_mul_i32 s80, s60, 32
    s_add_u32 s80, s80, s47
    s_add_u32 s80, s80, 1327104
    s_mov_b64 exec, 0xff
    buffer_load_dwordx2 v[30:31], v5, s[32:35], s80 offen offset:0 sc1
    s_mov_b64 exec, -1
    s_xor_b32 s60, s58, 0
    s_lshl_b32 s61, s45, 1
    s_add_u32 s60, s60, s61
    s_lshl_b32 s60, s60, 2
    s_add_u32 s60, s60, s44
    s_cmp_lg_u32 s50, 0
    s_cselect_b32 s63, s71, s47
    s_mul_i32 s82, s60, 8192
    s_add_u32 s82, s82, s63
    s_add_u32 s82, s82, 524288
    s_xor_b32 s60, s58, 1
    s_lshl_b32 s61, s45, 1
    s_add_u32 s60, s60, s61
    s_lshl_b32 s60, s60, 2
    s_add_u32 s60, s60, s44
    s_cmp_lg_u32 s50, 0
    s_cselect_b32 s63, s71, s47
    s_mul_i32 s83, s60, 8192
    s_add_u32 s83, s83, s63
    s_add_u32 s83, s83, 524288
    s_add_u32 s84, s82, 4096
    s_add_u32 s85, s83, 4096
    s_mov_b64 exec, 0xff
    s_mov_b32 s66, 0
L_poll_33:
    buffer_load_dwordx2 v[236:237], v5, s[32:35], s80 offen sc1
    s_add_u32 s66, s66, 1
    s_cmp_gt_u32 s66, 65536
    s_cbranch_scc1 L_pollout_34
    s_waitcnt vmcnt(1)
    v_cmp_ne_u64 vcc, s[48:49], v[30:31]
    s_nop 0
    s_cbranch_vccz L_pollout_34
    buffer_load_dwordx2 v[30:31], v5, s[32:35], s80 offen sc1
    s_waitcnt vmcnt(1)
    v_cmp_ne_u64 vcc, s[48:49], v[236:237]
    s_nop 0
    s_cbranch_vccnz L_poll_33
L_pollout_34:
    s_mov_b64 exec, -1
    s_cmp_lg_u32 s50, 0
    s_cbranch_scc0 L_acq_35
L_acqback_36:
    buffer_load_dwordx4 v[96:99], v1, s[32:35], s82 offen offset:0 sc1
    buffer_load_dwordx4 v[100:103], v1, s[32:35], s83 offen offset:0 sc1
    buffer_load_dwordx4 v[104:107], v1, s[32:35], s82 offen offset:1024 sc1
    buffer_load_dwordx4 v[108:111], v1, s[32:35], s83 offen offset:1024 sc1
    buffer_load_dwordx4 v[112:115], v1, s[32:35], s82 offen offset:2048 sc1
    buffer_load_dwordx4 v[116:119], v1, s[32:35], s83 offen offset:2048 sc1
    buffer_load_dwordx4 v[120:123], v1, s[32:35], s82 offen offset:3072 sc1
    buffer_load_dwordx4 v[124:127], v1, s[32:35], s83 offen offset:3072 sc1
    buffer_load_dwordx4 v[128:131], v1, s[32:35], s84 offen offset:0 sc1
    buffer_load_dwordx4 v[132:135], v1, s[32:35], s85 offen offset:0 sc1
    s_waitcnt vmcnt(9)
    v_mfma_f32_32x32x16_bf16 v[176:191], v[36:39], v[96:99], 0
    buffer_load_dwordx4 v[136:139], v1, s[32:35], s84 offen offset:1024 sc1
    s_waitcnt vmcnt(9)
    v_mfma_f32_32x32x16_bf16 v[192:207], v[32:35], v[100:103], 0
    buffer_load_dwordx4 v[140:143], v1, s[32:35], s85 offen offset:1024 sc1
    v_mfma_f32_32x32x16_bf16 v[208:223], v[36:39], v[100:103], 0
    s_waitcnt vmcnt(9)
    v_mfma_f32_32x32x16_bf16 v[176:191], v[44:47], v[104:107], v[176:191]
    buffer_load_dwordx4 v[144:147], v1, s[32:35], s84 offen offset:2048 sc1
    s_waitcnt vmcnt(9)
    v_mfma_f32_32x32x16_bf16 v[192:207], v[40:43], v[108:111], v[192:207]
    buffer_load_dwordx4 v[148:151], v1, s[32:35], s85 offen offset:2048 sc1
    v_mfma_f32_32x32x16_bf16 v[208:223], v[44:47], v[108:111], v[208:223]
    s_waitcnt vmcnt(9)
    v_mfma_f32_32x32x16_bf16 v[176:191], v[52:55], v[112:115], v[176:191]
    buffer_load_dwordx4 v[152:155], v1, s[32:35], s84 offen offset:3072 sc1
    s_waitcnt vmcnt(9)
    v_mfma_f32_32x32x16_bf16 v[192:207], v[48:51], v[116:119], v[192:207]
    buffer_load_dwordx4 v[156:159], v1, s[32:35], s85 offen offset:3072 sc1
    v_mfma_f32_32x32x16_bf16 v[208:223], v[52:55], v[116:119], v[208:223]
    s_waitcnt vmcnt(9)
    v_mfma_f32_32x32x16_bf16 v[176:191], v[60:63], v[120:123], v[176:191]
    s_waitcnt vmcnt(8)
    v_mfma_f32_32x32x16_bf16 v[192:207], v[56:59], v[124:127], v[192:207]
    v_mfma_f32_32x32x16_bf16 v[208:223], v[60:63], v[124:127], v[208:223]
    s_waitcnt vmcnt(7)
    v_mfma_f32_32x32x16_bf16 v[176:191], v[68:71], v[128:131], v[176:191]
    s_waitcnt vmcnt(6)
    v_mfma_f32_32x32x16_bf16 v[192:207], v[64:67], v[132:135], v[192:207]
    v_mfma_f32_32x32x16_bf16 v[208:223], v[68:71], v[132:135], v[208:223]
    s_waitcnt vmcnt(5)
    v_mfma_f32_32x32x16_bf16 v[176:191], v[76:79], v[136:139], v[176:191]
    s_waitcnt vmcnt(4)
    v_mfma_f32_32x32x16_bf16 v[192:207], v[72:75], v[140:143], v[192:207]
    v_mfma_f32_32x32x16_bf16 v[208:223], v[76:79], v[140:143], v[208:223]
    s_waitcnt vmcnt(3)
    v_mfma_f32_32x32x16_bf16 v[176:191], v[84:87], v[144:147], v[176:191]
    s_waitcnt vmcnt(2)
    v_mfma_f32_32x32x16_bf16 v[192:207], v[80:83], v[148:151], v[192:207]
    v_mfma_f32_32x32x16_bf16 v[208:223], v[84:87], v[148:151], v[208:223]
    s_waitcnt vmcnt(1)
    v_mfma_f32_32x32x16_bf16 v[176:191], v[92:95], v[152:155], v[176:191]
    s_waitcnt vmcnt(0)
    v_mfma_f32_32x32x16_bf16 v[192:207], v[88:91], v[156:159], v[192:207]
    v_mfma_f32_32x32x16_bf16 v[208:223], v[92:95], v[156:159], v[208:223]
    v_mfma_f32_32x32x16_bf16 v[160:175], v[32:35], v[96:99], v[240:255]
    v_mfma_f32_32x32x16_bf16 v[160:175], v[40:43], v[104:107], v[160:175]
    v_mfma_f32_32x32x16_bf16 v[160:175], v[48:51], v[112:115], v[160:175]
    s_nop 5
    ds_write_b128 v6, v[176:179] offset:0
    ds_write_b128 v6, v[180:183] offset:1024
    v_mfma_f32_32x32x16_bf16 v[160:175], v[56:59], v[120:123], v[160:175]
    ds_write_b128 v6, v[184:187] offset:2048
    ds_write_b128 v6, v[188:191] offset:3072
    v_mfma_f32_32x32x16_bf16 v[160:175], v[64:67], v[128:131], v[160:175]
    ds_write_b128 v7, v[192:195] offset:0
    ds_write_b128 v7, v[196:199] offset:1024
    v_mfma_f32_32x32x16_bf16 v[160:175], v[72:75], v[136:139], v[160:175]
    ds_write_b128 v7, v[200:203] offset:2048
    ds_write_b128 v7, v[204:207] offset:3072
    v_mfma_f32_32x32x16_bf16 v[160:175], v[80:83], v[144:147], v[160:175]
    ds_write_b128 v8, v[208:211] offset:0
    ds_write_b128 v8, v[212:215] offset:1024
    v_mfma_f32_32x32x16_bf16 v[160:175], v[88:91], v[152:155], v[160:175]
    ds_write_b128 v8, v[216:219] offset:2048
    ds_write_b128 v8, v[220:223] offset:3072
    s_waitcnt lgkmcnt(0)
    s_branch L_padskip5
L_pad5:
    s_setpc_b64 s[98:99]
L_padskip5:
    s_barrier
    ds_read_b128 v[32:35], v9 offset:0
    ds_read_b128 v[48:51], v9 offset:4096
    ds_read_b128 v[64:67], v9 offset:8192
    ds_read_b128 v[36:39], v9 offset:1024
    ds_read_b128 v[52:55], v9 offset:5120
    ds_read_b128 v[68:71], v9 offset:9216
    ds_read_b128 v[40:43], v9 offset:2048
    ds_read_b128 v[56:59], v9 offset:6144
    ds_read_b128 v[72:75], v9 offset:10240
    ds_read_b128 v[44:47], v9 offset:3072
    ds_read_b128 v[60:63], v9 offset:7168
    ds_read_b128 v[76:79], v9 offset:11264
    s_waitcnt lgkmcnt(10)
    v_pk_add_f32 v[32:33], v[32:33], v[48:49]
    s_waitcnt lgkmcnt(9)
    v_pk_add_f32 v[160:161], v[160:161], v[64:65]
    v_pk_add_f32 v[160:161], v[160:161], v[32:33]
    v_pk_add_f32 v[34:35], v[34:35], v[50:51]
    v_pk_add_f32 v[162:163], v[162:163], v[66:67]
    v_pk_add_f32 v[162:163], v[162:163], v[34:35]
    s_waitcnt lgkmcnt(7)
    v_pk_add_f32 v[36:37], v[36:37], v[52:53]
    s_waitcnt lgkmcnt(6)
    v_pk_add_f32 v[164:165], v[164:165], v[68:69]
    v_pk_add_f32 v[164:165], v[164:165], v[36:37]
    v_pk_add_f32 v[38:39], v[38:39], v[54:55]
    v_pk_add_f32 v[166:167], v[166:167], v[70:71]
    v_pk_add_f32 v[166:167], v[166:167], v[38:39]
    s_waitcnt lgkmcnt(4)
    v_pk_add_f32 v[40:41], v[40:41], v[56:57]
    s_waitcnt lgkmcnt(3)
    v_pk_add_f32 v[168:169], v[168:169], v[72:73]
    v_pk_add_f32 v[168:169], v[168:169], v[40:41]
    v_pk_add_f32 v[42:43], v[42:43], v[58:59]
    v_pk_add_f32 v[170:171], v[170:171], v[74:75]
    v_pk_add_f32 v[170:171], v[170:171], v[42:43]
    s_waitcnt lgkmcnt(1)
    v_pk_add_f32 v[44:45], v[44:45], v[60:61]
    s_waitcnt lgkmcnt(0)
    v_pk_add_f32 v[172:173], v[172:173], v[76:77]
    v_pk_add_f32 v[172:173], v[172:173], v[44:45]
    v_pk_add_f32 v[46:47], v[46:47], v[62:63]
    v_pk_add_f32 v[174:175], v[174:175], v[78:79]
    v_pk_add_f32 v[174:175], v[174:175], v[46:47]
    v_cvt_pk_bf16_f32 v96, v160, v161
    v_cvt_pk_bf16_f32 v97, v162, v163
    v_cvt_pk_bf16_f32 v98, v164, v165
    v_cvt_pk_bf16_f32 v99, v166, v167
    v_cvt_pk_bf16_f32 v100, v168, v169
    v_cvt_pk_bf16_f32 v101, v170, v171
    v_cvt_pk_bf16_f32 v102, v172, v173
    v_cvt_pk_bf16_f32 v103, v174, v175
    buffer_store_dwordx4 v[96:99], v10, s[32:35], s68 offen offset:0
    buffer_store_dwordx4 v[100:103], v10, s[32:35], s68 offen offset:512
    v_mov_b32 v24, s57
    v_dot2_f32_bf16 v22, v96, v24, 0
    v_dot2_f32_bf16 v23, v96, v96, 0
    v_dot2_f32_bf16 v22, v97, v24, v22
    v_dot2_f32_bf16 v23, v97, v97, v23
    v_dot2_f32_bf16 v22, v98, v24, v22
    v_dot2_f32_bf16 v23, v98, v98, v23
    v_dot2_f32_bf16 v22, v99, v24, v22
    v_dot2_f32_bf16 v23, v99, v99, v23
    v_dot2_f32_bf16 v22, v100, v24, v22
    v_dot2_f32_bf16 v23, v100, v100, v23
    v_dot2_f32_bf16 v22, v101, v24, v22
    v_dot2_f32_bf16 v23, v101, v101, v23
    v_dot2_f32_bf16 v22, v102, v24, v22
    v_dot2_f32_bf16 v23, v102, v102, v23
    v_dot2_f32_bf16 v22, v103, v24, v22
    v_dot2_f32_bf16 v23, v103, v103, v23
    s_nop 1
    v_mov_b32 v24, v22
    v_mov_b32 v25, v23
    s_nop 0
    v_permlane32_swap_b32 v22, v24
    v_permlane32_swap_b32 v23, v25
    v_add_f32 v22, v22, v24
    v_add_f32 v23, v23, v25
    s_mov_b32 exec_hi, 0
    buffer_store_dwordx2 v[22:23], v3, s[32:35], s69 offen
    s_mov_b64 exec, -1
    s_waitcnt vmcnt(0)
    s_mov_b64 exec, 1
    s_cmp_lg_u32 s50, 0
    s_cbranch_scc0 L_pubslow_37
    buffer_store_dwordx2 v[12:13], off, s[32:35], s70 offset:0
L_pubback_38:
    s_mov_b64 exec, -1
    v_lshlrev_b32 v240, 16, v96
    v_and_b32 v241, 0xffff0000, v96
    v_lshlrev_b32 v242, 16, v97
    v_and_b32 v243, 0xffff0000, v97
    v_lshlrev_b32 v244, 16, v98
    v_and_b32 v245, 0xffff0000, v98
    v_lshlrev_b32 v246, 16, v99
    v_and_b32 v247, 0xffff0000, v99
    v_lshlrev_b32 v248, 16, v100
    v_and_b32 v249, 0xffff0000, v100
    v_lshlrev_b32 v250, 16, v101
    v_and_b32 v251, 0xffff0000, v101
    v_lshlrev_b32 v252, 16, v102
    v_and_b32 v253, 0xffff0000, v102
    v_lshlrev_b32 v254, 16, v103
    v_and_b32 v255, 0xffff0000, v103
L_p3join_31:
    s_barrier
    s_mul_i32 s72, s43, 100352
    s_mul_i32 s73, s44, 11264
    s_add_u32 s72, s72, s73
    s_add_u32 m0, s73, 112640
    s_add_u32 s65, s72, 2480128
    buffer_load_dwordx4 v1, s[32:35], s65 offen offset:0 sc1 lds
    buffer_load_dwordx4 v1, s[32:35], s65 offen offset:1024 sc1 lds
    buffer_load_dwordx4 v1, s[32:35], s65 offen offset:2048 sc1 lds
    buffer_load_dwordx4 v1, s[32:35], s65 offen offset:3072 sc1 lds
    s_add_u32 m0, s73, 116736
    s_add_u32 s65, s72, 2484224
    buffer_load_dwordx4 v1, s[32:35], s65 offen offset:0 sc1 lds
    buffer_load_dwordx4 v1, s[32:35], s65 offen offset:1024 sc1 lds
    buffer_load_dwordx4 v1, s[32:35], s65 offen offset:2048 sc1 lds
    buffer_load_dwordx4 v1, s[32:35], s65 offen offset:3072 sc1 lds
    s_add_u32 m0, s73, 120832
    s_add_u32 s65, s72, 2488320
    buffer_load_dwordx4 v1, s[32:35], s65 offen offset:0 sc1 lds
    buffer_load_dwordx4 v1, s[32:35], s65 offen offset:1024 sc1 lds
    buffer_load_dwordx4 v1, s[32:35], s65 offen offset:2048 sc1 lds
    s_mul_i32 s85, s52, 128
    s_add_u32 s85, s85, s47
    s_add_u32 s85, s85, 1328128
    s_mov_b64 exec, 0x3fff
    buffer_load_dwordx2 v[30:31], v3, s[32:35], s85 offen offset:0 sc1
    s_mov_b64 exec, -1
    s_add_u32 s63, s47, 786432
    s_add_u32 s64, s71, 1015808
    s_cmp_lg_u32 s50, 0
    s_cselect_b32 s63, s64, s63
    s_mul_i32 s80, s52, 28672
    s_add_u32 s80, s80, s63
    s_add_u32 s81, s80, 8192
    s_add_u32 s82, s80, 16384
    s_add_u32 s83, s80, 24576
    s_mul_i32 s84, s52, 3584
    s_add_u32 s84, s84, s47
    s_add_u32 s84, s84, 1245184
    s_lshl_b32 s60, s52, 4
    s_add_u32 s60, s60, s43
    s_mul_i32 s86, s60, 7168
    s_add_u32 s86, s86, s47
    s_add_u32 s86, s86, 1376256
    s_add_u32 s87, s86, 4096
    s_mul_i32 s88, s60, 8
    s_add_u32 s88, s88, s47
    s_add_u32 s88, s88, 1331200
    v_lshrrev_b32 v11, 4, v0
    v_lshlrev_b32 v11, 4, v11
    v_add_u32 v11, 162304, v11
    v_lshrrev_b32 v17, 5, v0
    v_lshlrev_b32 v17, 10, v17
    v_bfe_u32 v18, v0, 4, 1
    v_lshl_add_u32 v17, v18, 9, v17
    v_and_b32 v16, 15, v0
    v_lshl_add_u32 v17, v16, 4, v17
    v_lshlrev_b32 v18, 3, v18
    v_lshl_add_u32 v18, v16, 4, v18
    v_lshrrev_b32 v16, 5, v0
    v_lshl_add_u32 v18, v16, 9, v18
    v_add_u32 v28, 4096, v1
    v_add_u32 v19, 57344, v2
    s_min_u32 s72, s45, 3
    s_lshl_b32 s60, s72, 3
    s_add_u32 s60, s60, s44
    s_mul_i32 s89, s60, 32
    s_add_u32 s89, s89, s47
    s_add_u32 s89, s89, 1331200
    s_xor_b32 s60, s58, 0
    s_lshl_b32 s61, s72, 1
    s_add_u32 s60, s60, s61
    s_lshl_b32 s60, s60, 2
    s_add_u32 s60, s60, s44
    s_mul_i32 s62, s60, 28672
    s_add_u32 s62, s62, s47
    s_add_u32 s62, s62, 1376256
    s_add_u32 s60, 0, 0
    s_and_b32 s60, s60, 3
    s_mul_i32 s60, s60, 7168
    s_add_u32 s76, s62, s60
    s_add_u32 s60, 0, 1
    s_and_b32 s60, s60, 3
    s_mul_i32 s60, s60, 7168
    s_add_u32 s78, s62, s60
    s_add_u32 s60, 0, 2
    s_and_b32 s60, s60, 3
    s_mul_i32 s60, s60, 7168
    s_add_u32 s92, s62, s60
    s_add_u32 s60, 0, 3
    s_and_b32 s60, s60, 3
    s_mul_i32 s60, s60, 7168
    s_add_u32 s94, s62, s60
    s_xor_b32 s60, s58, 1
    s_lshl_b32 s61, s72, 1
    s_add_u32 s60, s60, s61
    s_lshl_b32 s60, s60, 2
    s_add_u32 s60, s60, s44
    s_mul_i32 s62, s60, 28672
    s_add_u32 s62, s62, s47
    s_add_u32 s62, s62, 1376256
    s_add_u32 s60, 0, 0
    s_and_b32 s60, s60, 3
    s_mul_i32 s60, s60, 7168
    s_add_u32 s77, s62, s60
    s_add_u32 s60, 0, 1
    s_and_b32 s60, s60, 3
    s_mul_i32 s60, s60, 7168
    s_add_u32 s79, s62, s60
    s_add_u32 s60, 0, 2
    s_and_b32 s60, s60, 3
    s_mul_i32 s60, s60, 7168
    s_add_u32 s93, s62, s60
    s_add_u32 s60, 0, 3
    s_and_b32 s60, s60, 3
    s_mul_i32 s60, s60, 7168
    s_add_u32 s95, s62, s60
    s_lshl_b32 s60, s72, 1
    s_add_u32 s60, s60, s58
    s_mul_i32 s90, s60, 3584
    s_add_u32 s90, s90, s47
    s_add_u32 s90, s90, 1245184
    s_lshl_b32 s60, s45, 1
    s_add_u32 s60, s60, s58
    s_lshl_b32 s61, s46, 1
    s_add_u32 s61, s61, s59
    s_mul_i32 s62, s60, 14
    s_add_u32 s62, s62, s61
    s_add_u32 s63, s47, 3309568
    s_add_u32 s64, s71, 1015808
    s_cmp_lg_u32 s50, 0
    s_cselect_b32 s63, s64, s63
    s_mul_i32 s68, s62, 2048
    s_add_u32 s68, s68, s63
    s_mul_i32 s69, s62, 256
    s_add_u32 s69, s69, s47
    s_add_u32 s69, s69, 3571712
    s_lshl_b32 s60, s60, 4
    s_add_u32 s60, s60, s61
    s_mul_i32 s70, s60, 8
    s_add_u32 s70, s70, s47
    s_add_u32 s70, s70, 3622912
    s_cmp_ge_u32 s41, 28
    s_cselect_b32 s68, 4096, s68
    s_cselect_b32 s69, 4096, s69
    s_cselect_b32 s70, 4096, s70
    v_lshlrev_b32 v16, 7, v0
    ds_read_b128 v[200:203], v2 offset:0
    ds_read_b128 v[204:207], v2 offset:1024
    ds_read_b128 v[208:211], v2 offset:2048
    ds_read_b128 v[212:215], v2 offset:3072
    s_branch L_padskip6
L_pad6:
    s_setpc_b64 s[98:99]
L_padskip6:
    s_mov_b64 exec, 0x3fff
    s_mov_b32 s66, 0
L_poll_39:
    buffer_load_dwordx2 v[236:237], v3, s[32:35], s85 offen sc1
    s_add_u32 s66, s66, 1
    s_cmp_gt_u32 s66, 65536
    s_cbranch_scc1 L_pollout_40
    s_waitcnt vmcnt(1)
    v_cmp_ne_u64 vcc, s[48:49], v[30:31]
    s_nop 0
    s_cbranch_vccz L_pollout_40
    buffer_load_dwordx2 v[30:31], v3, s[32:35], s85 offen sc1
    s_waitcnt vmcnt(1)
    v_cmp_ne_u64 vcc, s[48:49], v[236:237]
    s_nop 0
    s_cbranch_vccnz L_poll_39
L_pollout_40:
    s_mov_b64 exec, -1
    s_cmp_lg_u32 s50, 0
    s_cbranch_scc0 L_acq_41
L_acqback_42:
    buffer_load_dwordx4 v[32:35], v1, s[32:35], s80 offen offset:0 sc1
    buffer_load_dwordx4 v[36:39], v1, s[32:35], s80 offen offset:1024 sc1
    buffer_load_dwordx4 v[40:43], v1, s[32:35], s80 offen offset:2048 sc1
    buffer_load_dwordx4 v[44:47], v1, s[32:35], s80 offen offset:3072 sc1
    buffer_load_dwordx4 v[48:51], v28, s[32:35], s80 offen offset:0 sc1
    buffer_load_dwordx4 v[52:55], v28, s[32:35], s80 offen offset:1024 sc1
    buffer_load_dwordx4 v[56:59], v28, s[32:35], s80 offen offset:2048 sc1
    buffer_load_dwordx4 v[60:63], v28, s[32:35], s80 offen offset:3072 sc1
    s_barrier
    v_mov_b32 v24, s57
    v_mov_b32 v25, s57
    v_mov_b32 v26, s57
    v_mov_b32 v27, s57
    s_lshl_b32 s60, s44, 10
    v_add_u32 v20, s60, v2
    ds_read_b128 v[180:183], v20 offset:0
    ds_read_b128 v[184:187], v20 offset:4096
    ds_read_b128 v[188:191], v20 offset:8192
    s_waitcnt lgkmcnt(2)
    v_mfma_f32_16x16x32_bf16 v[176:179], v[24:27], v[180:183], 0
    ds_read_b128 v[192:195], v20 offset:12288
    s_waitcnt lgkmcnt(2)
    v_mfma_f32_16x16x32_bf16 v[176:179], v[24:27], v[184:187], v[176:179]
    ds_read_b128 v[180:183], v20 offset:16384
    buffer_load_dwordx4 v[64:67], v1, s[32:35], s81 offen offset:0 sc1
    s_waitcnt lgkmcnt(2)
    v_mfma_f32_16x16x32_bf16 v[176:179], v[24:27], v[188:191], v[176:179]
    ds_read_b128 v[184:187], v20 offset:20480
    s_waitcnt lgkmcnt(2)
    v_mfma_f32_16x16x32_bf16 v[176:179], v[24:27], v[192:195], v[176:179]
    ds_read_b128 v[188:191], v20 offset:24576
    s_waitcnt lgkmcnt(2)
    v_mfma_f32_16x16x32_bf16 v[176:179], v[24:27], v[180:183], v[176:179]
    ds_read_b128 v[192:195], v20 offset:28672
    buffer_load_dwordx4 v[68:71], v1, s[32:35], s81 offen offset:1024 sc1
    s_waitcnt lgkmcnt(2)
    v_mfma_f32_16x16x32_bf16 v[176:179], v[24:27], v[184:187], v[176:179]
    ds_read_b128 v[180:183], v20 offset:32768
    s_waitcnt lgkmcnt(2)
    v_mfma_f32_16x16x32_bf16 v[176:179], v[24:27], v[188:191], v[176:179]
    ds_read_b128 v[184:187], v20 offset:36864
    s_waitcnt lgkmcnt(2)
    v_mfma_f32_16x16x32_bf16 v[176:179], v[24:27], v[192:195], v[176:179]
    ds_read_b128 v[188:191], v20 offset:40960
    buffer_load_dwordx4 v[72:75], v1, s[32:35], s81 offen offset:2048 sc1
    s_waitcnt lgkmcnt(2)
    v_mfma_f32_16x16x32_bf16 v[176:179], v[24:27], v[180:183], v[176:179]
    ds_read_b128 v[192:195], v20 offset:45056
    s_waitcnt lgkmcnt(2)
    v_mfma_f32_16x16x32_bf16 v[176:179], v[24:27], v[184:187], v[176:179]
    ds_read_b128 v[180:183], v20 offset:49152
    s_waitcnt lgkmcnt(2)
    v_mfma_f32_16x16x32_bf16 v[176:179], v[24:27], v[188:191], v[176:179]
    ds_read_b128 v[184:187], v20 offset:53248
    buffer_load_dwordx4 v[76:79], v1, s[32:35], s81 offen offset:3072 sc1
    s_waitcnt lgkmcnt(2)
    v_mfma_f32_16x16x32_bf16 v[176:179], v[24:27], v[192:195], v[176:179]
    s_waitcnt lgkmcnt(1)
    v_mfma_f32_16x16x32_bf16 v[176:179], v[24:27], v[180:183], v[176:179]
    s_waitcnt lgkmcnt(0)
    v_mfma_f32_16x16x32_bf16 v[176:179], v[24:27], v[184:187], v[176:179]
    buffer_load_dwordx4 v[80:83], v28, s[32:35], s81 offen offset:0 sc1
    s_lshl_b32 s60, s44, 6
    s_add_u32 s60, s60, 162304
    v_and_b32 v20, 15, v0
    v_lshlrev_b32 v20, 2, v20
    v_add_u32 v20, s60, v20
    s_nop 1
    ds_write_b32 v20, v176
    s_waitcnt lgkmcnt(0)
    v_mov_b32 v24, s57
    v_mov_b32 v25, s57
    v_mov_b32 v26, s57
    v_mov_b32 v27, s57
    s_lshl_b32 s60, s44, 10
    s_min_u32 s60, s60, 2048
    s_add_u32 s60, s60, 57344
    v_add_u32 v20, s60, v2
    ds_read_b128 v[180:183], v20 offset:0
    ds_read_b128 v[184:187], v20 offset:3072
    ds_read_b128 v[188:191], v20 offset:6144
    s_waitcnt lgkmcnt(2)
    v_mfma_f32_16x16x32_bf16 v[176:179], v[24:27], v[180:183], 0
    ds_read_b128 v[192:195], v20 offset:9216
    s_waitcnt lgkmcnt(2)
    v_mfma_f32_16x16x32_bf16 v[176:179], v[24:27], v[184:187], v[176:179]
    ds_read_b128 v[180:183], v20 offset:12288
    buffer_load_dwordx4 v[84:87], v28, s[32:35], s81 offen offset:1024 sc1
    s_waitcnt lgkmcnt(2)
    v_mfma_f32_16x16x32_bf16 v[176:179], v[24:27], v[188:191], v[176:179]
    ds_read_b128 v[184:187], v20 offset:15360
    s_waitcnt lgkmcnt(2)
    v_mfma_f32_16x16x32_bf16 v[176:179], v[24:27], v[192:195], v[176:179]
    ds_read_b128 v[188:191], v20 offset:18432
    s_waitcnt lgkmcnt(2)
    v_mfma_f32_16x16x32_bf16 v[176:179], v[24:27], v[180:183], v[176:179]
    ds_read_b128 v[192:195], v20 offset:21504
    buffer_load_dwordx4 v[88:91], v28, s[32:35], s81 offen offset:2048 sc1
    s_waitcnt lgkmcnt(2)
    v_mfma_f32_16x16x32_bf16 v[176:179], v[24:27], v[184:187], v[176:179]
    ds_read_b128 v[180:183], v20 offset:24576
    s_waitcnt lgkmcnt(2)
    v_mfma_f32_16x16x32_bf16 v[176:179], v[24:27], v[188:191], v[176:179]
    ds_read_b128 v[184:187], v20 offset:27648
    s_waitcnt lgkmcnt(2)
    v_mfma_f32_16x16x32_bf16 v[176:179], v[24:27], v[192:195], v[176:179]
    ds_read_b128 v[188:191], v20 offset:30720
    buffer_load_dwordx4 v[92:95], v28, s[32:35], s81 offen offset:3072 sc1
    s_waitcnt lgkmcnt(2)
    v_mfma_f32_16x16x32_bf16 v[176:179], v[24:27], v[180:183], v[176:179]
    ds_read_b128 v[192:195], v20 offset:33792
    s_waitcnt lgkmcnt(2)
    v_mfma_f32_16x16x32_bf16 v[176:179], v[24:27], v[184:187], v[176:179]
    ds_read_b128 v[180:183], v20 offset:36864
    s_waitcnt lgkmcnt(2)
    v_mfma_f32_16x16x32_bf16 v[176:179], v[24:27], v[188:191], v[176:179]
    ds_read_b128 v[184:187], v20 offset:39936
    buffer_load_dwordx4 v[96:99], v1, s[32:35], s82 offen offset:0 sc1
    s_waitcnt lgkmcnt(2)
    v_mfma_f32_16x16x32_bf16 v[176:179], v[24:27], v[192:195], v[176:179]
    s_waitcnt lgkmcnt(1)
    v_mfma_f32_16x16x32_bf16 v[176:179], v[24:27], v[180:183], v[176:179]
    s_waitcnt lgkmcnt(0)
    v_mfma_f32_16x16x32_bf16 v[176:179], v[24:27], v[184:187], v[176:179]
    buffer_load_dwordx4 v[100:103], v1, s[32:35], s82 offen offset:1024 sc1
    s_lshl_b32 s60, s44, 6
    s_add_u32 s60, s60, 162560
    v_and_b32 v20, 15, v0
    v_lshlrev_b32 v20, 2, v20
    v_add_u32 v20, s60, v20
    s_nop 1
    ds_write_b32 v20, v176
    s_waitcnt lgkmcnt(0)
    s_waitcnt vmcnt(16)
    v_mfma_f32_16x16x32_bf16 v[144:147], v[200:203], v[32:35], 0
    ds_read_b128 v[216:219], v2 offset:4096
    v_mfma_f32_16x16x32_bf16 v[148:151], v[200:203], v[36:39], 0
    buffer_load_dwordx4 v[104:107], v1, s[32:35], s82 offen offset:2048 sc1
    v_mfma_f32_16x16x32_bf16 v[152:155], v[204:207], v[32:35], 0
    ds_read_b128 v[220:223], v2 offset:5120
    v_mfma_f32_16x16x32_bf16 v[156:159], v[204:207], v[36:39], 0
    v_mfma_f32_16x16x32_bf16 v[160:163], v[208:211], v[32:35], 0
    ds_read_b128 v[200:203], v2 offset:6144
    v_mfma_f32_16x16x32_bf16 v[164:167], v[208:211], v[36:39], 0
    buffer_load_dwordx4 v[108:111], v1, s[32:35], s82 offen offset:3072 sc1
    v_mfma_f32_16x16x32_bf16 v[168:171], v[212:215], v[32:35], 0
    ds_read_b128 v[204:207], v2 offset:7168
    v_mfma_f32_16x16x32_bf16 v[172:175], v[212:215], v[36:39], 0
    s_waitcnt vmcnt(16) lgkmcnt(2)
    v_mfma_f32_16x16x32_bf16 v[144:147], v[216:219], v[40:43], v[144:147]
    ds_read_b128 v[208:211], v2 offset:8192
    v_mfma_f32_16x16x32_bf16 v[148:151], v[216:219], v[44:47], v[148:151]
    buffer_load_dwordx4 v[112:115], v28, s[32:35], s82 offen offset:0 sc1
    v_mfma_f32_16x16x32_bf16 v[152:155], v[220:223], v[40:43], v[152:155]
    ds_read_b128 v[212:215], v2 offset:9216
    v_mfma_f32_16x16x32_bf16 v[156:159], v[220:223], v[44:47], v[156:159]
    s_waitcnt lgkmcnt(2)
    v_mfma_f32_16x16x32_bf16 v[160:163], v[200:203], v[40:43], v[160:163]
    ds_read_b128 v[216:219], v2 offset:10240
    v_mfma_f32_16x16x32_bf16 v[164:167], v[200:203], v[44:47], v[164:167]
    buffer_load_dwordx4 v[116:119], v28, s[32:35], s82 offen offset:1024 sc1
    v_mfma_f32_16x16x32_bf16 v[168:171], v[204:207], v[40:43], v[168:171]
    ds_read_b128 v[220:223], v2 offset:11264
    v_mfma_f32_16x16x32_bf16 v[172:175], v[204:207], v[44:47], v[172:175]
    s_waitcnt vmcnt(16) lgkmcnt(2)
    v_mfma_f32_16x16x32_bf16 v[144:147], v[208:211], v[48:51], v[144:147]
    ds_read_b128 v[200:203], v2 offset:12288
    v_mfma_f32_16x16x32_bf16 v[148:151], v[208:211], v[52:55], v[148:151]
    buffer_load_dwordx4 v[120:123], v28, s[32:35], s82 offen offset:2048 sc1
    v_mfma_f32_16x16x32_bf16 v[152:155], v[212:215], v[48:51], v[152:155]
    ds_read_b128 v[204:207], v2 offset:13312
    v_mfma_f32_16x16x32_bf16 v[156:159], v[212:215], v[52:55], v[156:159]
    s_waitcnt lgkmcnt(2)
    v_mfma_f32_16x16x32_bf16 v[160:163], v[216:219], v[48:51], v[160:163]
    ds_read_b128 v[208:211], v2 offset:14336
    v_mfma_f32_16x16x32_bf16 v[164:167], v[216:219], v[52:55], v[164:167]
    buffer_load_dwordx4 v[124:127], v28, s[32:35], s82 offen offset:3072 sc1
    v_mfma_f32_16x16x32_bf16 v[168:171], v[220:223], v[48:51], v[168:171]
    ds_read_b128 v[212:215], v2 offset:15360
    v_mfma_f32_16x16x32_bf16 v[172:175], v[220:223], v[52:55], v[172:175]
    s_waitcnt vmcnt(16) lgkmcnt(2)
    v_mfma_f32_16x16x32_bf16 v[144:147], v[200:203], v[56:59], v[144:147]
    ds_read_b128 v[216:219], v2 offset:16384
    v_mfma_f32_16x16x32_bf16 v[148:151], v[200:203], v[60:63], v[148:151]
    buffer_load_dwordx4 v[128:131], v1, s[32:35], s83 offen offset:0 sc1
    v_mfma_f32_16x16x32_bf16 v[152:155], v[204:207], v[56:59], v[152:155]
    ds_read_b128 v[220:223], v2 offset:17408
    v_mfma_f32_16x16x32_bf16 v[156:159], v[204:207], v[60:63], v[156:159]
    s_waitcnt lgkmcnt(2)
    v_mfma_f32_16x16x32_bf16 v[160:163], v[208:211], v[56:59], v[160:163]
    ds_read_b128 v[200:203], v2 offset:18432
    v_mfma_f32_16x16x32_bf16 v[164:167], v[208:211], v[60:63], v[164:167]
    buffer_load_dwordx4 v[132:135], v1, s[32:35], s83 offen offset:1024 sc1
    v_mfma_f32_16x16x32_bf16 v[168:171], v[212:215], v[56:59], v[168:171]
    ds_read_b128 v[204:207], v2 offset:19456
    v_mfma_f32_16x16x32_bf16 v[172:175], v[212:215], v[60:63], v[172:175]
    s_waitcnt vmcnt(16) lgkmcnt(2)
    v_mfma_f32_16x16x32_bf16 v[144:147], v[216:219], v[64:67], v[144:147]
    ds_read_b128 v[208:211], v2 offset:20480
    v_mfma_f32_16x16x32_bf16 v[148:151], v[216:219], v[68:71], v[148:151]
    buffer_load_dwordx4 v[136:139], v1, s[32:35], s83 offen offset:2048 sc1
    v_mfma_f32_16x16x32_bf16 v[152:155], v[220:223], v[64:67], v[152:155]
    ds_read_b128 v[212:215], v2 offset:21504
    v_mfma_f32_16x16x32_bf16 v[156:159], v[220:223], v[68:71], v[156:159]
    s_waitcnt lgkmcnt(2)
    v_mfma_f32_16x16x32_bf16 v[160:163], v[200:203], v[64:67], v[160:163]
    ds_read_b128 v[216:219], v2 offset:22528
    v_mfma_f32_16x16x32_bf16 v[164:167], v[200:203], v[68:71], v[164:167]
    buffer_load_dwordx4 v[140:143], v1, s[32:35], s83 offen offset:3072 sc1
    v_mfma_f32_16x16x32_bf16 v[168:171], v[204:207], v[64:67], v[168:171]
    ds_read_b128 v[220:223], v2 offset:23552
    v_mfma_f32_16x16x32_bf16 v[172:175], v[204:207], v[68:71], v[172:175]
    s_waitcnt vmcnt(16) lgkmcnt(2)
    v_mfma_f32_16x16x32_bf16 v[144:147], v[208:211], v[72:75], v[144:147]
    ds_read_b128 v[200:203], v2 offset:24576
    v_mfma_f32_16x16x32_bf16 v[148:151], v[208:211], v[76:79], v[148:151]
    v_mfma_f32_16x16x32_bf16 v[152:155], v[212:215], v[72:75], v[152:155]
    ds_read_b128 v[204:207], v2 offset:25600
    v_mfma_f32_16x16x32_bf16 v[156:159], v[212:215], v[76:79], v[156:159]
    s_waitcnt lgkmcnt(2)
    v_mfma_f32_16x16x32_bf16 v[160:163], v[216:219], v[72:75], v[160:163]
    ds_read_b128 v[208:211], v2 offset:26624
    v_mfma_f32_16x16x32_bf16 v[164:167], v[216:219], v[76:79], v[164:167]
    v_mfma_f32_16x16x32_bf16 v[168:171], v[220:223], v[72:75], v[168:171]
    ds_read_b128 v[212:215], v2 offset:27648
    v_mfma_f32_16x16x32_bf16 v[172:175], v[220:223], v[76:79], v[172:175]
    s_waitcnt vmcnt(14) lgkmcnt(2)
    v_mfma_f32_16x16x32_bf16 v[144:147], v[200:203], v[80:83], v[144:147]
    ds_read_b128 v[216:219], v2 offset:28672
    v_mfma_f32_16x16x32_bf16 v[148:151], v[200:203], v[84:87], v[148:151]
    v_mfma_f32_16x16x32_bf16 v[152:155], v[204:207], v[80:83], v[152:155]
    ds_read_b128 v[220:223], v2 offset:29696
    v_mfma_f32_16x16x32_bf16 v[156:159], v[204:207], v[84:87], v[156:159]
    s_waitcnt lgkmcnt(2)
    v_mfma_f32_16x16x32_bf16 v[160:163], v[208:211], v[80:83], v[160:163]
    ds_read_b128 v[200:203], v2 offset:30720
    v_mfma_f32_16x16x32_bf16 v[164:167], v[208:211], v[84:87], v[164:167]
    v_mfma_f32_16x16x32_bf16 v[168:171], v[212:215], v[80:83], v[168:171]
    ds_read_b128 v[204:207], v2 offset:31744
    v_mfma_f32_16x16x32_bf16 v[172:175], v[212:215], v[84:87], v[172:175]
    buffer_load_dwordx2 v[224:225], v4, s[32:35], s84 offen offset:0 sc1
    s_waitcnt vmcnt(13) lgkmcnt(2)
    v_mfma_f32_16x16x32_bf16 v[144:147], v[216:219], v[88:91], v[144:147]
    ds_read_b128 v[208:211], v2 offset:32768
    v_mfma_f32_16x16x32_bf16 v[148:151], v[216:219], v[92:95], v[148:151]
    v_mfma_f32_16x16x32_bf16 v[152:155], v[220:223], v[88:91], v[152:155]
    ds_read_b128 v[212:215], v2 offset:33792
    v_mfma_f32_16x16x32_bf16 v[156:159], v[220:223], v[92:95], v[156:159]
    buffer_load_dwordx2 v[226:227], v4, s[32:35], s84 offen offset:256 sc1
    s_waitcnt lgkmcnt(2)
    v_mfma_f32_16x16x32_bf16 v[160:163], v[200:203], v[88:91], v[160:163]
    ds_read_b128 v[216:219], v2 offset:34816
    v_mfma_f32_16x16x32_bf16 v[164:167], v[200:203], v[92:95], v[164:167]
    v_mfma_f32_16x16x32_bf16 v[168:171], v[204:207], v[88:91], v[168:171]
    ds_read_b128 v[220:223], v2 offset:35840
    v_mfma_f32_16x16x32_bf16 v[172:175], v[204:207], v[92:95], v[172:175]
    buffer_load_dwordx2 v[228:229], v4, s[32:35], s84 offen offset:512 sc1
    s_waitcnt vmcnt(13) lgkmcnt(2)
    v_mfma_f32_16x16x32_bf16 v[144:147], v[208:211], v[96:99], v[144:147]
    ds_read_b128 v[200:203], v2 offset:36864
    v_mfma_f32_16x16x32_bf16 v[148:151], v[208:211], v[100:103], v[148:151]
    v_mfma_f32_16x16x32_bf16 v[152:155], v[212:215], v[96:99], v[152:155]
    ds_read_b128 v[204:207], v2 offset:37888
    v_mfma_f32_16x16x32_bf16 v[156:159], v[212:215], v[100:103], v[156:159]
    buffer_load_dwordx2 v[230:231], v4, s[32:35], s84 offen offset:768 sc1
    s_waitcnt lgkmcnt(2)
    v_mfma_f32_16x16x32_bf16 v[160:163], v[216:219], v[96:99], v[160:163]
    ds_read_b128 v[208:211], v2 offset:38912
    v_mfma_f32_16x16x32_bf16 v[164:167], v[216:219], v[100:103], v[164:167]
    v_mfma_f32_16x16x32_bf16 v[168:171], v[220:223], v[96:99], v[168:171]
    ds_read_b128 v[212:215], v2 offset:39936
    v_mfma_f32_16x16x32_bf16 v[172:175], v[220:223], v[100:103], v[172:175]
    buffer_load_dwordx2 v[232:233], v4, s[32:35], s84 offen offset:1024 sc1
    s_waitcnt vmcnt(13) lgkmcnt(2)
    v_mfma_f32_16x16x32_bf16 v[144:147], v[200:203], v[104:107], v[144:147]
    ds_read_b128 v[216:219], v2 offset:40960
    v_mfma_f32_16x16x32_bf16 v[148:151], v[200:203], v[108:111], v[148:151]
    v_mfma_f32_16x16x32_bf16 v[152:155], v[204:207], v[104:107], v[152:155]
    ds_read_b128 v[220:223], v2 offset:41984
    v_mfma_f32_16x16x32_bf16 v[156:159], v[204:207], v[108:111], v[156:159]
    buffer_load_dwordx2 v[234:235], v4, s[32:35], s84 offen offset:1280 sc1
    s_waitcnt lgkmcnt(2)
    v_mfma_f32_16x16x32_bf16 v[160:163], v[208:211], v[104:107], v[160:163]
    ds_read_b128 v[200:203], v2 offset:43008
    v_mfma_f32_16x16x32_bf16 v[164:167], v[208:211], v[108:111], v[164:167]
    v_mfma_f32_16x16x32_bf16 v[168:171], v[212:215], v[104:107], v[168:171]
    ds_read_b128 v[204:207], v2 offset:44032
    v_mfma_f32_16x16x32_bf16 v[172:175], v[212:215], v[108:111], v[172:175]
    buffer_load_dwordx2 v[236:237], v4, s[32:35], s84 offen offset:1536 sc1
    s_waitcnt vmcnt(13) lgkmcnt(2)
    v_mfma_f32_16x16x32_bf16 v[144:147], v[216:219], v[112:115], v[144:147]
    ds_read_b128 v[208:211], v2 offset:45056
    v_mfma_f32_16x16x32_bf16 v[148:151], v[216:219], v[116:119], v[148:151]
    v_mfma_f32_16x16x32_bf16 v[152:155], v[220:223], v[112:115], v[152:155]
    ds_read_b128 v[212:215], v2 offset:46080
    v_mfma_f32_16x16x32_bf16 v[156:159], v[220:223], v[116:119], v[156:159]
    s_waitcnt lgkmcnt(2)
    v_mfma_f32_16x16x32_bf16 v[160:163], v[200:203], v[112:115], v[160:163]
    ds_read_b128 v[216:219], v2 offset:47104
    v_mfma_f32_16x16x32_bf16 v[164:167], v[200:203], v[116:119], v[164:167]
    v_mfma_f32_16x16x32_bf16 v[168:171], v[204:207], v[112:115], v[168:171]
    ds_read_b128 v[220:223], v2 offset:48128
    v_mfma_f32_16x16x32_bf16 v[172:175], v[204:207], v[116:119], v[172:175]
    s_waitcnt vmcnt(11) lgkmcnt(2)
    v_mfma_f32_16x16x32_bf16 v[144:147], v[208:211], v[120:123], v[144:147]
    ds_read_b128 v[200:203], v2 offset:49152
    s_waitcnt vmcnt(5)
    v_add_f32 v224, v224, v226
    v_mfma_f32_16x16x32_bf16 v[148:151], v[208:211], v[124:127], v[148:151]
    v_add_f32 v225, v225, v227
    s_waitcnt vmcnt(4)
    v_add_f32 v224, v224, v228
    v_mfma_f32_16x16x32_bf16 v[152:155], v[212:215], v[120:123], v[152:155]
    ds_read_b128 v[204:207], v2 offset:50176
    v_add_f32 v225, v225, v229
    v_mfma_f32_16x16x32_bf16 v[156:159], v[212:215], v[124:127], v[156:159]
    s_waitcnt vmcnt(3)
    v_add_f32 v224, v224, v230
    s_waitcnt lgkmcnt(2)
    v_mfma_f32_16x16x32_bf16 v[160:163], v[216:219], v[120:123], v[160:163]
    ds_read_b128 v[208:211], v2 offset:51200
    v_add_f32 v225, v225, v231
    v_mfma_f32_16x16x32_bf16 v[164:167], v[216:219], v[124:127], v[164:167]
    s_waitcnt vmcnt(2)
    v_add_f32 v224, v224, v232
    v_add_f32 v225, v225, v233
    v_mfma_f32_16x16x32_bf16 v[168:171], v[220:223], v[120:123], v[168:171]
    ds_read_b128 v[212:215], v2 offset:52224
    s_waitcnt vmcnt(1)
    v_add_f32 v224, v224, v234
    v_mfma_f32_16x16x32_bf16 v[172:175], v[220:223], v[124:127], v[172:175]
    v_add_f32 v225, v225, v235
    s_waitcnt lgkmcnt(2)
    v_mfma_f32_16x16x32_bf16 v[144:147], v[200:203], v[128:131], v[144:147]
    ds_read_b128 v[216:219], v2 offset:53248
    s_waitcnt vmcnt(0)
    v_add_f32 v224, v224, v236
    v_mfma_f32_16x16x32_bf16 v[148:151], v[200:203], v[132:135], v[148:151]
    v_add_f32 v225, v225, v237
    v_mov_b32 v226, v224
    v_mfma_f32_16x16x32_bf16 v[152:155], v[204:207], v[128:131], v[152:155]
    ds_read_b128 v[220:223], v2 offset:54272
    v_mov_b32 v227, v225
    v_mfma_f32_16x16x32_bf16 v[156:159], v[204:207], v[132:135], v[156:159]
    s_nop 0
    s_waitcnt lgkmcnt(2)
    v_mfma_f32_16x16x32_bf16 v[160:163], v[208:211], v[128:131], v[160:163]
    ds_read_b128 v[200:203], v2 offset:55296
    v_mfma_f32_16x16x32_bf16 v[164:167], v[208:211], v[132:135], v[164:167]
    v_permlane32_swap_b32 v224, v226
    v_mfma_f32_16x16x32_bf16 v[168:171], v[212:215], v[128:131], v[168:171]
    ds_read_b128 v[204:207], v2 offset:56320
    v_mfma_f32_16x16x32_bf16 v[172:175], v[212:215], v[132:135], v[172:175]
    s_waitcnt lgkmcnt(2)
    v_mfma_f32_16x16x32_bf16 v[144:147], v[216:219], v[136:139], v[144:147]
    ds_read_b128 v[208:211], v19 offset:0
    v_mfma_f32_16x16x32_bf16 v[148:151], v[216:219], v[140:143], v[148:151]
    v_permlane32_swap_b32 v225, v227
    v_mfma_f32_16x16x32_bf16 v[152:155], v[220:223], v[136:139], v[152:155]
    ds_read_b128 v[212:215], v19 offset:1024
    v_add_f32 v224, v224, v226
    v_mfma_f32_16x16x32_bf16 v[156:159], v[220:223], v[140:143], v[156:159]
    v_add_f32 v225, v225, v227
    s_waitcnt lgkmcnt(2)
    v_mfma_f32_16x16x32_bf16 v[160:163], v[200:203], v[136:139], v[160:163]
    ds_read_b128 v[216:219], v19 offset:2048
    v_mul_f32 v14, 0xbb124925, v224
    v_mfma_f32_16x16x32_bf16 v[164:167], v[200:203], v[140:143], v[164:167]
    v_mul_f32 v225, 0x3b124925, v225
    v_fma_f32 v225, -v14, v14, v225
    v_mfma_f32_16x16x32_bf16 v[168:171], v[204:207], v[136:139], v[168:171]
    ds_read_b128 v[220:223], v19 offset:3072
    v_max_f32 v225, 0, v225
    v_mfma_f32_16x16x32_bf16 v[172:175], v[204:207], v[140:143], v[172:175]
    v_add_f32 v225, 0x3727c5ac, v225
    v_rsq_f32 v15, v225
    v_mov_b32 v15, v14
    s_nop 0
    s_nop 0
    v_permlane16_swap_b32 v14, v15
    s_branch L_padskip7
L_pad7:
    s_setpc_b64 s[98:99]
L_padskip7:
    s_barrier
    ds_read_b128 v[224:227], v11 offset:0
    ds_read_b128 v[228:231], v11 offset:64
    ds_read_b128 v[232:235], v11 offset:128
    ds_read_b128 v[236:239], v11 offset:192
    s_waitcnt lgkmcnt(3)
    v_pk_fma_f32 v[144:145], v[224:225], v[14:15], v[144:145] op_sel:[0,0,0] op_sel_hi:[1,0,1]
    v_pk_fma_f32 v[146:147], v[226:227], v[14:15], v[146:147] op_sel:[0,0,0] op_sel_hi:[1,0,1]
    s_waitcnt lgkmcnt(2)
    v_pk_fma_f32 v[152:153], v[228:229], v[14:15], v[152:153] op_sel:[0,0,0] op_sel_hi:[1,0,1]
    v_pk_fma_f32 v[154:155], v[230:231], v[14:15], v[154:155] op_sel:[0,0,0] op_sel_hi:[1,0,1]
    v_cvt_pk_bf16_f32 v20, v144, v145
    v_cvt_pk_bf16_f32 v21, v146, v147
    v_cvt_pk_bf16_f32 v22, v152, v153
    v_cvt_pk_bf16_f32 v23, v154, v155
    v_pk_max_i16 v20, v20, 0
    v_pk_max_i16 v21, v21, 0
    v_pk_max_i16 v22, v22, 0
    v_pk_max_i16 v23, v23, 0
    buffer_store_dwordx4 v[20:23], v17, s[32:35], s86 offen offset:0 sc1
    v_pk_fma_f32 v[148:149], v[224:225], v[14:15], v[148:149] op_sel:[0,1,0] op_sel_hi:[1,1,1]
    v_pk_fma_f32 v[150:151], v[226:227], v[14:15], v[150:151] op_sel:[0,1,0] op_sel_hi:[1,1,1]
    v_pk_fma_f32 v[156:157], v[228:229], v[14:15], v[156:157] op_sel:[0,1,0] op_sel_hi:[1,1,1]
    v_pk_fma_f32 v[158:159], v[230:231], v[14:15], v[158:159] op_sel:[0,1,0] op_sel_hi:[1,1,1]
    v_cvt_pk_bf16_f32 v24, v148, v149
    v_cvt_pk_bf16_f32 v25, v150, v151
    v_cvt_pk_bf16_f32 v26, v156, v157
    v_cvt_pk_bf16_f32 v27, v158, v159
    v_pk_max_i16 v24, v24, 0
    v_pk_max_i16 v25, v25, 0
    v_pk_max_i16 v26, v26, 0
    v_pk_max_i16 v27, v27, 0
    buffer_store_dwordx4 v[24:27], v17, s[32:35], s86 offen offset:256 sc1
    s_waitcnt lgkmcnt(1)
    v_pk_fma_f32 v[160:161], v[232:233], v[14:15], v[160:161] op_sel:[0,0,0] op_sel_hi:[1,0,1]
    v_pk_fma_f32 v[162:163], v[234:235], v[14:15], v[162:163] op_sel:[0,0,0] op_sel_hi:[1,0,1]
    s_waitcnt lgkmcnt(0)
    v_pk_fma_f32 v[168:169], v[236:237], v[14:15], v[168:169] op_sel:[0,0,0] op_sel_hi:[1,0,1]
    v_pk_fma_f32 v[170:171], v[238:239], v[14:15], v[170:171] op_sel:[0,0,0] op_sel_hi:[1,0,1]
    v_cvt_pk_bf16_f32 v20, v160, v161
    v_cvt_pk_bf16_f32 v21, v162, v163
    v_cvt_pk_bf16_f32 v22, v168, v169
    v_cvt_pk_bf16_f32 v23, v170, v171
    v_pk_max_i16 v20, v20, 0
    v_pk_max_i16 v21, v21, 0
    v_pk_max_i16 v22, v22, 0
    v_pk_max_i16 v23, v23, 0
    buffer_store_dwordx4 v[20:23], v17, s[32:35], s86 offen offset:2048 sc1
    v_pk_fma_f32 v[164:165], v[232:233], v[14:15], v[164:165] op_sel:[0,1,0] op_sel_hi:[1,1,1]
    v_pk_fma_f32 v[166:167], v[234:235], v[14:15], v[166:167] op_sel:[0,1,0] op_sel_hi:[1,1,1]
    v_pk_fma_f32 v[172:173], v[236:237], v[14:15], v[172:173] op_sel:[0,1,0] op_sel_hi:[1,1,1]
    v_pk_fma_f32 v[174:175], v[238:239], v[14:15], v[174:175] op_sel:[0,1,0] op_sel_hi:[1,1,1]
    v_cvt_pk_bf16_f32 v24, v164, v165
    v_cvt_pk_bf16_f32 v25, v166, v167
    v_cvt_pk_bf16_f32 v26, v172, v173
    v_cvt_pk_bf16_f32 v27, v174, v175
    v_pk_max_i16 v24, v24, 0
    v_pk_max_i16 v25, v25, 0
    v_pk_max_i16 v26, v26, 0
    v_pk_max_i16 v27, v27, 0
    buffer_store_dwordx4 v[24:27], v17, s[32:35], s86 offen offset:2304 sc1
    v_mfma_f32_16x16x32_bf16 v[176:179], v[208:211], v[32:35], 0
    ds_read_b128 v[200:203], v19 offset:4096
    v_mfma_f32_16x16x32_bf16 v[180:183], v[208:211], v[36:39], 0
    v_mfma_f32_16x16x32_bf16 v[184:187], v[212:215], v[32:35], 0
    ds_read_b128 v[204:207], v19 offset:5120
    v_mfma_f32_16x16x32_bf16 v[188:191], v[212:215], v[36:39], 0
    v_mfma_f32_16x16x32_bf16 v[192:195], v[216:219], v[32:35], 0
    ds_read_b128 v[208:211], v19 offset:6144
    v_mfma_f32_16x16x32_bf16 v[196:199], v[216:219], v[36:39], 0
    v_mfma_f32_16x16x32_bf16 v[176:179], v[220:223], v[40:43], v[176:179]
    ds_read_b128 v[212:215], v19 offset:7168
    v_mfma_f32_16x16x32_bf16 v[180:183], v[220:223], v[44:47], v[180:183]
    s_waitcnt lgkmcnt(2)
    v_mfma_f32_16x16x32_bf16 v[184:187], v[200:203], v[40:43], v[184:187]
    ds_read_b128 v[216:219], v19 offset:8192
    v_mfma_f32_16x16x32_bf16 v[188:191], v[200:203], v[44:47], v[188:191]
    v_mfma_f32_16x16x32_bf16 v[192:195], v[204:207], v[40:43], v[192:195]
    ds_read_b128 v[220:223], v19 offset:9216
    v_mfma_f32_16x16x32_bf16 v[196:199], v[204:207], v[44:47], v[196:199]
    s_waitcnt lgkmcnt(2)
    v_mfma_f32_16x16x32_bf16 v[176:179], v[208:211], v[48:51], v[176:179]
    ds_read_b128 v[200:203], v19 offset:10240
    v_mfma_f32_16x16x32_bf16 v[180:183], v[208:211], v[52:55], v[180:183]
    v_mfma_f32_16x16x32_bf16 v[184:187], v[212:215], v[48:51], v[184:187]
    ds_read_b128 v[204:207], v19 offset:11264
    v_mfma_f32_16x16x32_bf16 v[188:191], v[212:215], v[52:55], v[188:191]
    s_waitcnt lgkmcnt(2)
    v_mfma_f32_16x16x32_bf16 v[192:195], v[216:219], v[48:51], v[192:195]
    ds_read_b128 v[208:211], v19 offset:12288
    v_mfma_f32_16x16x32_bf16 v[196:199], v[216:219], v[52:55], v[196:199]
    v_mfma_f32_16x16x32_bf16 v[176:179], v[220:223], v[56:59], v[176:179]
    ds_read_b128 v[212:215], v19 offset:13312
    v_mfma_f32_16x16x32_bf16 v[180:183], v[220:223], v[60:63], v[180:183]
    s_waitcnt vmcnt(0)
    s_mov_b64 exec, 1
    s_cmp_lg_u32 s50, 0
    s_cbranch_scc0 L_pubslow_43
    buffer_store_dwordx2 v[12:13], off, s[32:35], s88 offset:0
L_pubback_44:
    s_mov_b64 exec, -1
    s_waitcnt lgkmcnt(2)
    v_mfma_f32_16x16x32_bf16 v[184:187], v[200:203], v[56:59], v[184:187]
    ds_read_b128 v[216:219], v19 offset:14336
    v_mfma_f32_16x16x32_bf16 v[188:191], v[200:203], v[60:63], v[188:191]
    v_mfma_f32_16x16x32_bf16 v[192:195], v[204:207], v[56:59], v[192:195]
    ds_read_b128 v[220:223], v19 offset:15360
    v_mfma_f32_16x16x32_bf16 v[196:199], v[204:207], v[60:63], v[196:199]
    s_waitcnt lgkmcnt(2)
    v_mfma_f32_16x16x32_bf16 v[176:179], v[208:211], v[64:67], v[176:179]
    ds_read_b128 v[200:203], v19 offset:16384
    v_mfma_f32_16x16x32_bf16 v[180:183], v[208:211], v[68:71], v[180:183]
    v_mfma_f32_16x16x32_bf16 v[184:187], v[212:215], v[64:67], v[184:187]
    ds_read_b128 v[204:207], v19 offset:17408
    v_mfma_f32_16x16x32_bf16 v[188:191], v[212:215], v[68:71], v[188:191]
    s_waitcnt lgkmcnt(2)
    v_mfma_f32_16x16x32_bf16 v[192:195], v[216:219], v[64:67], v[192:195]
    ds_read_b128 v[208:211], v19 offset:18432
    v_mfma_f32_16x16x32_bf16 v[196:199], v[216:219], v[68:71], v[196:199]
    v_mfma_f32_16x16x32_bf16 v[176:179], v[220:223], v[72:75], v[176:179]
    ds_read_b128 v[212:215], v19 offset:19456
    v_mfma_f32_16x16x32_bf16 v[180:183], v[220:223], v[76:79], v[180:183]
    s_waitcnt lgkmcnt(2)
    v_mfma_f32_16x16x32_bf16 v[184:187], v[200:203], v[72:75], v[184:187]
    ds_read_b128 v[216:219], v19 offset:20480
    v_mfma_f32_16x16x32_bf16 v[188:191], v[200:203], v[76:79], v[188:191]
    v_mfma_f32_16x16x32_bf16 v[192:195], v[204:207], v[72:75], v[192:195]
    ds_read_b128 v[220:223], v19 offset:21504
    v_mfma_f32_16x16x32_bf16 v[196:199], v[204:207], v[76:79], v[196:199]
    s_waitcnt lgkmcnt(2)
    v_mfma_f32_16x16x32_bf16 v[176:179], v[208:211], v[80:83], v[176:179]
    ds_read_b128 v[200:203], v19 offset:22528
    v_mfma_f32_16x16x32_bf16 v[180:183], v[208:211], v[84:87], v[180:183]
    v_mfma_f32_16x16x32_bf16 v[184:187], v[212:215], v[80:83], v[184:187]
    ds_read_b128 v[204:207], v19 offset:23552
    v_mfma_f32_16x16x32_bf16 v[188:191], v[212:215], v[84:87], v[188:191]
    s_waitcnt lgkmcnt(2)
    v_mfma_f32_16x16x32_bf16 v[192:195], v[216:219], v[80:83], v[192:195]
    ds_read_b128 v[208:211], v19 offset:24576
    v_mfma_f32_16x16x32_bf16 v[196:199], v[216:219], v[84:87], v[196:199]
    v_mfma_f32_16x16x32_bf16 v[176:179], v[220:223], v[88:91], v[176:179]
    ds_read_b128 v[212:215], v19 offset:25600
    v_mfma_f32_16x16x32_bf16 v[180:183], v[220:223], v[92:95], v[180:183]
    s_waitcnt lgkmcnt(2)
    v_mfma_f32_16x16x32_bf16 v[184:187], v[200:203], v[88:91], v[184:187]
    ds_read_b128 v[216:219], v19 offset:26624
    v_mfma_f32_16x16x32_bf16 v[188:191], v[200:203], v[92:95], v[188:191]
    v_mfma_f32_16x16x32_bf16 v[192:195], v[204:207], v[88:91], v[192:195]
    ds_read_b128 v[220:223], v19 offset:27648
    v_mfma_f32_16x16x32_bf16 v[196:199], v[204:207], v[92:95], v[196:199]
    s_waitcnt lgkmcnt(2)
    v_mfma_f32_16x16x32_bf16 v[176:179], v[208:211], v[96:99], v[176:179]
    ds_read_b128 v[200:203], v19 offset:28672
    v_mfma_f32_16x16x32_bf16 v[180:183], v[208:211], v[100:103], v[180:183]
    v_mfma_f32_16x16x32_bf16 v[184:187], v[212:215], v[96:99], v[184:187]
    ds_read_b128 v[204:207], v19 offset:29696
    v_mfma_f32_16x16x32_bf16 v[188:191], v[212:215], v[100:103], v[188:191]
    s_waitcnt lgkmcnt(2)
    v_mfma_f32_16x16x32_bf16 v[192:195], v[216:219], v[96:99], v[192:195]
    ds_read_b128 v[208:211], v19 offset:30720
    v_mfma_f32_16x16x32_bf16 v[196:199], v[216:219], v[100:103], v[196:199]
    v_mfma_f32_16x16x32_bf16 v[176:179], v[220:223], v[104:107], v[176:179]
    ds_read_b128 v[212:215], v19 offset:31744
    v_mfma_f32_16x16x32_bf16 v[180:183], v[220:223], v[108:111], v[180:183]
    s_waitcnt lgkmcnt(2)
    v_mfma_f32_16x16x32_bf16 v[184:187], v[200:203], v[104:107], v[184:187]
    ds_read_b128 v[216:219], v19 offset:32768
    v_mfma_f32_16x16x32_bf16 v[188:191], v[200:203], v[108:111], v[188:191]
    s_mov_b64 exec, 0xff
    buffer_load_dwordx2 v[30:31], v5, s[32:35], s89 offen offset:0 sc1
    s_mov_b64 exec, -1
    v_mfma_f32_16x16x32_bf16 v[192:195], v[204:207], v[104:107], v[192:195]
    ds_read_b128 v[220:223], v19 offset:33792
    v_mfma_f32_16x16x32_bf16 v[196:199], v[204:207], v[108:111], v[196:199]
    ds_read_b128 v[224:227], v11 offset:256
    ds_read_b128 v[228:231], v11 offset:320
    s_waitcnt lgkmcnt(4)
    v_mfma_f32_16x16x32_bf16 v[176:179], v[208:211], v[112:115], v[176:179]
    ds_read_b128 v[200:203], v19 offset:34816
    v_mfma_f32_16x16x32_bf16 v[180:183], v[208:211], v[116:119], v[180:183]
    ds_read_b128 v[232:235], v11 offset:384
    v_mfma_f32_16x16x32_bf16 v[184:187], v[212:215], v[112:115], v[184:187]
    ds_read_b128 v[204:207], v19 offset:35840
    v_mfma_f32_16x16x32_bf16 v[188:191], v[212:215], v[116:119], v[188:191]
    s_waitcnt vmcnt(0)
    s_mov_b64 exec, 0xff
    v_cmp_ne_u64 vcc, s[48:49], v[30:31]
    s_mov_b64 exec, -1
    s_or_b64 vcc, vcc, s[54:55]
    s_cbranch_scc1 L_peek_45
L_peekback_46:
    s_waitcnt lgkmcnt(5)
    v_mfma_f32_16x16x32_bf16 v[192:195], v[216:219], v[112:115], v[192:195]
    ds_read_b128 v[208:211], v19 offset:36864
    v_mfma_f32_16x16x32_bf16 v[196:199], v[216:219], v[116:119], v[196:199]
    buffer_load_dwordx4 v[32:35], v1, s[32:35], s76 offen offset:0 sc1
    v_mfma_f32_16x16x32_bf16 v[176:179], v[220:223], v[120:123], v[176:179]
    ds_read_b128 v[212:215], v19 offset:37888
    v_mfma_f32_16x16x32_bf16 v[180:183], v[220:223], v[124:127], v[180:183]
    buffer_load_dwordx4 v[36:39], v1, s[32:35], s77 offen offset:0 sc1
    s_waitcnt lgkmcnt(2)
    v_mfma_f32_16x16x32_bf16 v[184:187], v[200:203], v[120:123], v[184:187]
    ds_read_b128 v[216:219], v19 offset:38912
    v_mfma_f32_16x16x32_bf16 v[188:191], v[200:203], v[124:127], v[188:191]
    buffer_load_dwordx4 v[40:43], v1, s[32:35], s76 offen offset:1024 sc1
    v_mfma_f32_16x16x32_bf16 v[192:195], v[204:207], v[120:123], v[192:195]
    ds_read_b128 v[220:223], v19 offset:39936
    v_mfma_f32_16x16x32_bf16 v[196:199], v[204:207], v[124:127], v[196:199]
    buffer_load_dwordx4 v[44:47], v1, s[32:35], s77 offen offset:1024 sc1
    s_waitcnt lgkmcnt(2)
    v_mfma_f32_16x16x32_bf16 v[176:179], v[208:211], v[128:131], v[176:179]
    ds_read_b128 v[200:203], v19 offset:40960
    v_mfma_f32_16x16x32_bf16 v[180:183], v[208:211], v[132:135], v[180:183]
    buffer_load_dwordx4 v[48:51], v1, s[32:35], s76 offen offset:2048 sc1
    v_mfma_f32_16x16x32_bf16 v[184:187], v[212:215], v[128:131], v[184:187]
    ds_read_b128 v[204:207], v19 offset:41984
    v_mfma_f32_16x16x32_bf16 v[188:191], v[212:215], v[132:135], v[188:191]
    buffer_load_dwordx4 v[52:55], v1, s[32:35], s77 offen offset:2048 sc1
    s_waitcnt lgkmcnt(2)
    v_mfma_f32_16x16x32_bf16 v[192:195], v[216:219], v[128:131], v[192:195]
    v_mfma_f32_16x16x32_bf16 v[196:199], v[216:219], v[132:135], v[196:199]
    buffer_load_dwordx4 v[56:59], v1, s[32:35], s76 offen offset:3072 sc1
    v_mfma_f32_16x16x32_bf16 v[176:179], v[220:223], v[136:139], v[176:179]
    v_mfma_f32_16x16x32_bf16 v[180:183], v[220:223], v[140:143], v[180:183]
    buffer_load_dwordx4 v[60:63], v1, s[32:35], s77 offen offset:3072 sc1
    s_waitcnt lgkmcnt(0)
    v_mfma_f32_16x16x32_bf16 v[184:187], v[200:203], v[136:139], v[184:187]
    v_mfma_f32_16x16x32_bf16 v[188:191], v[200:203], v[140:143], v[188:191]
    buffer_load_dwordx4 v[64:67], v1, s[32:35], s78 offen offset:0 sc1
    v_mfma_f32_16x16x32_bf16 v[192:195], v[204:207], v[136:139], v[192:195]
    v_mfma_f32_16x16x32_bf16 v[196:199], v[204:207], v[140:143], v[196:199]
    buffer_load_dwordx4 v[68:71], v1, s[32:35], s79 offen offset:0 sc1
    v_pk_fma_f32 v[176:177], v[224:225], v[14:15], v[176:177] op_sel:[0,0,0] op_sel_hi:[1,0,1]
    v_pk_fma_f32 v[178:179], v[226:227], v[14:15], v[178:179] op_sel:[0,0,0] op_sel_hi:[1,0,1]
    s_nop 0
    v_pk_fma_f32 v[184:185], v[228:229], v[14:15], v[184:185] op_sel:[0,0,0] op_sel_hi:[1,0,1]
    v_pk_fma_f32 v[186:187], v[230:231], v[14:15], v[186:187] op_sel:[0,0,0] op_sel_hi:[1,0,1]
    v_cvt_pk_bf16_f32 v20, v176, v177
    v_cvt_pk_bf16_f32 v21, v178, v179
    v_cvt_pk_bf16_f32 v22, v184, v185
    v_cvt_pk_bf16_f32 v23, v186, v187
    v_pk_max_i16 v20, v20, 0
    v_pk_max_i16 v21, v21, 0
    v_pk_max_i16 v22, v22, 0
    v_pk_max_i16 v23, v23, 0
    buffer_store_dwordx4 v[20:23], v17, s[32:35], s87 offen offset:0 sc1
    v_pk_fma_f32 v[180:181], v[224:225], v[14:15], v[180:181] op_sel:[0,1,0] op_sel_hi:[1,1,1]
    v_pk_fma_f32 v[182:183], v[226:227], v[14:15], v[182:183] op_sel:[0,1,0] op_sel_hi:[1,1,1]
    v_pk_fma_f32 v[188:189], v[228:229], v[14:15], v[188:189] op_sel:[0,1,0] op_sel_hi:[1,1,1]
    v_pk_fma_f32 v[190:191], v[230:231], v[14:15], v[190:191] op_sel:[0,1,0] op_sel_hi:[1,1,1]
    v_cvt_pk_bf16_f32 v24, v180, v181
    v_cvt_pk_bf16_f32 v25, v182, v183
    v_cvt_pk_bf16_f32 v26, v188, v189
    v_cvt_pk_bf16_f32 v27, v190, v191
    v_pk_max_i16 v24, v24, 0
    v_pk_max_i16 v25, v25, 0
    v_pk_max_i16 v26, v26, 0
    v_pk_max_i16 v27, v27, 0
    buffer_store_dwordx4 v[24:27], v17, s[32:35], s87 offen offset:256 sc1
    v_pk_fma_f32 v[192:193], v[232:233], v[14:15], v[192:193] op_sel:[0,0,0] op_sel_hi:[1,0,1]
    v_pk_fma_f32 v[194:195], v[234:235], v[14:15], v[194:195] op_sel:[0,0,0] op_sel_hi:[1,0,1]
    v_cvt_pk_bf16_f32 v20, v192, v193
    v_cvt_pk_bf16_f32 v21, v194, v195
    v_pk_max_i16 v20, v20, 0
    v_pk_max_i16 v21, v21, 0
    buffer_store_dwordx2 v[20:21], v18, s[32:35], s87 offen offset:2048 sc1
    v_pk_fma_f32 v[196:197], v[232:233], v[14:15], v[196:197] op_sel:[0,1,0] op_sel_hi:[1,1,1]
    v_pk_fma_f32 v[198:199], v[234:235], v[14:15], v[198:199] op_sel:[0,1,0] op_sel_hi:[1,1,1]
    v_cvt_pk_bf16_f32 v24, v196, v197
    v_cvt_pk_bf16_f32 v25, v198, v199
    v_pk_max_i16 v24, v24, 0
    v_pk_max_i16 v25, v25, 0
    buffer_store_dwordx2 v[24:25], v18, s[32:35], s87 offen offset:2304 sc1
    s_branch L_padskip8
L_pad8:
    s_setpc_b64 s[98:99]
L_padskip8:
    s_cmp_ge_u32 s41, 28
    s_cbranch_scc1 L_p5skip_50
    s_barrier
    s_waitcnt vmcnt(13)
    v_mfma_f32_32x32x16_bf16 v[160:175], a[0:3], v[32:35], 0
    buffer_load_dwordx4 v[72:75], v1, s[32:35], s78 offen offset:1024 sc1
    v_mfma_f32_32x32x16_bf16 v[176:191], a[4:7], v[32:35], 0
    buffer_load_dwordx4 v[76:79], v1, s[32:35], s79 offen offset:1024 sc1
    s_waitcnt vmcnt(14)
    v_mfma_f32_32x32x16_bf16 v[192:207], a[0:3], v[36:39], 0
    v_mfma_f32_32x32x16_bf16 v[208:223], a[4:7], v[36:39], 0
    s_waitcnt vmcnt(13)
    v_mfma_f32_32x32x16_bf16 v[160:175], a[8:11], v[40:43], v[160:175]
    buffer_load_dwordx4 v[80:83], v1, s[32:35], s78 offen offset:2048 sc1
    v_mfma_f32_32x32x16_bf16 v[176:191], a[12:15], v[40:43], v[176:191]
    buffer_load_dwordx4 v[84:87], v1, s[32:35], s79 offen offset:2048 sc1
    s_waitcnt vmcnt(14)
    v_mfma_f32_32x32x16_bf16 v[192:207], a[8:11], v[44:47], v[192:207]
    v_mfma_f32_32x32x16_bf16 v[208:223], a[12:15], v[44:47], v[208:223]
    s_waitcnt vmcnt(13)
    v_mfma_f32_32x32x16_bf16 v[160:175], a[16:19], v[48:51], v[160:175]
    buffer_load_dwordx4 v[88:91], v1, s[32:35], s78 offen offset:3072 sc1
    v_mfma_f32_32x32x16_bf16 v[176:191], a[20:23], v[48:51], v[176:191]
    buffer_load_dwordx4 v[92:95], v1, s[32:35], s79 offen offset:3072 sc1
    s_waitcnt vmcnt(14)
    v_mfma_f32_32x32x16_bf16 v[192:207], a[16:19], v[52:55], v[192:207]
    v_mfma_f32_32x32x16_bf16 v[208:223], a[20:23], v[52:55], v[208:223]
    s_waitcnt vmcnt(13)
    v_mfma_f32_32x32x16_bf16 v[160:175], a[24:27], v[56:59], v[160:175]
    buffer_load_dwordx4 v[96:99], v1, s[32:35], s92 offen offset:0 sc1
    v_mfma_f32_32x32x16_bf16 v[176:191], a[28:31], v[56:59], v[176:191]
    buffer_load_dwordx4 v[100:103], v1, s[32:35], s93 offen offset:0 sc1
    s_waitcnt vmcnt(14)
    v_mfma_f32_32x32x16_bf16 v[192:207], a[24:27], v[60:63], v[192:207]
    v_mfma_f32_32x32x16_bf16 v[208:223], a[28:31], v[60:63], v[208:223]
    s_waitcnt vmcnt(8)
    s_mov_b64 exec, 1
    s_cmp_lg_u32 s50, 0
    s_cbranch_scc0 L_pubslow_54
    buffer_store_dwordx2 v[12:13], off, s[32:35], s88 offset:1024
L_pubback_55:
    s_mov_b64 exec, -1
    v_mfma_f32_32x32x16_bf16 v[160:175], a[56:59], v[64:67], v[160:175]
    buffer_load_dwordx4 v[104:107], v1, s[32:35], s92 offen offset:1024 sc1
    v_mfma_f32_32x32x16_bf16 v[176:191], a[60:63], v[64:67], v[176:191]
    buffer_load_dwordx4 v[108:111], v1, s[32:35], s93 offen offset:1024 sc1
    v_mfma_f32_32x32x16_bf16 v[192:207], a[56:59], v[68:71], v[192:207]
    v_mfma_f32_32x32x16_bf16 v[208:223], a[60:63], v[68:71], v[208:223]
    s_waitcnt vmcnt(10)
    v_mfma_f32_32x32x16_bf16 v[160:175], a[64:67], v[72:75], v[160:175]
    buffer_load_dwordx4 v[112:115], v1, s[32:35], s92 offen offset:2048 sc1
    v_mfma_f32_32x32x16_bf16 v[176:191], a[68:71], v[72:75], v[176:191]
    buffer_load_dwordx4 v[116:119], v1, s[32:35], s93 offen offset:2048 sc1
    s_waitcnt vmcnt(11)
    v_mfma_f32_32x32x16_bf16 v[192:207], a[64:67], v[76:79], v[192:207]
    v_mfma_f32_32x32x16_bf16 v[208:223], a[68:71], v[76:79], v[208:223]
    s_waitcnt vmcnt(10)
    v_mfma_f32_32x32x16_bf16 v[160:175], a[72:75], v[80:83], v[160:175]
    buffer_load_dwordx4 v[120:123], v1, s[32:35], s92 offen offset:3072 sc1
    v_mfma_f32_32x32x16_bf16 v[176:191], a[76:79], v[80:83], v[176:191]
    buffer_load_dwordx4 v[124:127], v1, s[32:35], s93 offen offset:3072 sc1
    s_waitcnt vmcnt(11)
    v_mfma_f32_32x32x16_bf16 v[192:207], a[72:75], v[84:87], v[192:207]
    v_mfma_f32_32x32x16_bf16 v[208:223], a[76:79], v[84:87], v[208:223]
    s_waitcnt vmcnt(10)
    v_mfma_f32_32x32x16_bf16 v[160:175], a[80:83], v[88:91], v[160:175]
    buffer_load_dwordx4 v[128:131], v1, s[32:35], s94 offen offset:0 sc1
    v_mfma_f32_32x32x16_bf16 v[176:191], a[84:87], v[88:91], v[176:191]
    buffer_load_dwordx4 v[132:135], v1, s[32:35], s95 offen offset:0 sc1
    s_waitcnt vmcnt(11)
    v_mfma_f32_32x32x16_bf16 v[192:207], a[80:83], v[92:95], v[192:207]
    v_mfma_f32_32x32x16_bf16 v[208:223], a[84:87], v[92:95], v[208:223]
    s_waitcnt vmcnt(10)
    v_mfma_f32_32x32x16_bf16 v[160:175], a[112:115], v[96:99], v[160:175]
    buffer_load_dwordx4 v[136:139], v1, s[32:35], s94 offen offset:1024 sc1
    v_mfma_f32_32x32x16_bf16 v[176:191], a[116:119], v[96:99], v[176:191]
    buffer_load_dwordx4 v[140:143], v1, s[32:35], s95 offen offset:1024 sc1
    s_waitcnt vmcnt(11)
    v_mfma_f32_32x32x16_bf16 v[192:207], a[112:115], v[100:103], v[192:207]
    v_mfma_f32_32x32x16_bf16 v[208:223], a[116:119], v[100:103], v[208:223]
    s_mov_b64 exec, 0xff
    buffer_load_dwordx2 v[30:31], v5, s[32:35], s89 offen offset:1024 sc1
    s_mov_b64 exec, -1
    s_waitcnt vmcnt(10)
    v_mfma_f32_32x32x16_bf16 v[160:175], a[120:123], v[104:107], v[160:175]
    buffer_load_dwordx4 v[144:147], v1, s[32:35], s94 offen offset:2048 sc1
    v_mfma_f32_32x32x16_bf16 v[176:191], a[124:127], v[104:107], v[176:191]
    buffer_load_dwordx4 v[148:151], v1, s[32:35], s95 offen offset:2048 sc1
    s_waitcnt vmcnt(11)
    v_mfma_f32_32x32x16_bf16 v[192:207], a[120:123], v[108:111], v[192:207]
    v_mfma_f32_32x32x16_bf16 v[208:223], a[124:127], v[108:111], v[208:223]
    s_waitcnt vmcnt(10)
    v_mfma_f32_32x32x16_bf16 v[160:175], a[128:131], v[112:115], v[160:175]
    buffer_load_dwordx4 v[152:155], v1, s[32:35], s94 offen offset:3072 sc1
    v_mfma_f32_32x32x16_bf16 v[176:191], a[132:135], v[112:115], v[176:191]
    buffer_load_dwordx4 v[156:159], v1, s[32:35], s95 offen offset:3072 sc1
    s_waitcnt vmcnt(11)
    v_mfma_f32_32x32x16_bf16 v[192:207], a[128:131], v[116:119], v[192:207]
    v_mfma_f32_32x32x16_bf16 v[208:223], a[132:135], v[116:119], v[208:223]
    s_waitcnt vmcnt(10)
    v_mfma_f32_32x32x16_bf16 v[160:175], a[136:139], v[120:123], v[160:175]
    s_waitcnt vmcnt(4)
    s_mov_b64 exec, 0xff
    v_cmp_ne_u64 vcc, s[48:49], v[30:31]
    s_mov_b64 exec, -1
    s_or_b64 vcc, vcc, s[54:55]
    s_cbranch_scc1 L_peek_56
L_peekback_57:
    buffer_load_dwordx4 v[32:35], v28, s[32:35], s76 offen offset:0 sc1
    v_mfma_f32_32x32x16_bf16 v[176:191], a[140:143], v[120:123], v[176:191]
    buffer_load_dwordx4 v[36:39], v28, s[32:35], s77 offen offset:0 sc1
    v_mfma_f32_32x32x16_bf16 v[192:207], a[136:139], v[124:127], v[192:207]
    v_mfma_f32_32x32x16_bf16 v[208:223], a[140:143], v[124:127], v[208:223]
    v_mfma_f32_32x32x16_bf16 v[160:175], a[168:171], v[128:131], v[160:175]
    buffer_load_dwordx4 v[40:43], v28, s[32:35], s76 offen offset:1024 sc1
    v_mfma_f32_32x32x16_bf16 v[176:191], a[172:175], v[128:131], v[176:191]
    buffer_load_dwordx4 v[44:47], v28, s[32:35], s77 offen offset:1024 sc1
    v_mfma_f32_32x32x16_bf16 v[192:207], a[168:171], v[132:135], v[192:207]
    v_mfma_f32_32x32x16_bf16 v[208:223], a[172:175], v[132:135], v[208:223]
    v_mfma_f32_32x32x16_bf16 v[160:175], a[176:179], v[136:139], v[160:175]
    buffer_load_dwordx4 v[48:51], v28, s[32:35], s76 offen offset:2048 sc1
    v_mfma_f32_32x32x16_bf16 v[176:191], a[180:183], v[136:139], v[176:191]
    buffer_load_dwordx4 v[52:55], v28, s[32:35], s77 offen offset:2048 sc1
    v_mfma_f32_32x32x16_bf16 v[192:207], a[176:179], v[140:143], v[192:207]
    v_mfma_f32_32x32x16_bf16 v[208:223], a[180:183], v[140:143], v[208:223]
    s_waitcnt vmcnt(9)
    v_mfma_f32_32x32x16_bf16 v[176:191], a[188:191], v[144:147], v[176:191]
    buffer_load_dwordx4 v[56:59], v28, s[32:35], s78 offen offset:0 sc1
    s_waitcnt vmcnt(9)
    v_mfma_f32_32x32x16_bf16 v[192:207], a[184:187], v[148:151], v[192:207]
    buffer_load_dwordx4 v[60:63], v28, s[32:35], s79 offen offset:0 sc1
    v_mfma_f32_32x32x16_bf16 v[208:223], a[188:191], v[148:151], v[208:223]
    s_waitcnt vmcnt(9)
    v_mfma_f32_32x32x16_bf16 v[176:191], a[196:199], v[152:155], v[176:191]
    buffer_load_dwordx4 v[64:67], v28, s[32:35], s78 offen offset:1024 sc1
    s_waitcnt vmcnt(9)
    v_mfma_f32_32x32x16_bf16 v[192:207], a[192:195], v[156:159], v[192:207]
    buffer_load_dwordx4 v[68:71], v28, s[32:35], s79 offen offset:1024 sc1
    v_mfma_f32_32x32x16_bf16 v[208:223], a[196:199], v[156:159], v[208:223]
    s_waitcnt vmcnt(9)
    v_mfma_f32_32x32x16_bf16 v[176:191], a[36:39], v[32:35], v[176:191]
    buffer_load_dwordx4 v[72:75], v28, s[32:35], s78 offen offset:2048 sc1
    s_waitcnt vmcnt(9)
    v_mfma_f32_32x32x16_bf16 v[192:207], a[32:35], v[36:39], v[192:207]
    buffer_load_dwordx4 v[76:79], v28, s[32:35], s79 offen offset:2048 sc1
    v_mfma_f32_32x32x16_bf16 v[208:223], a[36:39], v[36:39], v[208:223]
    s_waitcnt vmcnt(9)
    v_mfma_f32_32x32x16_bf16 v[176:191], a[44:47], v[40:43], v[176:191]
    buffer_load_dwordx4 v[80:83], v28, s[32:35], s92 offen offset:0 sc1
    s_waitcnt vmcnt(9)
    v_mfma_f32_32x32x16_bf16 v[192:207], a[40:43], v[44:47], v[192:207]
    buffer_load_dwordx4 v[84:87], v28, s[32:35], s93 offen offset:0 sc1
    v_mfma_f32_32x32x16_bf16 v[208:223], a[44:47], v[44:47], v[208:223]
    s_waitcnt vmcnt(9)
    v_mfma_f32_32x32x16_bf16 v[176:191], a[52:55], v[48:51], v[176:191]
    buffer_load_dwordx4 v[88:91], v28, s[32:35], s92 offen offset:1024 sc1
    s_waitcnt vmcnt(9)
    v_mfma_f32_32x32x16_bf16 v[192:207], a[48:51], v[52:55], v[192:207]
    buffer_load_dwordx4 v[92:95], v28, s[32:35], s93 offen offset:1024 sc1
    v_mfma_f32_32x32x16_bf16 v[208:223], a[52:55], v[52:55], v[208:223]
    s_waitcnt vmcnt(9)
    v_mfma_f32_32x32x16_bf16 v[176:191], a[92:95], v[56:59], v[176:191]
    buffer_load_dwordx4 v[96:99], v28, s[32:35], s92 offen offset:2048 sc1
    s_waitcnt vmcnt(9)
    v_mfma_f32_32x32x16_bf16 v[192:207], a[88:91], v[60:63], v[192:207]
    buffer_load_dwordx4 v[100:103], v28, s[32:35], s93 offen offset:2048 sc1
    v_mfma_f32_32x32x16_bf16 v[208:223], a[92:95], v[60:63], v[208:223]
    s_waitcnt vmcnt(9)
    v_mfma_f32_32x32x16_bf16 v[176:191], a[100:103], v[64:67], v[176:191]
    buffer_load_dwordx4 v[104:107], v28, s[32:35], s94 offen offset:0 sc1
    s_waitcnt vmcnt(9)
    v_mfma_f32_32x32x16_bf16 v[192:207], a[96:99], v[68:71], v[192:207]
    buffer_load_dwordx4 v[108:111], v28, s[32:35], s95 offen offset:0 sc1
    v_mfma_f32_32x32x16_bf16 v[208:223], a[100:103], v[68:71], v[208:223]
    s_waitcnt vmcnt(9)
    v_mfma_f32_32x32x16_bf16 v[176:191], a[108:111], v[72:75], v[176:191]
    buffer_load_dwordx4 v[112:115], v28, s[32:35], s94 offen offset:1024 sc1
    s_waitcnt vmcnt(9)
    v_mfma_f32_32x32x16_bf16 v[192:207], a[104:107], v[76:79], v[192:207]
    buffer_load_dwordx4 v[116:119], v28, s[32:35], s95 offen offset:1024 sc1
    v_mfma_f32_32x32x16_bf16 v[208:223], a[108:111], v[76:79], v[208:223]
    s_waitcnt vmcnt(9)
    v_mfma_f32_32x32x16_bf16 v[176:191], a[148:151], v[80:83], v[176:191]
    buffer_load_dwordx4 v[120:123], v28, s[32:35], s94 offen offset:2048 sc1
    s_waitcnt vmcnt(9)
    v_mfma_f32_32x32x16_bf16 v[192:207], a[144:147], v[84:87], v[192:207]
    buffer_load_dwordx4 v[124:127], v28, s[32:35], s95 offen offset:2048 sc1
    v_mfma_f32_32x32x16_bf16 v[208:223], a[148:151], v[84:87], v[208:223]
    s_waitcnt vmcnt(9)
    v_mfma_f32_32x32x16_bf16 v[176:191], a[156:159], v[88:91], v[176:191]
    buffer_load_dwordx2 v[224:225], v4, s[32:35], s90 offen offset:0 sc1
    s_waitcnt vmcnt(9)
    v_mfma_f32_32x32x16_bf16 v[192:207], a[152:155], v[92:95], v[192:207]
    buffer_load_dwordx2 v[226:227], v4, s[32:35], s90 offen offset:256 sc1
    v_mfma_f32_32x32x16_bf16 v[208:223], a[156:159], v[92:95], v[208:223]
    buffer_load_dwordx2 v[228:229], v4, s[32:35], s90 offen offset:512 sc1
    s_waitcnt vmcnt(10)
    v_mfma_f32_32x32x16_bf16 v[176:191], a[164:167], v[96:99], v[176:191]
    buffer_load_dwordx2 v[230:231], v4, s[32:35], s90 offen offset:768 sc1
    s_waitcnt vmcnt(10)
    v_mfma_f32_32x32x16_bf16 v[192:207], a[160:163], v[100:103], v[192:207]
    buffer_load_dwordx2 v[232:233], v4, s[32:35], s90 offen offset:1024 sc1
    v_mfma_f32_32x32x16_bf16 v[208:223], a[164:167], v[100:103], v[208:223]
    buffer_load_dwordx2 v[234:235], v4, s[32:35], s90 offen offset:1280 sc1
    s_waitcnt vmcnt(11)
    v_mfma_f32_32x32x16_bf16 v[176:191], a[204:207], v[104:107], v[176:191]
    buffer_load_dwordx2 v[236:237], v4, s[32:35], s90 offen offset:1536 sc1
    s_waitcnt vmcnt(11)
    v_mfma_f32_32x32x16_bf16 v[192:207], a[200:203], v[108:111], v[192:207]
    v_mfma_f32_32x32x16_bf16 v[208:223], a[204:207], v[108:111], v[208:223]
    s_waitcnt vmcnt(10)
    v_mfma_f32_32x32x16_bf16 v[176:191], a[212:215], v[112:115], v[176:191]
    s_waitcnt vmcnt(9)
    v_mfma_f32_32x32x16_bf16 v[192:207], a[208:211], v[116:119], v[192:207]
    v_mfma_f32_32x32x16_bf16 v[208:223], a[212:215], v[116:119], v[208:223]
    s_waitcnt vmcnt(8)
    v_mfma_f32_32x32x16_bf16 v[176:191], a[220:223], v[120:123], v[176:191]
    s_waitcnt vmcnt(7)
    v_mfma_f32_32x32x16_bf16 v[192:207], a[216:219], v[124:127], v[192:207]
    v_mfma_f32_32x32x16_bf16 v[208:223], a[220:223], v[124:127], v[208:223]
    v_mfma_f32_32x32x16_bf16 v[160:175], a[184:187], v[144:147], v[160:175]
    s_waitcnt vmcnt(5)
    v_add_f32 v224, v224, v226
    v_add_f32 v225, v225, v227
    s_waitcnt vmcnt(4)
    v_add_f32 v224, v224, v228
    v_add_f32 v225, v225, v229
    s_waitcnt vmcnt(3)
    v_add_f32 v224, v224, v230
    v_mfma_f32_32x32x16_bf16 v[160:175], a[192:195], v[152:155], v[160:175]
    v_add_f32 v225, v225, v231
    s_waitcnt vmcnt(2)
    v_add_f32 v224, v224, v232
    v_add_f32 v225, v225, v233
    s_waitcnt vmcnt(1)
    v_add_f32 v224, v224, v234
    v_add_f32 v225, v225, v235
    v_mfma_f32_32x32x16_bf16 v[160:175], a[32:35], v[32:35], v[160:175]
    ds_write_b128 v6, v[176:179] offset:0
    s_waitcnt vmcnt(0)
    v_add_f32 v224, v224, v236
    v_add_f32 v225, v225, v237
    v_mov_b32 v226, v224
    v_mov_b32 v227, v225
    v_mfma_f32_32x32x16_bf16 v[160:175], a[40:43], v[40:43], v[160:175]
    ds_write_b128 v6, v[180:183] offset:1024
    s_nop 0
    v_permlane32_swap_b32 v224, v226
    v_mfma_f32_32x32x16_bf16 v[160:175], a[48:51], v[48:51], v[160:175]
    ds_write_b128 v6, v[184:187] offset:2048
    v_permlane32_swap_b32 v225, v227
    v_add_f32 v224, v224, v226
    v_add_f32 v225, v225, v227
    v_mfma_f32_32x32x16_bf16 v[160:175], a[88:91], v[56:59], v[160:175]
    ds_write_b128 v6, v[188:191] offset:3072
    v_mul_f32 v14, 0xbb124925, v224
    v_mul_f32 v225, 0x3b124925, v225
    v_fma_f32 v225, -v14, v14, v225
    v_max_f32 v225, 0, v225
    v_mfma_f32_32x32x16_bf16 v[160:175], a[96:99], v[64:67], v[160:175]
    ds_write_b128 v7, v[192:195] offset:0
    v_add_f32 v225, 0x3727c5ac, v225
    v_rsq_f32 v15, v225
    v_mfma_f32_32x32x16_bf16 v[160:175], a[104:107], v[72:75], v[160:175]
    ds_write_b128 v7, v[196:199] offset:1024
    v_mfma_f32_32x32x16_bf16 v[160:175], a[144:147], v[80:83], v[160:175]
    ds_write_b128 v7, v[200:203] offset:2048
    v_mfma_f32_32x32x16_bf16 v[160:175], a[152:155], v[88:91], v[160:175]
    ds_write_b128 v7, v[204:207] offset:3072
    v_mfma_f32_32x32x16_bf16 v[160:175], a[160:163], v[96:99], v[160:175]
    ds_write_b128 v8, v[208:211] offset:0
    v_mfma_f32_32x32x16_bf16 v[160:175], a[200:203], v[104:107], v[160:175]
    ds_write_b128 v8, v[212:215] offset:1024
    v_mfma_f32_32x32x16_bf16 v[160:175], a[208:211], v[112:115], v[160:175]
    ds_write_b128 v8, v[216:219] offset:2048
    v_mfma_f32_32x32x16_bf16 v[160:175], a[216:219], v[120:123], v[160:175]
    ds_write_b128 v8, v[220:223] offset:3072
    s_waitcnt lgkmcnt(0)
    s_branch L_padskip9
L_pad9:
    s_setpc_b64 s[98:99]
L_padskip9:
    s_barrier
    ds_read_b128 v[32:35], v9 offset:0
    ds_read_b128 v[48:51], v9 offset:4096
    ds_read_b128 v[64:67], v9 offset:8192
    ds_read_b128 v[36:39], v9 offset:1024
    ds_read_b128 v[52:55], v9 offset:5120
    ds_read_b128 v[68:71], v9 offset:9216
    ds_read_b128 v[40:43], v9 offset:2048
    ds_read_b128 v[56:59], v9 offset:6144
    ds_read_b128 v[72:75], v9 offset:10240
    ds_read_b128 v[44:47], v9 offset:3072
    ds_read_b128 v[60:63], v9 offset:7168
    ds_read_b128 v[76:79], v9 offset:11264
    s_waitcnt lgkmcnt(10)
    v_pk_add_f32 v[32:33], v[32:33], v[48:49]
    s_waitcnt lgkmcnt(9)
    v_pk_add_f32 v[160:161], v[160:161], v[64:65]
    v_pk_add_f32 v[160:161], v[160:161], v[32:33]
    v_pk_add_f32 v[34:35], v[34:35], v[50:51]
    v_pk_add_f32 v[162:163], v[162:163], v[66:67]
    v_pk_add_f32 v[162:163], v[162:163], v[34:35]
    s_waitcnt lgkmcnt(7)
    v_pk_add_f32 v[36:37], v[36:37], v[52:53]
    s_waitcnt lgkmcnt(6)
    v_pk_add_f32 v[164:165], v[164:165], v[68:69]
    v_pk_add_f32 v[164:165], v[164:165], v[36:37]
    v_pk_add_f32 v[38:39], v[38:39], v[54:55]
    v_pk_add_f32 v[166:167], v[166:167], v[70:71]
    v_pk_add_f32 v[166:167], v[166:167], v[38:39]
    s_waitcnt lgkmcnt(4)
    v_pk_add_f32 v[40:41], v[40:41], v[56:57]
    s_waitcnt lgkmcnt(3)
    v_pk_add_f32 v[168:169], v[168:169], v[72:73]
    v_pk_add_f32 v[168:169], v[168:169], v[40:41]
    v_pk_add_f32 v[42:43], v[42:43], v[58:59]
    v_pk_add_f32 v[170:171], v[170:171], v[74:75]
    v_pk_add_f32 v[170:171], v[170:171], v[42:43]
    s_waitcnt lgkmcnt(1)
    v_pk_add_f32 v[44:45], v[44:45], v[60:61]
    s_waitcnt lgkmcnt(0)
    v_pk_add_f32 v[172:173], v[172:173], v[76:77]
    v_pk_add_f32 v[172:173], v[172:173], v[44:45]
    v_pk_add_f32 v[46:47], v[46:47], v[62:63]
    v_pk_add_f32 v[174:175], v[174:175], v[78:79]
    v_pk_add_f32 v[174:175], v[174:175], v[46:47]
    v_pk_fma_f32 v[160:161], v[160:161], v[14:15], v[240:241] op_sel:[0,1,0] op_sel_hi:[1,1,1]
    v_cvt_pk_bf16_f32 v96, v160, v161
    v_pk_fma_f32 v[162:163], v[162:163], v[14:15], v[242:243] op_sel:[0,1,0] op_sel_hi:[1,1,1]
    v_cvt_pk_bf16_f32 v97, v162, v163
    v_pk_fma_f32 v[164:165], v[164:165], v[14:15], v[244:245] op_sel:[0,1,0] op_sel_hi:[1,1,1]
    v_cvt_pk_bf16_f32 v98, v164, v165
    v_pk_fma_f32 v[166:167], v[166:167], v[14:15], v[246:247] op_sel:[0,1,0] op_sel_hi:[1,1,1]
    v_cvt_pk_bf16_f32 v99, v166, v167
    v_pk_fma_f32 v[168:169], v[168:169], v[14:15], v[248:249] op_sel:[0,1,0] op_sel_hi:[1,1,1]
    v_cvt_pk_bf16_f32 v100, v168, v169
    v_pk_fma_f32 v[170:171], v[170:171], v[14:15], v[250:251] op_sel:[0,1,0] op_sel_hi:[1,1,1]
    v_cvt_pk_bf16_f32 v101, v170, v171
    v_pk_fma_f32 v[172:173], v[172:173], v[14:15], v[252:253] op_sel:[0,1,0] op_sel_hi:[1,1,1]
    v_cvt_pk_bf16_f32 v102, v172, v173
    v_pk_fma_f32 v[174:175], v[174:175], v[14:15], v[254:255] op_sel:[0,1,0] op_sel_hi:[1,1,1]
    v_cvt_pk_bf16_f32 v103, v174, v175
    buffer_store_dwordx4 v[96:99], v1, s[32:35], s68 offen offset:0
    buffer_store_dwordx4 v[100:103], v1, s[32:35], s68 offen offset:1024
    v_mov_b32 v24, s57
    v_dot2_f32_bf16 v22, v96, v24, 0
    v_dot2_f32_bf16 v23, v96, v96, 0
    v_dot2_f32_bf16 v22, v97, v24, v22
    v_dot2_f32_bf16 v23, v97, v97, v23
    v_dot2_f32_bf16 v22, v98, v24, v22
    v_dot2_f32_bf16 v23, v98, v98, v23
    v_dot2_f32_bf16 v22, v99, v24, v22
    v_dot2_f32_bf16 v23, v99, v99, v23
    v_dot2_f32_bf16 v22, v100, v24, v22
    v_dot2_f32_bf16 v23, v100, v100, v23
    v_dot2_f32_bf16 v22, v101, v24, v22
    v_dot2_f32_bf16 v23, v101, v101, v23
    v_dot2_f32_bf16 v22, v102, v24, v22
    v_dot2_f32_bf16 v23, v102, v102, v23
    v_dot2_f32_bf16 v22, v103, v24, v22
    v_dot2_f32_bf16 v23, v103, v103, v23
    s_nop 1
    v_mov_b32 v24, v22
    v_mov_b32 v25, v23
    s_nop 0
    v_permlane32_swap_b32 v22, v24
    v_permlane32_swap_b32 v23, v25
    v_add_f32 v22, v22, v24
    v_add_f32 v23, v23, v25
    s_mov_b32 exec_hi, 0
    buffer_store_dwordx2 v[22:23], v3, s[32:35], s69 offen
    s_mov_b64 exec, -1
    s_waitcnt vmcnt(0)
    s_mov_b64 exec, 1
    s_cmp_lg_u32 s50, 0
    s_cbranch_scc0 L_pubslow_61
    buffer_store_dwordx2 v[12:13], off, s[32:35], s70 offset:0
L_pubback_62:
    s_mov_b64 exec, -1
    v_lshlrev_b32 v240, 16, v96
    v_and_b32 v241, 0xffff0000, v96
    v_lshlrev_b32 v242, 16, v97
    v_and_b32 v243, 0xffff0000, v97
    v_lshlrev_b32 v244, 16, v98
    v_and_b32 v245, 0xffff0000, v98
    v_lshlrev_b32 v246, 16, v99
    v_and_b32 v247, 0xffff0000, v99
    v_lshlrev_b32 v248, 16, v100
    v_and_b32 v249, 0xffff0000, v100
    v_lshlrev_b32 v250, 16, v101
    v_and_b32 v251, 0xffff0000, v101
    v_lshlrev_b32 v252, 16, v102
    v_and_b32 v253, 0xffff0000, v102
    v_lshlrev_b32 v254, 16, v103
    v_and_b32 v255, 0xffff0000, v103
L_p5join_51:
    s_add_u32 s47, s47, 2293760
    s_barrier
    s_mul_i32 s88, s52, 128
    s_add_u32 s88, s88, s47
    s_add_u32 s88, s88, 1329152
    s_mov_b64 exec, 0x3fff
    buffer_load_dwordx2 v[30:31], v3, s[32:35], s88 offen offset:0 sc1
    s_mov_b64 exec, -1
    s_add_u32 s63, s47, 1015808
    s_add_u32 s64, s71, 1015808
    s_cmp_lg_u32 s50, 0
    s_cselect_b32 s63, s64, s63
    s_mul_i32 s80, s52, 28672
    s_add_u32 s80, s80, s63
    s_add_u32 s81, s80, 4096
    s_add_u32 s82, s80, 8192
    s_add_u32 s83, s80, 12288
    s_add_u32 s84, s80, 16384
    s_add_u32 s85, s80, 20480
    s_add_u32 s86, s80, 24576
    s_mul_i32 s87, s52, 3584
    s_add_u32 s87, s87, s47
    s_add_u32 s87, s87, 1277952
    s_lshl_b32 s60, s43, 3
    s_add_u32 s60, s60, s52
    s_mul_i32 s89, s60, 4096
    s_add_u32 s89, s89, s47
    s_add_u32 s89, s89, 0
    s_mul_i32 s90, s60, 128
    s_add_u32 s90, s90, s47
    s_add_u32 s90, s90, 1310720
    v_lshrrev_b32 v11, 5, v0
    v_lshlrev_b32 v11, 4, v11
    v_add_u32 v11, 161792, v11
    ds_read_b128 v[192:195], v1 offset:0
    ds_read_b128 v[196:199], v1 offset:28672
    ds_read_b128 v[200:203], v1 offset:1024
    ds_read_b128 v[204:207], v1 offset:29696
    ds_read_b128 v[208:211], v1 offset:2048
    ds_read_b128 v[212:215], v1 offset:30720
    s_branch L_padskip10
L_pad10:
    s_setpc_b64 s[98:99]
L_padskip10:
    s_mov_b64 exec, 0x3fff
    s_mov_b32 s66, 0
L_poll_63:
    buffer_load_dwordx2 v[236:237], v3, s[32:35], s88 offen sc1
    s_add_u32 s66, s66, 1
    s_cmp_gt_u32 s66, 65536
    s_cbranch_scc1 L_pollout_64
    s_waitcnt vmcnt(1)
    v_cmp_ne_u64 vcc, s[48:49], v[30:31]
    s_nop 0
    s_cbranch_vccz L_pollout_64
    buffer_load_dwordx2 v[30:31], v3, s[32:35], s88 offen sc1
    s_waitcnt vmcnt(1)
    v_cmp_ne_u64 vcc, s[48:49], v[236:237]
    s_nop 0
    s_cbranch_vccnz L_poll_63
L_pollout_64:
    s_mov_b64 exec, -1
    s_cmp_lg_u32 s50, 0
    s_cbranch_scc0 L_acq_65
L_acqback_66:
    buffer_load_dwordx4 v[32:35], v1, s[32:35], s80 offen offset:0 sc1
    buffer_load_dwordx4 v[36:39], v1, s[32:35], s80 offen offset:1024 sc1
    buffer_load_dwordx4 v[40:43], v1, s[32:35], s80 offen offset:2048 sc1
    buffer_load_dwordx4 v[44:47], v1, s[32:35], s80 offen offset:3072 sc1
    buffer_load_dwordx4 v[48:51], v1, s[32:35], s81 offen offset:0 sc1
    buffer_load_dwordx4 v[52:55], v1, s[32:35], s81 offen offset:1024 sc1
    buffer_load_dwordx4 v[56:59], v1, s[32:35], s81 offen offset:2048 sc1
    buffer_load_dwordx4 v[60:63], v1, s[32:35], s81 offen offset:3072 sc1
    s_mul_i32 s60, s44, 7168
    v_add_u32 v238, s60, v2
    s_waitcnt vmcnt(7) lgkmcnt(4)
    v_mfma_f32_32x32x16_bf16 v[144:159], v[192:195], v[32:35], 0
    ds_read_b128 v[216:219], v1 offset:3072
    buffer_load_dwordx4 v[64:67], v1, s[32:35], s82 offen offset:0 sc1
    v_mfma_f32_32x32x16_bf16 v[160:175], v[196:199], v[32:35], 0
    ds_read_b128 v[220:223], v1 offset:31744
    s_waitcnt vmcnt(7) lgkmcnt(4)
    v_mfma_f32_32x32x16_bf16 v[144:159], v[200:203], v[36:39], v[144:159]
    ds_read_b128 v[192:195], v1 offset:4096
    buffer_load_dwordx4 v[68:71], v1, s[32:35], s82 offen offset:1024 sc1
    v_mfma_f32_32x32x16_bf16 v[160:175], v[204:207], v[36:39], v[160:175]
    ds_read_b128 v[196:199], v1 offset:32768
    ds_write_b128 v238, a[224:227] offset:0
    s_waitcnt vmcnt(7) lgkmcnt(5)
    v_mfma_f32_32x32x16_bf16 v[144:159], v[208:211], v[40:43], v[144:159]
    ds_read_b128 v[200:203], v1 offset:5120
    buffer_load_dwordx4 v[72:75], v1, s[32:35], s82 offen offset:2048 sc1
    v_mfma_f32_32x32x16_bf16 v[160:175], v[212:215], v[40:43], v[160:175]
    ds_read_b128 v[204:207], v1 offset:33792
    s_waitcnt vmcnt(7) lgkmcnt(5)
    v_mfma_f32_32x32x16_bf16 v[144:159], v[216:219], v[44:47], v[144:159]
    ds_read_b128 v[208:211], v1 offset:6144
    buffer_load_dwordx4 v[76:79], v1, s[32:35], s82 offen offset:3072 sc1
    v_mfma_f32_32x32x16_bf16 v[160:175], v[220:223], v[44:47], v[160:175]
    ds_read_b128 v[212:215], v1 offset:34816
    ds_write_b128 v238, a[228:231] offset:1024
    s_waitcnt vmcnt(7) lgkmcnt(6)
    v_mfma_f32_32x32x16_bf16 v[144:159], v[192:195], v[48:51], v[144:159]
    ds_read_b128 v[216:219], v1 offset:7168
    buffer_load_dwordx4 v[80:83], v1, s[32:35], s83 offen offset:0 sc1
    v_mfma_f32_32x32x16_bf16 v[160:175], v[196:199], v[48:51], v[160:175]
    ds_read_b128 v[220:223], v1 offset:35840
    s_waitcnt vmcnt(7) lgkmcnt(5)
    v_mfma_f32_32x32x16_bf16 v[144:159], v[200:203], v[52:55], v[144:159]
    ds_read_b128 v[192:195], v1 offset:8192
    buffer_load_dwordx4 v[84:87], v1, s[32:35], s83 offen offset:1024 sc1
    v_mfma_f32_32x32x16_bf16 v[160:175], v[204:207], v[52:55], v[160:175]
    ds_read_b128 v[196:199], v1 offset:36864
    ds_write_b128 v238, a[232:235] offset:2048
    s_waitcnt vmcnt(7) lgkmcnt(6)
    v_mfma_f32_32x32x16_bf16 v[144:159], v[208:211], v[56:59], v[144:159]
    ds_read_b128 v[200:203], v1 offset:9216
    buffer_load_dwordx4 v[88:91], v1, s[32:35], s83 offen offset:2048 sc1
    v_mfma_f32_32x32x16_bf16 v[160:175], v[212:215], v[56:59], v[160:175]
    ds_read_b128 v[204:207], v1 offset:37888
    s_waitcnt vmcnt(7) lgkmcnt(5)
    v_mfma_f32_32x32x16_bf16 v[144:159], v[216:219], v[60:63], v[144:159]
    ds_read_b128 v[208:211], v1 offset:10240
    buffer_load_dwordx4 v[92:95], v1, s[32:35], s83 offen offset:3072 sc1
    v_mfma_f32_32x32x16_bf16 v[160:175], v[220:223], v[60:63], v[160:175]
    ds_read_b128 v[212:215], v1 offset:38912
    ds_write_b128 v238, a[236:239] offset:3072
    s_waitcnt vmcnt(7) lgkmcnt(6)
    v_mfma_f32_32x32x16_bf16 v[144:159], v[192:195], v[64:67], v[144:159]
    ds_read_b128 v[216:219], v1 offset:11264
    buffer_load_dwordx4 v[96:99], v1, s[32:35], s84 offen offset:0 sc1
    v_mfma_f32_32x32x16_bf16 v[160:175], v[196:199], v[64:67], v[160:175]
    ds_read_b128 v[220:223], v1 offset:39936
    s_waitcnt vmcnt(7) lgkmcnt(5)
    v_mfma_f32_32x32x16_bf16 v[144:159], v[200:203], v[68:71], v[144:159]
    ds_read_b128 v[192:195], v1 offset:12288
    buffer_load_dwordx4 v[100:103], v1, s[32:35], s84 offen offset:1024 sc1
    v_mfma_f32_32x32x16_bf16 v[160:175], v[204:207], v[68:71], v[160:175]
    ds_read_b128 v[196:199], v1 offset:40960
    ds_write_b128 v238, a[240:243] offset:4096
    s_waitcnt vmcnt(7) lgkmcnt(6)
    v_mfma_f32_32x32x16_bf16 v[144:159], v[208:211], v[72:75], v[144:159]
    ds_read_b128 v[200:203], v1 offset:13312
    buffer_load_dwordx4 v[104:107], v1, s[32:35], s84 offen offset:2048 sc1
    v_mfma_f32_32x32x16_bf16 v[160:175], v[212:215], v[72:75], v[160:175]
    ds_read_b128 v[204:207], v1 offset:41984
    s_waitcnt vmcnt(7) lgkmcnt(5)
    v_mfma_f32_32x32x16_bf16 v[144:159], v[216:219], v[76:79], v[144:159]
    ds_read_b128 v[208:211], v1 offset:14336
    buffer_load_dwordx4 v[108:111], v1, s[32:35], s84 offen offset:3072 sc1
    v_mfma_f32_32x32x16_bf16 v[160:175], v[220:223], v[76:79], v[160:175]
    ds_read_b128 v[212:215], v1 offset:43008
    ds_write_b128 v238, a[244:247] offset:5120
    s_waitcnt vmcnt(7) lgkmcnt(6)
    v_mfma_f32_32x32x16_bf16 v[144:159], v[192:195], v[80:83], v[144:159]
    ds_read_b128 v[216:219], v1 offset:15360
    buffer_load_dwordx4 v[112:115], v1, s[32:35], s85 offen offset:0 sc1
    v_mfma_f32_32x32x16_bf16 v[160:175], v[196:199], v[80:83], v[160:175]
    ds_read_b128 v[220:223], v1 offset:44032
    s_waitcnt vmcnt(7) lgkmcnt(5)
    v_mfma_f32_32x32x16_bf16 v[144:159], v[200:203], v[84:87], v[144:159]
    ds_read_b128 v[192:195], v1 offset:16384
    buffer_load_dwordx4 v[116:119], v1, s[32:35], s85 offen offset:1024 sc1
    v_mfma_f32_32x32x16_bf16 v[160:175], v[204:207], v[84:87], v[160:175]
    ds_read_b128 v[196:199], v1 offset:45056
    buffer_load_dwordx2 v[224:225], v4, s[32:35], s87 offen offset:0 sc1
    ds_write_b128 v238, a[248:251] offset:6144
    s_waitcnt vmcnt(8) lgkmcnt(6)
    v_mfma_f32_32x32x16_bf16 v[144:159], v[208:211], v[88:91], v[144:159]
    ds_read_b128 v[200:203], v1 offset:17408
    buffer_load_dwordx4 v[120:123], v1, s[32:35], s85 offen offset:2048 sc1
    v_mfma_f32_32x32x16_bf16 v[160:175], v[212:215], v[88:91], v[160:175]
    ds_read_b128 v[204:207], v1 offset:46080
    buffer_load_dwordx2 v[226:227], v4, s[32:35], s87 offen offset:256 sc1
    s_waitcnt vmcnt(9) lgkmcnt(5)
    v_mfma_f32_32x32x16_bf16 v[144:159], v[216:219], v[92:95], v[144:159]
    ds_read_b128 v[208:211], v1 offset:18432
    buffer_load_dwordx4 v[124:127], v1, s[32:35], s85 offen offset:3072 sc1
    s_mov_b32 s79, 0
    s_lshl_b32 s60, s44, 1
    s_add_u32 s60, s60, 0
    s_lshl_b32 s93, s60, 12
    v_mfma_f32_32x32x16_bf16 v[160:175], v[220:223], v[92:95], v[160:175]
    ds_read_b128 v[212:215], v1 offset:47104
    buffer_load_dwordx2 v[228:229], v4, s[32:35], s87 offen offset:512 sc1
    s_add_u32 s93, s93, 112640
    s_lshl_b32 s61, s42, 2
    s_add_u32 s60, s60, s61
    s_waitcnt vmcnt(10) lgkmcnt(5)
    v_mfma_f32_32x32x16_bf16 v[144:159], v[192:195], v[96:99], v[144:159]
    ds_read_b128 v[216:219], v1 offset:19456
    buffer_load_dwordx4 v[128:131], v1, s[32:35], s86 offen offset:0 sc1
    s_cmp_lt_u32 s60, 8
    s_cselect_b32 s61, 4587520, 0
    s_sub_u32 s61, s47, s61
    s_and_b32 s60, s60, 7
    v_mfma_f32_32x32x16_bf16 v[160:175], v[196:199], v[96:99], v[160:175]
    ds_read_b128 v[220:223], v1 offset:48128
    buffer_load_dwordx2 v[230:231], v4, s[32:35], s87 offen offset:768 sc1
    s_waitcnt vmcnt(11) lgkmcnt(4)
    v_mfma_f32_32x32x16_bf16 v[144:159], v[200:203], v[100:103], v[144:159]
    ds_read_b128 v[192:195], v1 offset:20480
    buffer_load_dwordx4 v[132:135], v1, s[32:35], s86 offen offset:1024 sc1
    s_cmp_lt_i32 s61, 6291456
    s_cselect_b32 s62, 1, 0
    s_cselect_b32 s61, s47, s61
    s_cselect_b32 s60, s52, s60
    v_mfma_f32_32x32x16_bf16 v[160:175], v[204:207], v[100:103], v[160:175]
    ds_read_b128 v[196:199], v1 offset:49152
    buffer_load_dwordx2 v[232:233], v4, s[32:35], s87 offen offset:1024 sc1
    s_or_b32 s79, s79, s62
    s_lshl_b32 s62, s43, 3
    s_add_u32 s60, s60, s62
    s_waitcnt vmcnt(12) lgkmcnt(4)
    v_mfma_f32_32x32x16_bf16 v[144:159], v[208:211], v[104:107], v[144:159]
    ds_read_b128 v[200:203], v1 offset:21504
    buffer_load_dwordx4 v[136:139], v1, s[32:35], s86 offen offset:2048 sc1
    s_lshl_b32 s91, s60, 12
    s_add_u32 s91, s91, s61
    s_lshl_b32 s60, s60, 7
    s_add_u32 s60, s60, s61
    v_mfma_f32_32x32x16_bf16 v[160:175], v[212:215], v[104:107], v[160:175]
    ds_read_b128 v[204:207], v1 offset:50176
    buffer_load_dwordx2 v[234:235], v4, s[32:35], s87 offen offset:1280 sc1
    s_add_u32 s95, s60, 1310720
    s_lshl_b32 s60, s44, 1
    s_add_u32 s60, s60, 1
    s_waitcnt vmcnt(13) lgkmcnt(4)
    v_mfma_f32_32x32x16_bf16 v[144:159], v[216:219], v[108:111], v[144:159]
    ds_read_b128 v[208:211], v1 offset:22528
    buffer_load_dwordx4 v[140:143], v1, s[32:35], s86 offen offset:3072 sc1
    s_lshl_b32 s94, s60, 12
    s_add_u32 s94, s94, 112640
    s_lshl_b32 s61, s42, 2
    s_add_u32 s60, s60, s61
    v_mfma_f32_32x32x16_bf16 v[160:175], v[220:223], v[108:111], v[160:175]
    ds_read_b128 v[212:215], v1 offset:51200
    buffer_load_dwordx2 v[236:237], v4, s[32:35], s87 offen offset:1536 sc1
    s_cmp_lt_u32 s60, 8
    s_cselect_b32 s61, 4587520, 0
    s_sub_u32 s61, s47, s61
    s_waitcnt vmcnt(14) lgkmcnt(4)
    v_mfma_f32_32x32x16_bf16 v[144:159], v[192:195], v[112:115], v[144:159]
    ds_read_b128 v[216:219], v1 offset:23552
    s_and_b32 s60, s60, 7
    s_cmp_lt_i32 s61, 6291456
    s_cselect_b32 s62, 2, 0
    s_cselect_b32 s61, s47, s61
    s_cselect_b32 s60, s52, s60
    v_mfma_f32_32x32x16_bf16 v[160:175], v[196:199], v[112:115], v[160:175]
    ds_read_b128 v[220:223], v1 offset:52224
    s_or_b32 s79, s79, s62
    s_lshl_b32 s62, s43, 3
    s_add_u32 s60, s60, s62
    s_lshl_b32 s92, s60, 12
    s_waitcnt vmcnt(13) lgkmcnt(4)
    v_mfma_f32_32x32x16_bf16 v[144:159], v[200:203], v[116:119], v[144:159]
    ds_read_b128 v[192:195], v1 offset:24576
    s_add_u32 s92, s92, s61
    s_lshl_b32 s60, s60, 7
    s_add_u32 s60, s60, s61
    s_add_u32 s78, s60, 1310720
    ds_read_b128 v[176:179], v11 offset:128
    v_mfma_f32_32x32x16_bf16 v[160:175], v[204:207], v[116:119], v[160:175]
    ds_read_b128 v[196:199], v1 offset:53248
    ds_read_b128 v[180:183], v11 offset:160
    ds_read_b128 v[184:187], v11 offset:192
    ds_read_b128 v[188:191], v11 offset:224
    ds_read_b128 v[16:19], v11 offset:0
    s_waitcnt vmcnt(11) lgkmcnt(9)
    v_mfma_f32_32x32x16_bf16 v[144:159], v[208:211], v[120:123], v[144:159]
    ds_read_b128 v[200:203], v1 offset:25600
    ds_read_b128 v[20:23], v11 offset:32
    ds_read_b128 v[24:27], v11 offset:64
    ds_read_b128 v[28:31], v11 offset:96
    s_waitcnt vmcnt(10)
    v_add_f32 v224, v224, v226
    v_add_f32 v225, v225, v227
    v_mfma_f32_32x32x16_bf16 v[160:175], v[212:215], v[120:123], v[160:175]
    ds_read_b128 v[204:207], v1 offset:54272
    s_waitcnt vmcnt(8)
    v_add_f32 v224, v224, v228
    v_add_f32 v225, v225, v229
    s_waitcnt vmcnt(6)
    v_add_f32 v224, v224, v230
    v_add_f32 v225, v225, v231
    s_waitcnt lgkmcnt(12)
    v_mfma_f32_32x32x16_bf16 v[144:159], v[216:219], v[124:127], v[144:159]
    ds_read_b128 v[208:211], v1 offset:26624
    s_waitcnt vmcnt(4)
    v_add_f32 v224, v224, v232
    v_add_f32 v225, v225, v233
    s_waitcnt vmcnt(2)
    v_add_f32 v224, v224, v234
    v_add_f32 v225, v225, v235
    s_waitcnt vmcnt(0)
    v_add_f32 v224, v224, v236
    v_mfma_f32_32x32x16_bf16 v[160:175], v[220:223], v[124:127], v[160:175]
    ds_read_b128 v[212:215], v1 offset:55296
    v_add_f32 v225, v225, v237
    v_mov_b32 v226, v224
    v_mov_b32 v227, v225
    s_nop 0
    s_waitcnt lgkmcnt(11)
    v_mfma_f32_32x32x16_bf16 v[144:159], v[192:195], v[128:131], v[144:159]
    ds_read_b128 v[216:219], v1 offset:27648
    v_permlane32_swap_b32 v224, v226
    v_permlane32_swap_b32 v225, v227
    v_add_f32 v224, v224, v226
    v_mfma_f32_32x32x16_bf16 v[160:175], v[196:199], v[128:131], v[160:175]
    ds_read_b128 v[220:223], v1 offset:56320
    v_add_f32 v225, v225, v227
    v_mul_f32 v14, 0xbb124925, v224
    v_mul_f32 v225, 0x3b124925, v225
    v_fma_f32 v225, -v14, v14, v225
    s_waitcnt lgkmcnt(4)
    v_mfma_f32_32x32x16_bf16 v[144:159], v[200:203], v[132:135], v[144:159]
    v_max_f32 v225, 0, v225
    v_add_f32 v225, 0x3727c5ac, v225
    v_rsq_f32 v15, v225
    v_mfma_f32_32x32x16_bf16 v[160:175], v[204:207], v[132:135], v[160:175]
    s_waitcnt lgkmcnt(2)
    v_mfma_f32_32x32x16_bf16 v[144:159], v[208:211], v[136:139], v[144:159]
    v_mfma_f32_32x32x16_bf16 v[160:175], v[212:215], v[136:139], v[160:175]
    s_waitcnt lgkmcnt(0)
    v_mfma_f32_32x32x16_bf16 v[144:159], v[216:219], v[140:143], v[144:159]
    v_mfma_f32_32x32x16_bf16 v[160:175], v[220:223], v[140:143], v[160:175]
    s_nop 10
    v_pk_fma_f32 v[144:145], v[16:17], v[14:15], v[144:145] op_sel:[0,0,0] op_sel_hi:[1,0,1]
    v_pk_fma_f32 v[146:147], v[18:19], v[14:15], v[146:147] op_sel:[0,0,0] op_sel_hi:[1,0,1]
    v_pk_fma_f32 v[148:149], v[20:21], v[14:15], v[148:149] op_sel:[0,0,0] op_sel_hi:[1,0,1]
    v_pk_fma_f32 v[150:151], v[22:23], v[14:15], v[150:151] op_sel:[0,0,0] op_sel_hi:[1,0,1]
    v_pk_fma_f32 v[152:153], v[24:25], v[14:15], v[152:153] op_sel:[0,0,0] op_sel_hi:[1,0,1]
    v_pk_fma_f32 v[154:155], v[26:27], v[14:15], v[154:155] op_sel:[0,0,0] op_sel_hi:[1,0,1]
    v_pk_fma_f32 v[156:157], v[28:29], v[14:15], v[156:157] op_sel:[0,0,0] op_sel_hi:[1,0,1]
    v_pk_fma_f32 v[158:159], v[30:31], v[14:15], v[158:159] op_sel:[0,0,0] op_sel_hi:[1,0,1]
    v_pk_mul_f32 v[144:145], v[144:145], v[14:15] op_sel:[0,1] op_sel_hi:[1,1]
    v_cvt_pk_bf16_f32 v16, v144, v145
    v_pk_mul_f32 v[146:147], v[146:147], v[14:15] op_sel:[0,1] op_sel_hi:[1,1]
    v_cvt_pk_bf16_f32 v17, v146, v147
    v_pk_mul_f32 v[148:149], v[148:149], v[14:15] op_sel:[0,1] op_sel_hi:[1,1]
    v_cvt_pk_bf16_f32 v18, v148, v149
    v_pk_mul_f32 v[150:151], v[150:151], v[14:15] op_sel:[0,1] op_sel_hi:[1,1]
    v_cvt_pk_bf16_f32 v19, v150, v151
    v_pk_mul_f32 v[152:153], v[152:153], v[14:15] op_sel:[0,1] op_sel_hi:[1,1]
    v_cvt_pk_bf16_f32 v20, v152, v153
    v_pk_mul_f32 v[154:155], v[154:155], v[14:15] op_sel:[0,1] op_sel_hi:[1,1]
    v_cvt_pk_bf16_f32 v21, v154, v155
    v_pk_mul_f32 v[156:157], v[156:157], v[14:15] op_sel:[0,1] op_sel_hi:[1,1]
    v_cvt_pk_bf16_f32 v22, v156, v157
    v_pk_mul_f32 v[158:159], v[158:159], v[14:15] op_sel:[0,1] op_sel_hi:[1,1]
    v_cvt_pk_bf16_f32 v23, v158, v159
    s_mov_b32 exec_lo, 0
    v_mov_b32 v22, 0x3f803f80
    v_mov_b32 v23, 0x3f80
    s_mov_b64 exec, -1
    buffer_store_dwordx4 v[16:19], v1, s[32:35], s89 offen offset:0 sc1
    buffer_store_dwordx4 v[20:23], v1, s[32:35], s89 offen offset:1024 sc1
    v_pk_fma_f32 v[160:161], v[176:177], v[14:15], v[160:161] op_sel:[0,0,0] op_sel_hi:[1,0,1]
    v_pk_fma_f32 v[162:163], v[178:179], v[14:15], v[162:163] op_sel:[0,0,0] op_sel_hi:[1,0,1]
    v_pk_fma_f32 v[164:165], v[180:181], v[14:15], v[164:165] op_sel:[0,0,0] op_sel_hi:[1,0,1]
    v_pk_fma_f32 v[166:167], v[182:183], v[14:15], v[166:167] op_sel:[0,0,0] op_sel_hi:[1,0,1]
    v_pk_fma_f32 v[168:169], v[184:185], v[14:15], v[168:169] op_sel:[0,0,0] op_sel_hi:[1,0,1]
    v_pk_fma_f32 v[170:171], v[186:187], v[14:15], v[170:171] op_sel:[0,0,0] op_sel_hi:[1,0,1]
    v_pk_fma_f32 v[172:173], v[188:189], v[14:15], v[172:173] op_sel:[0,0,0] op_sel_hi:[1,0,1]
    v_pk_fma_f32 v[174:175], v[190:191], v[14:15], v[174:175] op_sel:[0,0,0] op_sel_hi:[1,0,1]
    v_pk_mul_f32 v[160:161], v[160:161], v[14:15] op_sel:[0,1] op_sel_hi:[1,1]
    v_cvt_pk_bf16_f32 v24, v160, v161
    v_pk_mul_f32 v[162:163], v[162:163], v[14:15] op_sel:[0,1] op_sel_hi:[1,1]
    v_cvt_pk_bf16_f32 v25, v162, v163
    v_pk_mul_f32 v[164:165], v[164:165], v[14:15] op_sel:[0,1] op_sel_hi:[1,1]
    v_cvt_pk_bf16_f32 v26, v164, v165
    v_pk_mul_f32 v[166:167], v[166:167], v[14:15] op_sel:[0,1] op_sel_hi:[1,1]
    v_cvt_pk_bf16_f32 v27, v166, v167
    v_pk_mul_f32 v[168:169], v[168:169], v[14:15] op_sel:[0,1] op_sel_hi:[1,1]
    v_cvt_pk_bf16_f32 v28, v168, v169
    v_pk_mul_f32 v[170:171], v[170:171], v[14:15] op_sel:[0,1] op_sel_hi:[1,1]
    v_cvt_pk_bf16_f32 v29, v170, v171
    v_pk_mul_f32 v[172:173], v[172:173], v[14:15] op_sel:[0,1] op_sel_hi:[1,1]
    v_cvt_pk_bf16_f32 v30, v172, v173
    v_pk_mul_f32 v[174:175], v[174:175], v[14:15] op_sel:[0,1] op_sel_hi:[1,1]
    v_cvt_pk_bf16_f32 v31, v174, v175
    s_mov_b32 exec_lo, 0
    v_mov_b32 v30, 0x3f80
    v_mov_b32 v31, 0x0
    s_mov_b64 exec, -1
    buffer_store_dwordx4 v[24:27], v1, s[32:35], s89 offen offset:2048 sc1
    buffer_store_dwordx4 v[28:31], v1, s[32:35], s89 offen offset:3072 sc1
    s_barrier
    ds_read_b128 v[192:195], v2 offset:0
    ds_read_b128 v[196:199], v2 offset:1024
    ds_read_b128 v[200:203], v2 offset:2048
    ds_read_b128 v[204:207], v2 offset:3072
    ds_read_b128 v[208:211], v2 offset:4096
    ds_read_b128 v[212:215], v2 offset:5120
    s_waitcnt lgkmcnt(4)
    v_mfma_f32_32x32x16_bf16 v[176:191], v[192:195], v[32:35], 0
    ds_read_b128 v[216:219], v2 offset:6144
    s_lshl_b32 s60, s44, 12
    s_add_u32 s60, s60, 145408
    v_add_u32 v224, s60, v1
    v_mfma_f32_32x32x16_bf16 v[176:191], v[196:199], v[36:39], v[176:191]
    ds_read_b128 v[220:223], v2 offset:7168
    ds_write_b128 v224, v[16:19]
    ds_write_b128 v224, v[20:23] offset:1024
    v_and_b32 v225, 31, v0
    v_lshlrev_b32 v225, 6, v225
    s_waitcnt lgkmcnt(6)
    v_mfma_f32_32x32x16_bf16 v[176:191], v[200:203], v[40:43], v[176:191]
    ds_read_b128 v[192:195], v2 offset:8192
    v_lshrrev_b32 v224, 5, v0
    v_lshl_add_u32 v225, v224, 4, v225
    v_add_u32 v224, s60, v225
    v_mfma_f32_32x32x16_bf16 v[176:191], v[204:207], v[44:47], v[176:191]
    ds_read_b128 v[196:199], v2 offset:9216
    ds_write_b128 v224, v[24:27] offset:2048
    ds_write_b128 v224, v[28:31] offset:2080
    v_mul_f32 v15, 0x3e8b97f6, v15
    v_and_b32 v238, 31, v0
    s_waitcnt lgkmcnt(8)
    v_mfma_f32_32x32x16_bf16 v[176:191], v[208:211], v[48:51], v[176:191]
    ds_read_b128 v[200:203], v2 offset:10240
    v_lshrrev_b32 v239, 5, v0
    v_lshlrev_b32 v239, 2, v239
    v_sub_u32 v238, v238, v239
    v_mov_b32 v239, 0xf149f2ca
    v_mfma_f32_32x32x16_bf16 v[176:191], v[212:215], v[52:55], v[176:191]
    ds_read_b128 v[204:207], v2 offset:11264
    v_cmp_le_i32 vcc, 0, v238
    v_cmp_le_i32 s[4:5], 1, v238
    s_nop 0
    v_cndmask_b32_e64 v160, v239, 0, vcc
    v_cndmask_b32_e64 v161, v239, 0, s[4:5]
    s_waitcnt lgkmcnt(8)
    v_mfma_f32_32x32x16_bf16 v[176:191], v[216:219], v[56:59], v[176:191]
    ds_read_b128 v[208:211], v2 offset:12288
    v_cndmask_b32_e64 v144, 0, v239, vcc
    v_cndmask_b32_e64 v145, 0, v239, s[4:5]
    v_cmp_le_i32 vcc, 2, v238
    v_cmp_le_i32 s[4:5], 3, v238
    s_nop 0
    v_cndmask_b32_e64 v162, v239, 0, vcc
    v_mfma_f32_32x32x16_bf16 v[176:191], v[220:223], v[60:63], v[176:191]
    ds_read_b128 v[212:215], v2 offset:13312
    v_cndmask_b32_e64 v163, v239, 0, s[4:5]
    v_cndmask_b32_e64 v146, 0, v239, vcc
    v_cndmask_b32_e64 v147, 0, v239, s[4:5]
    s_waitcnt lgkmcnt(6)
    v_mfma_f32_32x32x16_bf16 v[176:191], v[192:195], v[64:67], v[176:191]
    ds_read_b128 v[216:219], v2 offset:14336
    v_cmp_le_i32 vcc, 8, v238
    v_cmp_le_i32 s[4:5], 9, v238
    s_nop 0
    v_cndmask_b32_e64 v164, v239, 0, vcc
    v_cndmask_b32_e64 v165, v239, 0, s[4:5]
    v_cndmask_b32_e64 v148, 0, v239, vcc
    v_mfma_f32_32x32x16_bf16 v[176:191], v[196:199], v[68:71], v[176:191]
    ds_read_b128 v[220:223], v2 offset:15360
    v_cndmask_b32_e64 v149, 0, v239, s[4:5]
    v_cmp_le_i32 vcc, 10, v238
    v_cmp_le_i32 s[4:5], 11, v238
    s_nop 0
    v_cndmask_b32_e64 v166, v239, 0, vcc
    s_waitcnt lgkmcnt(4)
    v_mfma_f32_32x32x16_bf16 v[176:191], v[200:203], v[72:75], v[176:191]
    ds_read_b128 v[192:195], v2 offset:16384
    v_cndmask_b32_e64 v167, v239, 0, s[4:5]
    v_cndmask_b32_e64 v150, 0, v239, vcc
    v_cndmask_b32_e64 v151, 0, v239, s[4:5]
    v_cmp_le_i32 vcc, 16, v238
    v_cmp_le_i32 s[4:5], 17, v238
    v_mfma_f32_32x32x16_bf16 v[176:191], v[204:207], v[76:79], v[176:191]
    ds_read_b128 v[196:199], v2 offset:17408
    v_cndmask_b32_e64 v168, v239, 0, vcc
    v_cndmask_b32_e64 v169, v239, 0, s[4:5]
    v_cndmask_b32_e64 v152, 0, v239, vcc
    v_cndmask_b32_e64 v153, 0, v239, s[4:5]
    s_waitcnt lgkmcnt(4)
    v_mfma_f32_32x32x16_bf16 v[176:191], v[208:211], v[80:83], v[176:191]
    ds_read_b128 v[200:203], v2 offset:18432
    v_cmp_le_i32 vcc, 18, v238
    v_cmp_le_i32 s[4:5], 19, v238
    s_nop 0
    v_cndmask_b32_e64 v170, v239, 0, vcc
    v_cndmask_b32_e64 v171, v239, 0, s[4:5]
    v_cndmask_b32_e64 v154, 0, v239, vcc
    v_mfma_f32_32x32x16_bf16 v[176:191], v[212:215], v[84:87], v[176:191]
    ds_read_b128 v[204:207], v2 offset:19456
    v_cndmask_b32_e64 v155, 0, v239, s[4:5]
    v_cmp_le_i32 vcc, 24, v238
    v_cmp_le_i32 s[4:5], 25, v238
    s_nop 0
    v_cndmask_b32_e64 v172, v239, 0, vcc
    s_waitcnt lgkmcnt(4)
    v_mfma_f32_32x32x16_bf16 v[176:191], v[216:219], v[88:91], v[176:191]
    ds_read_b128 v[208:211], v2 offset:20480
    v_cndmask_b32_e64 v173, v239, 0, s[4:5]
    v_cndmask_b32_e64 v156, 0, v239, vcc
    v_cndmask_b32_e64 v157, 0, v239, s[4:5]
    v_cmp_le_i32 vcc, 26, v238
    v_cmp_le_i32 s[4:5], 27, v238
    v_mfma_f32_32x32x16_bf16 v[176:191], v[220:223], v[92:95], v[176:191]
    ds_read_b128 v[212:215], v2 offset:21504
    v_cndmask_b32_e64 v174, v239, 0, vcc
    v_cndmask_b32_e64 v175, v239, 0, s[4:5]
    v_cndmask_b32_e64 v158, 0, v239, vcc
    v_cndmask_b32_e64 v159, 0, v239, s[4:5]
    s_waitcnt lgkmcnt(4)
    v_mfma_f32_32x32x16_bf16 v[176:191], v[192:195], v[96:99], v[176:191]
    ds_read_b128 v[216:219], v2 offset:22528
    ds_read_b128 v[224:227], v11 offset:256
    ds_read_b128 v[228:231], v11 offset:288
    ds_read_b128 v[232:235], v11 offset:320
    ds_read_b128 v[236:239], v11 offset:352
    v_mfma_f32_32x32x16_bf16 v[176:191], v[196:199], v[100:103], v[176:191]
    ds_read_b128 v[220:223], v2 offset:23552
    s_waitcnt lgkmcnt(8)
    v_mfma_f32_32x32x16_bf16 v[176:191], v[200:203], v[104:107], v[176:191]
    ds_read_b128 v[192:195], v2 offset:24576
    v_mfma_f32_32x32x16_bf16 v[176:191], v[204:207], v[108:111], v[176:191]
    ds_read_b128 v[196:199], v2 offset:25600
    s_waitcnt lgkmcnt(8)
    v_mfma_f32_32x32x16_bf16 v[176:191], v[208:211], v[112:115], v[176:191]
    ds_read_b128 v[200:203], v2 offset:26624
    v_mfma_f32_32x32x16_bf16 v[176:191], v[212:215], v[116:119], v[176:191]
    ds_read_b128 v[204:207], v2 offset:27648
    s_waitcnt lgkmcnt(4)
    v_mfma_f32_32x32x16_bf16 v[176:191], v[216:219], v[120:123], v[176:191]
    s_waitcnt vmcnt(0)
    s_mov_b64 exec, 1
    buffer_store_dwordx2 v[12:13], off, s[32:35], s90 sc1
    s_mov_b64 exec, -1
    v_mfma_f32_32x32x16_bf16 v[176:191], v[220:223], v[124:127], v[176:191]
    s_waitcnt lgkmcnt(2)
    v_mfma_f32_32x32x16_bf16 v[176:191], v[192:195], v[128:131], v[176:191]
    v_mfma_f32_32x32x16_bf16 v[176:191], v[196:199], v[132:135], v[176:191]
    s_waitcnt lgkmcnt(0)
    v_mfma_f32_32x32x16_bf16 v[176:191], v[200:203], v[136:139], v[176:191]
    v_mfma_f32_32x32x16_bf16 v[176:191], v[204:207], v[140:143], v[176:191]
    v_bfe_u32 v16, v0, 1, 1
    v_lshlrev_b32 v16, 10, v16
    v_and_b32 v17, 1, v0
    v_lshl_add_u32 v16, v17, 9, v16
    v_lshrrev_b32 v17, 2, v0
    v_lshl_add_u32 v16, v17, 4, v16
    s_waitcnt lgkmcnt(0)
    s_mov_b32 s66, 0
L_kvpoll_67:
    s_buffer_load_dwordx2 s[72:73], s[32:35], s95 glc
    s_buffer_load_dwordx2 s[74:75], s[32:35], s78 glc
    s_add_u32 s66, s66, 1
    s_cmp_gt_u32 s66, 65536
    s_cbranch_scc1 L_kvpollout_68
    s_waitcnt lgkmcnt(0)
    s_cmp_eq_u64 s[72:73], s[48:49]
    s_cbranch_scc0 L_kvpoll_67
    s_cmp_eq_u64 s[74:75], s[48:49]
    s_cbranch_scc0 L_kvpoll_67
L_kvpollout_68:
    s_bitcmp1_b32 s79, 0
    s_cbranch_scc1 L_null_69
    s_mov_b32 m0, s93
    s_sub_u32 s65, s91, 768
    buffer_load_dwordx4 v1, s[32:35], s91 offen sc1 lds
    buffer_load_dwordx4 v1, s[32:35], s91 offen offset:1024 sc1 lds
    buffer_load_dwordx4 v16, s[32:35], s91 offen offset:2048 sc1 lds
    buffer_load_dwordx4 v16, s[32:35], s65 offen offset:3072 sc1 lds
L_nullback_70:
    s_bitcmp1_b32 s79, 1
    s_cbranch_scc1 L_null_71
    s_mov_b32 m0, s94
    s_sub_u32 s65, s92, 768
    buffer_load_dwordx4 v1, s[32:35], s92 offen sc1 lds
    buffer_load_dwordx4 v1, s[32:35], s92 offen offset:1024 sc1 lds
    buffer_load_dwordx4 v16, s[32:35], s92 offen offset:2048 sc1 lds
    buffer_load_dwordx4 v16, s[32:35], s65 offen offset:3072 sc1 lds
L_nullback_72:
    v_pk_fma_f32 v[176:177], v[224:225], v[14:15], v[176:177] op_sel:[0,0,0] op_sel_hi:[1,0,1]
    v_pk_fma_f32 v[178:179], v[226:227], v[14:15], v[178:179] op_sel:[0,0,0] op_sel_hi:[1,0,1]
    v_pk_fma_f32 v[180:181], v[228:229], v[14:15], v[180:181] op_sel:[0,0,0] op_sel_hi:[1,0,1]
    v_pk_fma_f32 v[182:183], v[230:231], v[14:15], v[182:183] op_sel:[0,0,0] op_sel_hi:[1,0,1]
    v_pk_fma_f32 v[184:185], v[232:233], v[14:15], v[184:185] op_sel:[0,0,0] op_sel_hi:[1,0,1]
    v_pk_fma_f32 v[186:187], v[234:235], v[14:15], v[186:187] op_sel:[0,0,0] op_sel_hi:[1,0,1]
    v_pk_fma_f32 v[188:189], v[236:237], v[14:15], v[188:189] op_sel:[0,0,0] op_sel_hi:[1,0,1]
    v_pk_fma_f32 v[190:191], v[238:239], v[14:15], v[190:191] op_sel:[0,0,0] op_sel_hi:[1,0,1]
    v_pk_mul_f32 v[176:177], v[176:177], v[14:15] op_sel:[0,1] op_sel_hi:[1,1]
    v_cvt_pk_bf16_f32 v136, v176, v177
    v_pk_mul_f32 v[178:179], v[178:179], v[14:15] op_sel:[0,1] op_sel_hi:[1,1]
    v_cvt_pk_bf16_f32 v137, v178, v179
    v_pk_mul_f32 v[180:181], v[180:181], v[14:15] op_sel:[0,1] op_sel_hi:[1,1]
    v_cvt_pk_bf16_f32 v138, v180, v181
    v_pk_mul_f32 v[182:183], v[182:183], v[14:15] op_sel:[0,1] op_sel_hi:[1,1]
    v_cvt_pk_bf16_f32 v139, v182, v183
    v_pk_mul_f32 v[184:185], v[184:185], v[14:15] op_sel:[0,1] op_sel_hi:[1,1]
    v_cvt_pk_bf16_f32 v140, v184, v185
    v_pk_mul_f32 v[186:187], v[186:187], v[14:15] op_sel:[0,1] op_sel_hi:[1,1]
    v_cvt_pk_bf16_f32 v141, v186, v187
    v_pk_mul_f32 v[188:189], v[188:189], v[14:15] op_sel:[0,1] op_sel_hi:[1,1]
    v_cvt_pk_bf16_f32 v142, v188, v189
    v_pk_mul_f32 v[190:191], v[190:191], v[14:15] op_sel:[0,1] op_sel_hi:[1,1]
    v_cvt_pk_bf16_f32 v143, v190, v191
    s_mov_b32 exec_lo, 0
    v_mov_b32 v142, 0x0
    v_mov_b32 v143, 0x3f800000
    s_mov_b64 exec, -1
    s_branch L_padskip11
L_pad11:
    s_setpc_b64 s[98:99]
L_padskip11:
    s_barrier
    s_lshl_b32 s60, s44, 12
    s_add_u32 s60, s60, 112640
    v_add_u32 v16, s60, v1
    v_lshrrev_b32 v106, 5, v0
    v_bfe_u32 v107, v0, 2, 2
    v_lshl_add_u32 v106, v106, 2, v107
    v_lshlrev_b32 v17, 6, v106
    v_bfe_u32 v106, v0, 4, 1
    v_lshl_add_u32 v17, v106, 5, v17
    v_and_b32 v106, 1, v0
    v_lshl_add_u32 v17, v106, 4, v17
    v_bfe_u32 v106, v0, 1, 1
    v_lshl_add_u32 v17, v106, 3, v17
    v_add_u32 v17, s60, v17
    s_lshl_b32 s60, s52, 4
    s_add_u32 s60, s60, s43
    s_cmp_lg_u32 s50, 0
    s_cselect_b32 s63, s71, s47
    s_mul_i32 s80, s60, 2048
    s_add_u32 s80, s80, s63
    s_add_u32 s80, s80, 524288
    s_mul_i32 s81, s60, 8
    s_add_u32 s81, s81, s47
    s_add_u32 s81, s81, 1327104
    s_lshl_b32 s82, s46, 2
    s_add_u32 s82, s82, s44
    s_lshl_b32 s82, s82, 14
    s_add_u32 s82, s82, 4030464
    s_add_u32 s83, s82, 4096
    s_add_u32 s84, s82, 8192
    s_add_u32 s85, s82, 12288
    v_lshlrev_b32 v28, 7, v0
    v_add_u32 v28, s80, v28
    s_lshl_b32 s60, s52, 7
    s_lshl_b32 s61, s45, 8
    s_lshl_b32 s62, s58, 7
    s_add_u32 s62, s62, s61
    s_mul_i32 s63, s62, 28
    s_lshl_b32 s64, s46, 9
    s_add_u32 s63, s63, s64
    s_lshl_b32 s64, s59, 8
    s_add_u32 s63, s63, s64
    s_add_u32 s64, s60, 1327104
    s_add_u32 s64, s64, s47
    v_writelane_b32 v28, s64, 16
    s_add_u32 s64, s61, 1327104
    s_add_u32 s64, s64, s47
    v_writelane_b32 v28, s64, 17
    s_add_u32 s64, s61, 1327232
    s_add_u32 s64, s64, s47
    v_writelane_b32 v28, s64, 18
    s_add_u32 s64, s60, 1328128
    s_add_u32 s64, s64, s47
    v_writelane_b32 v28, s64, 19
    s_add_u32 s64, s62, 1328128
    s_add_u32 s64, s64, s47
    v_writelane_b32 v28, s64, 20
    s_add_u32 s64, s63, 1245184
    s_add_u32 s64, s64, s47
    v_writelane_b32 v28, s64, 21
    s_add_u32 s64, s63, 1245312
    s_add_u32 s64, s64, s47
    v_writelane_b32 v28, s64, 22
    s_add_u32 s64, s60, 1331200
    s_add_u32 s64, s64, s47
    v_writelane_b32 v28, s64, 23
    s_add_u32 s64, s61, 1331200
    s_add_u32 s64, s64, s47
    v_writelane_b32 v28, s64, 24
    s_add_u32 s64, s61, 1331328
    s_add_u32 s64, s64, s47
    v_writelane_b32 v28, s64, 25
    s_add_u32 s64, s60, 1332224
    s_add_u32 s64, s64, s47
    v_writelane_b32 v28, s64, 26
    s_add_u32 s64, s61, 1332224
    s_add_u32 s64, s64, s47
    v_writelane_b32 v28, s64, 27
    s_add_u32 s64, s61, 1332352
    s_add_u32 s64, s64, s47
    v_writelane_b32 v28, s64, 28
    s_lshl_b32 s60, s59, 10
    v_xor_b32 v24, s60, v1
    v_xor_b32 v25, 1024, v24
    v_lshlrev_b32 v23, 7, v0
    s_lshl_b32 s60, s45, 1
    s_add_u32 s60, s60, s58
    s_lshl_b32 s61, s46, 1
    s_add_u32 s61, s61, s59
    s_mul_i32 s62, s60, 14
    s_add_u32 s62, s62, s61
    s_add_u32 s63, s47, 786432
    s_add_u32 s64, s71, 1015808
    s_cmp_lg_u32 s50, 0
    s_cselect_b32 s63, s64, s63
    s_mul_i32 s68, s62, 2048
    s_add_u32 s68, s68, s63
    s_mul_i32 s69, s62, 256
    s_add_u32 s69, s69, s47
    s_add_u32 s69, s69, 1245184
    s_lshl_b32 s60, s60, 4
    s_add_u32 s60, s60, s61
    s_mul_i32 s70, s60, 8
    s_add_u32 s70, s70, s47
    s_add_u32 s70, s70, 1328128
    s_cmp_ge_u32 s41, 28
    s_cselect_b32 s68, 4096, s68
    s_cselect_b32 s69, 4096, s69
    s_cselect_b32 s70, 4096, s70
    s_sub_u32 s60, s68, 3712
    v_add_u32 v106, s60, v23
    v_cmp_lt_u32 vcc, 28, v0
    s_nop 1
    v_cndmask_b32 v28, v28, v106, vcc
    s_lshl_b32 s60, s46, 2
    s_add_u32 s60, s60, s45
    s_lshl_b32 s86, s60, 14
    s_lshl_b32 s62, s44, 12
    s_add_u32 s86, s86, s62
    s_add_u32 s86, s86, 4030464
    s_mul_i32 s72, s43, 100352
    s_mul_i32 s73, s44, 13312
    s_add_u32 s72, s72, s73
    s_branch L_padskip12
L_pad12:
    s_setpc_b64 s[98:99]
L_padskip12:
    s_waitcnt vmcnt(0) lgkmcnt(0)
    s_barrier
    s_mov_b32 exec_hi, 0
    buffer_load_dword a255, v23, s[32:35], s86 offen sc1
    s_mov_b32 exec_hi, 0x1fff
    buffer_load_dword a255, v28, s[32:35], 0 offen sc1
    s_mov_b64 exec, -1
    ds_read_b128 v[32:35], v16 offset:0
    ds_read_b128 v[36:39], v16 offset:1024
    ds_read_b128 v[40:43], v16 offset:4096
    ds_read_b128 v[44:47], v16 offset:5120
    ds_read_b128 v[48:51], v16 offset:8192
    ds_read_b128 v[52:55], v16 offset:9216
    ds_read_b128 v[56:59], v16 offset:12288
    ds_read_b128 v[60:63], v16 offset:13312
    s_waitcnt lgkmcnt(7)
    v_mfma_f32_32x32x16_bf16 v[104:119], v[32:35], v[136:139], v[144:159]
    ds_read_b128 v[64:67], v16 offset:16384
    ds_read_b128 v[68:71], v16 offset:17408
    s_waitcnt lgkmcnt(8)
    v_mfma_f32_32x32x16_bf16 v[104:119], v[36:39], v[140:143], v[104:119]
    ds_read_b128 v[72:75], v16 offset:20480
    ds_read_b128 v[76:79], v16 offset:21504
    s_waitcnt lgkmcnt(9)
    v_mfma_f32_32x32x16_bf16 v[120:135], v[40:43], v[136:139], 0
    ds_read_b128 v[80:83], v16 offset:24576
    ds_read_b128 v[84:87], v16 offset:25600
    s_waitcnt lgkmcnt(10)
    v_mfma_f32_32x32x16_bf16 v[120:135], v[44:47], v[140:143], v[120:135]
    ds_read_b128 v[88:91], v16 offset:28672
    ds_read_b128 v[92:95], v16 offset:29696
    s_waitcnt lgkmcnt(11)
    v_mfma_f32_32x32x16_bf16 v[176:191], v[48:51], v[136:139], 0
    ds_read_b128 v[96:99], v16 offset:32768
    ds_read_b128 v[100:103], v16 offset:33792
    v_max_f32 v18, v104, v105
    v_max_f32 v19, v106, v107
    v_max3_f32 v18, v108, v109, v18
    v_max3_f32 v19, v110, v111, v19
    s_waitcnt lgkmcnt(12)
    v_mfma_f32_32x32x16_bf16 v[176:191], v[52:55], v[140:143], v[176:191]
    v_max3_f32 v18, v112, v113, v18
    v_max3_f32 v19, v114, v115, v19
    v_max3_f32 v18, v116, v117, v18
    v_max3_f32 v19, v118, v119, v19
    s_waitcnt lgkmcnt(11)
    v_mfma_f32_32x32x16_bf16 v[104:119], v[56:59], v[136:139], 0
    s_add_u32 m0, s73, 57344
    s_add_u32 s65, s72, 2424832
    buffer_load_dwordx4 v1, s[32:35], s65 offen offset:0 sc1 lds
    v_max3_f32 v18, v120, v121, v18
    v_max3_f32 v19, v122, v123, v19
    v_max3_f32 v18, v124, v125, v18
    v_max3_f32 v19, v126, v127, v19
    s_waitcnt lgkmcnt(10)
    v_mfma_f32_32x32x16_bf16 v[104:119], v[60:63], v[140:143], v[104:119]
    v_max3_f32 v18, v128, v129, v18
    v_max3_f32 v19, v130, v131, v19
    v_max3_f32 v18, v132, v133, v18
    v_max3_f32 v19, v134, v135, v19
    s_waitcnt lgkmcnt(9)
    v_mfma_f32_32x32x16_bf16 v[120:135], v[64:67], v[136:139], 0
    v_max3_f32 v18, v176, v177, v18
    v_max3_f32 v19, v178, v179, v19
    v_max3_f32 v18, v180, v181, v18
    v_max3_f32 v19, v182, v183, v19
    s_waitcnt lgkmcnt(8)
    v_mfma_f32_32x32x16_bf16 v[120:135], v[68:71], v[140:143], v[120:135]
    v_max3_f32 v18, v184, v185, v18
    v_max3_f32 v19, v186, v187, v19
    v_max3_f32 v18, v188, v189, v18
    v_max3_f32 v19, v190, v191, v19
    s_waitcnt lgkmcnt(7)
    v_mfma_f32_32x32x16_bf16 v[176:191], v[72:75], v[136:139], 0
    buffer_load_dwordx4 v1, s[32:35], s65 offen offset:1024 sc1 lds
    v_max3_f32 v18, v104, v105, v18
    v_max3_f32 v19, v106, v107, v19
    v_max3_f32 v18, v108, v109, v18
    v_max3_f32 v19, v110, v111, v19
    s_waitcnt lgkmcnt(6)
    v_mfma_f32_32x32x16_bf16 v[176:191], v[76:79], v[140:143], v[176:191]
    v_max3_f32 v18, v112, v113, v18
    v_max3_f32 v19, v114, v115, v19
    v_max3_f32 v18, v116, v117, v18
    v_max3_f32 v19, v118, v119, v19
    s_waitcnt lgkmcnt(5)
    v_mfma_f32_32x32x16_bf16 v[104:119], v[80:83], v[136:139], 0
    v_max3_f32 v18, v120, v121, v18
    v_max3_f32 v19, v122, v123, v19
    v_max3_f32 v18, v124, v125, v18
    v_max3_f32 v19, v126, v127, v19
    s_waitcnt lgkmcnt(4)
    v_mfma_f32_32x32x16_bf16 v[104:119], v[84:87], v[140:143], v[104:119]
    v_max3_f32 v18, v128, v129, v18
    v_max3_f32 v19, v130, v131, v19
    v_max3_f32 v18, v132, v133, v18
    v_max3_f32 v19, v134, v135, v19
    s_waitcnt lgkmcnt(3)
    v_mfma_f32_32x32x16_bf16 v[120:135], v[88:91], v[136:139], 0
    ds_read_b64_tr_b16 v[224:225], v17 offset:2048
    ds_read_b64_tr_b16 v[226:227], v17 offset:2560
    buffer_load_dwordx4 v1, s[32:35], s65 offen offset:2048 sc1 lds
    v_max3_f32 v18, v176, v177, v18
    v_max3_f32 v19, v178, v179, v19
    v_max3_f32 v18, v180, v181, v18
    v_max3_f32 v19, v182, v183, v19
    s_waitcnt lgkmcnt(4)
    v_mfma_f32_32x32x16_bf16 v[120:135], v[92:95], v[140:143], v[120:135]
    v_max3_f32 v18, v184, v185, v18
    v_max3_f32 v19, v186, v187, v19
    v_max3_f32 v18, v188, v189, v18
    v_max3_f32 v19, v190, v191, v19
    s_waitcnt lgkmcnt(3)
    v_mfma_f32_32x32x16_bf16 v[176:191], v[96:99], v[136:139], v[160:175]
    ds_read_b64_tr_b16 v[228:229], v17 offset:3072
    ds_read_b64_tr_b16 v[230:231], v17 offset:3584
    v_max3_f32 v18, v104, v105, v18
    v_max3_f32 v19, v106, v107, v19
    v_max3_f32 v18, v108, v109, v18
    v_max3_f32 v19, v110, v111, v19
    s_waitcnt lgkmcnt(4)
    v_mfma_f32_32x32x16_bf16 v[176:191], v[100:103], v[140:143], v[176:191]
    v_max3_f32 v18, v112, v113, v18
    v_max3_f32 v19, v114, v115, v19
    v_max3_f32 v18, v116, v117, v18
    v_max3_f32 v19, v118, v119, v19
    v_max3_f32 v18, v120, v121, v18
    v_max3_f32 v19, v122, v123, v19
    v_max3_f32 v18, v124, v125, v18
    v_max3_f32 v19, v126, v127, v19
    v_max3_f32 v18, v128, v129, v18
    v_max3_f32 v19, v130, v131, v19
    v_max3_f32 v18, v132, v133, v18
    v_max3_f32 v19, v134, v135, v19
    v_max3_f32 v18, v176, v177, v18
    v_max3_f32 v19, v178, v179, v19
    v_max3_f32 v18, v180, v181, v18
    v_max3_f32 v19, v182, v183, v19
    v_max3_f32 v18, v184, v185, v18
    v_max3_f32 v19, v186, v187, v19
    v_max3_f32 v18, v188, v189, v18
    v_max3_f32 v19, v190, v191, v19
    v_max_f32 v18, v18, v19
    v_mov_b32 v20, v18
    s_nop 1
    v_permlane32_swap_b32 v18, v20
    v_max_f32 v18, v18, v20
    v_xor_b32 v18, 0x80000000, v18
    v_and_b32 v20, 0xffff0000, v18
    v_sub_f32 v22, v18, v20
    v_and_b32 v20, 0xffff0000, v22
    v_sub_f32 v21, v22, v20
    s_mov_b32 exec_lo, 0
    v_perm_b32 v142, v22, v18, s56
    v_perm_b32 v143, 1.0, v21, s56
    s_mov_b64 exec, -1
    s_branch L_padskip13
L_pad13:
    s_setpc_b64 s[98:99]
L_padskip13:
    v_mfma_f32_32x32x16_bf16 v[104:119], v[32:35], v[136:139], v[144:159]
    v_mfma_f32_32x32x16_bf16 v[104:119], v[36:39], v[140:143], v[104:119]
    v_mfma_f32_32x32x16_bf16 v[120:135], v[40:43], v[136:139], 0
    v_mfma_f32_32x32x16_bf16 v[120:135], v[44:47], v[140:143], v[120:135]
    s_nop 9
    v_exp_f32 v104, v104
    v_exp_f32 v105, v105
    v_exp_f32 v106, v106
    v_mfma_f32_32x32x16_bf16 v[176:191], v[48:51], v[136:139], 0
    ds_read_b64_tr_b16 v[232:233], v17 offset:6144
    ds_read_b64_tr_b16 v[234:235], v17 offset:6656
    buffer_load_dwordx4 v1, s[32:35], s65 offen offset:3072 sc1 lds
    v_exp_f32 v107, v107
    v_cvt_pk_bf16_f32 v208, v104, v105
    v_exp_f32 v108, v108
    v_exp_f32 v109, v109
    v_cvt_pk_bf16_f32 v209, v106, v107
    v_mfma_f32_32x32x16_bf16 v[176:191], v[52:55], v[140:143], v[176:191]
    ds_read_b64_tr_b16 v[236:237], v17 offset:7168
    ds_read_b64_tr_b16 v[238:239], v17 offset:7680
    s_add_u32 m0, s73, 61440
    s_add_u32 s65, s72, 2428928
    buffer_load_dwordx4 v1, s[32:35], s65 offen offset:0 sc1 lds
    v_exp_f32 v110, v110
    v_exp_f32 v111, v111
    v_cvt_pk_bf16_f32 v210, v108, v109
    v_exp_f32 v112, v112
    v_exp_f32 v113, v113
    v_cvt_pk_bf16_f32 v211, v110, v111
    v_exp_f32 v114, v114
    v_exp_f32 v115, v115
    v_cvt_pk_bf16_f32 v212, v112, v113
    v_exp_f32 v116, v116
    v_exp_f32 v117, v117
    v_cvt_pk_bf16_f32 v213, v114, v115
    v_exp_f32 v118, v118
    v_exp_f32 v119, v119
    v_cvt_pk_bf16_f32 v214, v116, v117
    v_cvt_pk_bf16_f32 v215, v118, v119
    v_exp_f32 v120, v120
    v_exp_f32 v121, v121
    v_exp_f32 v122, v122
    s_waitcnt lgkmcnt(6)
    v_mfma_f32_32x32x16_bf16 v[192:207], v[224:227], v[208:211], 0
    buffer_load_dwordx4 v1, s[32:35], s65 offen offset:1024 sc1 lds
    v_exp_f32 v123, v123
    v_cvt_pk_bf16_f32 v216, v120, v121
    v_exp_f32 v124, v124
    v_exp_f32 v125, v125
    v_cvt_pk_bf16_f32 v217, v122, v123
    s_waitcnt lgkmcnt(4)
    v_mfma_f32_32x32x16_bf16 v[192:207], v[228:231], v[212:215], v[192:207]
    ds_read_b64_tr_b16 v[224:225], v17 offset:10240
    ds_read_b64_tr_b16 v[226:227], v17 offset:10752
    v_exp_f32 v126, v126
    v_exp_f32 v127, v127
    v_cvt_pk_bf16_f32 v218, v124, v125
    v_exp_f32 v128, v128
    v_exp_f32 v129, v129
    v_mfma_f32_32x32x16_bf16 v[104:119], v[56:59], v[136:139], 0
    ds_read_b64_tr_b16 v[228:229], v17 offset:11264
    ds_read_b64_tr_b16 v[230:231], v17 offset:11776
    v_cvt_pk_bf16_f32 v219, v126, v127
    v_exp_f32 v130, v130
    v_exp_f32 v131, v131
    v_cvt_pk_bf16_f32 v220, v128, v129
    v_exp_f32 v132, v132
    v_mfma_f32_32x32x16_bf16 v[104:119], v[60:63], v[140:143], v[104:119]
    buffer_load_dwordx4 v1, s[32:35], s65 offen offset:2048 sc1 lds
    v_exp_f32 v133, v133
    v_cvt_pk_bf16_f32 v221, v130, v131
    v_exp_f32 v134, v134
    v_exp_f32 v135, v135
    v_cvt_pk_bf16_f32 v222, v132, v133
    v_cvt_pk_bf16_f32 v223, v134, v135
    v_exp_f32 v176, v176
    v_exp_f32 v177, v177
    v_exp_f32 v178, v178
    s_waitcnt lgkmcnt(6)
    v_mfma_f32_32x32x16_bf16 v[192:207], v[232:235], v[216:219], v[192:207]
    buffer_load_dwordx4 v1, s[32:35], s65 offen offset:3072 sc1 lds
    v_exp_f32 v179, v179
    v_cvt_pk_bf16_f32 v208, v176, v177
    v_exp_f32 v180, v180
    v_exp_f32 v181, v181
    v_cvt_pk_bf16_f32 v209, v178, v179
    s_waitcnt lgkmcnt(4)
    v_mfma_f32_32x32x16_bf16 v[192:207], v[236:239], v[220:223], v[192:207]
    ds_read_b64_tr_b16 v[232:233], v17 offset:14336
    ds_read_b64_tr_b16 v[234:235], v17 offset:14848
    v_exp_f32 v182, v182
    v_exp_f32 v183, v183
    v_cvt_pk_bf16_f32 v210, v180, v181
    v_exp_f32 v184, v184
    v_exp_f32 v185, v185
    v_mfma_f32_32x32x16_bf16 v[120:135], v[64:67], v[136:139], 0
    ds_read_b64_tr_b16 v[236:237], v17 offset:15360
    ds_read_b64_tr_b16 v[238:239], v17 offset:15872
    v_cvt_pk_bf16_f32 v211, v182, v183
    v_exp_f32 v186, v186
    v_exp_f32 v187, v187
    v_cvt_pk_bf16_f32 v212, v184, v185
    v_exp_f32 v188, v188
    v_mfma_f32_32x32x16_bf16 v[120:135], v[68:71], v[140:143], v[120:135]
    s_add_u32 m0, s73, 65536
    s_add_u32 s65, s72, 2433024
    buffer_load_dwordx4 v1, s[32:35], s65 offen offset:0 sc1 lds
    v_exp_f32 v189, v189
    v_cvt_pk_bf16_f32 v213, v186, v187
    v_exp_f32 v190, v190
    v_exp_f32 v191, v191
    v_cvt_pk_bf16_f32 v214, v188, v189
    v_cvt_pk_bf16_f32 v215, v190, v191
    v_exp_f32 v104, v104
    v_exp_f32 v105, v105
    v_exp_f32 v106, v106
    s_waitcnt lgkmcnt(6)
    v_mfma_f32_32x32x16_bf16 v[192:207], v[224:227], v[208:211], v[192:207]
    buffer_load_dwordx4 v1, s[32:35], s65 offen offset:1024 sc1 lds
    v_exp_f32 v107, v107
    v_cvt_pk_bf16_f32 v216, v104, v105
    v_exp_f32 v108, v108
    v_exp_f32 v109, v109
    v_cvt_pk_bf16_f32 v217, v106, v107
    s_waitcnt lgkmcnt(4)
    v_mfma_f32_32x32x16_bf16 v[192:207], v[228:231], v[212:215], v[192:207]
    ds_read_b64_tr_b16 v[224:225], v17 offset:18432
    ds_read_b64_tr_b16 v[226:227], v17 offset:18944
    v_exp_f32 v110, v110
    v_exp_f32 v111, v111
    v_cvt_pk_bf16_f32 v218, v108, v109
    v_exp_f32 v112, v112
    v_exp_f32 v113, v113
    v_mfma_f32_32x32x16_bf16 v[176:191], v[72:75], v[136:139], 0
    ds_read_b64_tr_b16 v[228:229], v17 offset:19456
    ds_read_b64_tr_b16 v[230:231], v17 offset:19968
    v_cvt_pk_bf16_f32 v219, v110, v111
    v_exp_f32 v114, v114
    v_exp_f32 v115, v115
    v_cvt_pk_bf16_f32 v220, v112, v113
    v_exp_f32 v116, v116
    v_mfma_f32_32x32x16_bf16 v[176:191], v[76:79], v[140:143], v[176:191]
    buffer_load_dwordx4 v1, s[32:35], s65 offen offset:2048 sc1 lds
    v_exp_f32 v117, v117
    v_cvt_pk_bf16_f32 v221, v114, v115
    v_exp_f32 v118, v118
    v_exp_f32 v119, v119
    v_cvt_pk_bf16_f32 v222, v116, v117
    v_cvt_pk_bf16_f32 v223, v118, v119
    v_exp_f32 v120, v120
    v_exp_f32 v121, v121
    v_exp_f32 v122, v122
    s_waitcnt lgkmcnt(6)
    v_mfma_f32_32x32x16_bf16 v[192:207], v[232:235], v[216:219], v[192:207]
    buffer_load_dwordx4 v1, s[32:35], s65 offen offset:3072 sc1 lds
    v_exp_f32 v123, v123
    v_cvt_pk_bf16_f32 v208, v120, v121
    v_exp_f32 v124, v124
    v_exp_f32 v125, v125
    v_cvt_pk_bf16_f32 v209, v122, v123
    s_waitcnt lgkmcnt(4)
    v_mfma_f32_32x32x16_bf16 v[192:207], v[236:239], v[220:223], v[192:207]
    ds_read_b64_tr_b16 v[232:233], v17 offset:22528
    ds_read_b64_tr_b16 v[234:235], v17 offset:23040
    v_exp_f32 v126, v126
    v_exp_f32 v127, v127
    v_cvt_pk_bf16_f32 v210, v124, v125
    v_exp_f32 v128, v128
    v_exp_f32 v129, v129
    v_mfma_f32_32x32x16_bf16 v[104:119], v[80:83], v[136:139], 0
    ds_read_b64_tr_b16 v[236:237], v17 offset:23552
    ds_read_b64_tr_b16 v[238:239], v17 offset:24064
    v_cvt_pk_bf16_f32 v211, v126, v127
    v_exp_f32 v130, v130
    v_exp_f32 v131, v131
    v_cvt_pk_bf16_f32 v212, v128, v129
    v_exp_f32 v132, v132
    v_mfma_f32_32x32x16_bf16 v[104:119], v[84:87], v[140:143], v[104:119]
    s_add_u32 m0, s73, 69632
    s_add_u32 s65, s72, 2437120
    buffer_load_dwordx4 v1, s[32:35], s65 offen offset:0 sc1 lds
    v_exp_f32 v133, v133
    v_cvt_pk_bf16_f32 v213, v130, v131
    v_exp_f32 v134, v134
    v_exp_f32 v135, v135
    v_cvt_pk_bf16_f32 v214, v132, v133
    v_cvt_pk_bf16_f32 v215, v134, v135
    v_exp_f32 v176, v176
    v_exp_f32 v177, v177
    v_exp_f32 v178, v178
    s_waitcnt lgkmcnt(6)
    v_mfma_f32_32x32x16_bf16 v[192:207], v[224:227], v[208:211], v[192:207]
    s_sub_u32 s72, s72, s73
    s_lshl_b32 s73, s59, 10
    s_add_u32 s72, s72, s73
    s_add_u32 m0, s73, 110592
    s_add_u32 s65, s72, 2478080
    buffer_load_dwordx4 v1, s[32:35], s65 offen offset:0 sc1 lds
    v_exp_f32 v179, v179
    v_cvt_pk_bf16_f32 v216, v176, v177
    v_exp_f32 v180, v180
    v_exp_f32 v181, v181
    v_cvt_pk_bf16_f32 v217, v178, v179
    s_waitcnt lgkmcnt(4)
    v_mfma_f32_32x32x16_bf16 v[192:207], v[228:231], v[212:215], v[192:207]
    ds_read_b64_tr_b16 v[224:225], v17 offset:26624
    ds_read_b64_tr_b16 v[226:227], v17 offset:27136
    v_exp_f32 v182, v182
    v_exp_f32 v183, v183
    v_cvt_pk_bf16_f32 v218, v180, v181
    v_exp_f32 v184, v184
    v_exp_f32 v185, v185
    v_mfma_f32_32x32x16_bf16 v[120:135], v[88:91], v[136:139], 0
    ds_read_b64_tr_b16 v[228:229], v17 offset:27648
    ds_read_b64_tr_b16 v[230:231], v17 offset:28160
    v_cvt_pk_bf16_f32 v219, v182, v183
    v_exp_f32 v186, v186
    v_exp_f32 v187, v187
    v_cvt_pk_bf16_f32 v220, v184, v185
    v_exp_f32 v188, v188
    v_mfma_f32_32x32x16_bf16 v[120:135], v[92:95], v[140:143], v[120:135]
    v_exp_f32 v189, v189
    v_cvt_pk_bf16_f32 v221, v186, v187
    v_exp_f32 v190, v190
    v_exp_f32 v191, v191
    v_cvt_pk_bf16_f32 v222, v188, v189
    v_cvt_pk_bf16_f32 v223, v190, v191
    v_exp_f32 v104, v104
    v_exp_f32 v105, v105
    v_exp_f32 v106, v106
    s_waitcnt lgkmcnt(6)
    v_mfma_f32_32x32x16_bf16 v[192:207], v[232:235], v[216:219], v[192:207]
    v_exp_f32 v107, v107
    v_cvt_pk_bf16_f32 v208, v104, v105
    v_exp_f32 v108, v108
    v_exp_f32 v109, v109
    v_cvt_pk_bf16_f32 v209, v106, v107
    s_waitcnt lgkmcnt(4)
    v_mfma_f32_32x32x16_bf16 v[192:207], v[236:239], v[220:223], v[192:207]
    ds_read_b64_tr_b16 v[232:233], v17 offset:30720
    ds_read_b64_tr_b16 v[234:235], v17 offset:31232
    v_exp_f32 v110, v110
    v_exp_f32 v111, v111
    v_cvt_pk_bf16_f32 v210, v108, v109
    v_exp_f32 v112, v112
    v_exp_f32 v113, v113
    v_mfma_f32_32x32x16_bf16 v[176:191], v[96:99], v[136:139], v[160:175]
    ds_read_b64_tr_b16 v[236:237], v17 offset:31744
    ds_read_b64_tr_b16 v[238:239], v17 offset:32256
    v_cvt_pk_bf16_f32 v211, v110, v111
    v_exp_f32 v114, v114
    v_exp_f32 v115, v115
    v_cvt_pk_bf16_f32 v212, v112, v113
    v_exp_f32 v116, v116
    v_mfma_f32_32x32x16_bf16 v[176:191], v[100:103], v[140:143], v[176:191]
    v_exp_f32 v117, v117
    v_cvt_pk_bf16_f32 v213, v114, v115
    v_exp_f32 v118, v118
    v_exp_f32 v119, v119
    v_cvt_pk_bf16_f32 v214, v116, v117
    v_cvt_pk_bf16_f32 v215, v118, v119
    v_exp_f32 v120, v120
    v_exp_f32 v121, v121
    v_exp_f32 v122, v122
    s_waitcnt lgkmcnt(6)
    v_mfma_f32_32x32x16_bf16 v[192:207], v[224:227], v[208:211], v[192:207]
    buffer_load_dwordx4 v[32:35], v24, s[32:35], s82 offen offset:0 sc1
    buffer_load_dwordx4 v[36:39], v25, s[32:35], s82 offen offset:0 sc1
    buffer_load_dwordx4 v[40:43], v24, s[32:35], s82 offen offset:2048 sc1
    buffer_load_dwordx4 v[44:47], v25, s[32:35], s82 offen offset:2048 sc1
    v_exp_f32 v123, v123
    v_cvt_pk_bf16_f32 v216, v120, v121
    v_exp_f32 v124, v124
    v_exp_f32 v125, v125
    v_cvt_pk_bf16_f32 v217, v122, v123
    s_waitcnt lgkmcnt(4)
    v_mfma_f32_32x32x16_bf16 v[192:207], v[228:231], v[212:215], v[192:207]
    ds_read_b64_tr_b16 v[224:225], v17 offset:34816
    ds_read_b64_tr_b16 v[226:227], v17 offset:35328
    buffer_load_dwordx4 v[48:51], v24, s[32:35], s83 offen offset:0 sc1
    buffer_load_dwordx4 v[52:55], v25, s[32:35], s83 offen offset:0 sc1
    buffer_load_dwordx4 v[56:59], v24, s[32:35], s83 offen offset:2048 sc1
    buffer_load_dwordx4 v[60:63], v25, s[32:35], s83 offen offset:2048 sc1
    v_exp_f32 v126, v126
    v_exp_f32 v127, v127
    v_cvt_pk_bf16_f32 v218, v124, v125
    v_exp_f32 v128, v128
    v_exp_f32 v129, v129
    v_cvt_pk_bf16_f32 v219, v126, v127
    v_exp_f32 v130, v130
    v_exp_f32 v131, v131
    v_cvt_pk_bf16_f32 v220, v128, v129
    v_exp_f32 v132, v132
    v_exp_f32 v133, v133
    v_cvt_pk_bf16_f32 v221, v130, v131
    v_exp_f32 v134, v134
    ds_read_b64_tr_b16 v[228:229], v17 offset:35840
    ds_read_b64_tr_b16 v[230:231], v17 offset:36352
    v_exp_f32 v135, v135
    v_cvt_pk_bf16_f32 v222, v132, v133
    v_cvt_pk_bf16_f32 v223, v134, v135
    v_exp_f32 v176, v176
    v_exp_f32 v177, v177
    v_exp_f32 v178, v178
    s_waitcnt lgkmcnt(6)
    v_mfma_f32_32x32x16_bf16 v[192:207], v[232:235], v[216:219], v[192:207]
    buffer_load_dwordx4 v[64:67], v24, s[32:35], s84 offen offset:0 sc1
    buffer_load_dwordx4 v[68:71], v25, s[32:35], s84 offen offset:0 sc1
    buffer_load_dwordx4 v[72:75], v24, s[32:35], s84 offen offset:2048 sc1
    buffer_load_dwordx4 v[76:79], v25, s[32:35], s84 offen offset:2048 sc1
    v_exp_f32 v179, v179
    v_cvt_pk_bf16_f32 v208, v176, v177
    v_exp_f32 v180, v180
    v_exp_f32 v181, v181
    v_cvt_pk_bf16_f32 v209, v178, v179
    s_waitcnt lgkmcnt(4)
    v_mfma_f32_32x32x16_bf16 v[192:207], v[236:239], v[220:223], v[192:207]
    buffer_load_dwordx4 v[80:83], v24, s[32:35], s85 offen offset:0 sc1
    buffer_load_dwordx4 v[84:87], v25, s[32:35], s85 offen offset:0 sc1
    buffer_load_dwordx4 v[88:91], v24, s[32:35], s85 offen offset:2048 sc1
    buffer_load_dwordx4 v[92:95], v25, s[32:35], s85 offen offset:2048 sc1
    v_exp_f32 v182, v182
    v_exp_f32 v183, v183
    v_cvt_pk_bf16_f32 v210, v180, v181
    v_exp_f32 v184, v184
    v_exp_f32 v185, v185
    v_cvt_pk_bf16_f32 v211, v182, v183
    v_exp_f32 v186, v186
    v_exp_f32 v187, v187
    v_cvt_pk_bf16_f32 v212, v184, v185
    v_exp_f32 v188, v188
    v_exp_f32 v189, v189
    v_cvt_pk_bf16_f32 v213, v186, v187
    v_exp_f32 v190, v190
    v_exp_f32 v191, v191
    v_cvt_pk_bf16_f32 v214, v188, v189
    v_cvt_pk_bf16_f32 v215, v190, v191
    s_waitcnt lgkmcnt(2)
    v_mfma_f32_32x32x16_bf16 v[192:207], v[224:227], v[208:211], v[192:207]
    s_waitcnt lgkmcnt(0)
    v_mfma_f32_32x32x16_bf16 v[192:207], v[228:231], v[212:215], v[192:207]
    s_nop 11
    v_mov_b32 v20, v204
    v_mov_b32 v21, v204
    s_nop 1
    v_permlane32_swap_b32 v20, v21
    v_rcp_f32 v21, v21
    s_nop 0
    v_pk_mul_f32 v[192:193], v[192:193], v[20:21] op_sel:[0,1] op_sel_hi:[1,1]
    v_cvt_pk_bf16_f32 v208, v192, v193
    v_pk_mul_f32 v[194:195], v[194:195], v[20:21] op_sel:[0,1] op_sel_hi:[1,1]
    v_cvt_pk_bf16_f32 v209, v194, v195
    v_pk_mul_f32 v[196:197], v[196:197], v[20:21] op_sel:[0,1] op_sel_hi:[1,1]
    v_cvt_pk_bf16_f32 v210, v196, v197
    v_pk_mul_f32 v[198:199], v[198:199], v[20:21] op_sel:[0,1] op_sel_hi:[1,1]
    v_cvt_pk_bf16_f32 v211, v198, v199
    buffer_store_dwordx4 v[208:211], v1, s[32:35], s80 offen offset:0
    v_pk_mul_f32 v[200:201], v[200:201], v[20:21] op_sel:[0,1] op_sel_hi:[1,1]
    v_cvt_pk_bf16_f32 v212, v200, v201
    v_pk_mul_f32 v[202:203], v[202:203], v[20:21] op_sel:[0,1] op_sel_hi:[1,1]
    v_cvt_pk_bf16_f32 v213, v202, v203
    v_pk_mul_f32 v[204:205], v[204:205], v[20:21] op_sel:[0,1] op_sel_hi:[1,1]
    v_cvt_pk_bf16_f32 v214, v204, v205
    v_pk_mul_f32 v[206:207], v[206:207], v[20:21] op_sel:[0,1] op_sel_hi:[1,1]
    v_cvt_pk_bf16_f32 v215, v206, v207
    buffer_store_dwordx4 v[212:215], v1, s[32:35], s80 offen offset:1024
    s_waitcnt vmcnt(0)
    s_mov_b64 exec, 1
    s_cmp_lg_u32 s50, 0
    s_cbranch_scc0 L_pubslow_73
    buffer_store_dwordx2 v[12:13], off, s[32:35], s81 offset:0
L_pubback_74:
    s_mov_b64 exec, -1
    s_branch L_padskip14
L_pad14:
    s_setpc_b64 s[98:99]
L_padskip14:
    s_barrier
    s_cmp_ge_u32 s41, 28
    s_cbranch_scc1 L_p3idle_76
    s_lshl_b32 s60, s45, 3
    s_add_u32 s60, s60, s44
    s_mul_i32 s80, s60, 32
    s_add_u32 s80, s80, s47
    s_add_u32 s80, s80, 1327104
    s_mov_b64 exec, 0xff
    buffer_load_dwordx2 v[30:31], v5, s[32:35], s80 offen offset:0 sc1
    s_mov_b64 exec, -1
    s_xor_b32 s60, s58, 0
    s_lshl_b32 s61, s45, 1
    s_add_u32 s60, s60, s61
    s_lshl_b32 s60, s60, 2
    s_add_u32 s60, s60, s44
    s_cmp_lg_u32 s50, 0
    s_cselect_b32 s63, s71, s47
    s_mul_i32 s82, s60, 8192
    s_add_u32 s82, s82, s63
    s_add_u32 s82, s82, 524288
    s_xor_b32 s60, s58, 1
    s_lshl_b32 s61, s45, 1
    s_add_u32 s60, s60, s61
    s_lshl_b32 s60, s60, 2
    s_add_u32 s60, s60, s44
    s_cmp_lg_u32 s50, 0
    s_cselect_b32 s63, s71, s47
    s_mul_i32 s83, s60, 8192
    s_add_u32 s83, s83, s63
    s_add_u32 s83, s83, 524288
    s_add_u32 s84, s82, 4096
    s_add_u32 s85, s83, 4096
    s_mov_b64 exec, 0xff
    s_mov_b32 s66, 0
L_poll_77:
    buffer_load_dwordx2 v[236:237], v5, s[32:35], s80 offen sc1
    s_add_u32 s66, s66, 1
    s_cmp_gt_u32 s66, 65536
    s_cbranch_scc1 L_pollout_78
    s_waitcnt vmcnt(1)
    v_cmp_ne_u64 vcc, s[48:49], v[30:31]
    s_nop 0
    s_cbranch_vccz L_pollout_78
    buffer_load_dwordx2 v[30:31], v5, s[32:35], s80 offen sc1
    s_waitcnt vmcnt(1)
    v_cmp_ne_u64 vcc, s[48:49], v[236:237]
    s_nop 0
    s_cbranch_vccnz L_poll_77
L_pollout_78:
    s_mov_b64 exec, -1
    s_cmp_lg_u32 s50, 0
    s_cbranch_scc0 L_acq_79
L_acqback_80:
    buffer_load_dwordx4 v[96:99], v1, s[32:35], s82 offen offset:0 sc1
    buffer_load_dwordx4 v[100:103], v1, s[32:35], s83 offen offset:0 sc1
    buffer_load_dwordx4 v[104:107], v1, s[32:35], s82 offen offset:1024 sc1
    buffer_load_dwordx4 v[108:111], v1, s[32:35], s83 offen offset:1024 sc1
    buffer_load_dwordx4 v[112:115], v1, s[32:35], s82 offen offset:2048 sc1
    buffer_load_dwordx4 v[116:119], v1, s[32:35], s83 offen offset:2048 sc1
    buffer_load_dwordx4 v[120:123], v1, s[32:35], s82 offen offset:3072 sc1
    buffer_load_dwordx4 v[124:127], v1, s[32:35], s83 offen offset:3072 sc1
    buffer_load_dwordx4 v[128:131], v1, s[32:35], s84 offen offset:0 sc1
    buffer_load_dwordx4 v[132:135], v1, s[32:35], s85 offen offset:0 sc1
    s_waitcnt vmcnt(9)
    v_mfma_f32_32x32x16_bf16 v[176:191], v[36:39], v[96:99], 0
    buffer_load_dwordx4 v[136:139], v1, s[32:35], s84 offen offset:1024 sc1
    s_waitcnt vmcnt(9)
    v_mfma_f32_32x32x16_bf16 v[192:207], v[32:35], v[100:103], 0
    buffer_load_dwordx4 v[140:143], v1, s[32:35], s85 offen offset:1024 sc1
    v_mfma_f32_32x32x16_bf16 v[208:223], v[36:39], v[100:103], 0
    s_waitcnt vmcnt(9)
    v_mfma_f32_32x32x16_bf16 v[176:191], v[44:47], v[104:107], v[176:191]
    buffer_load_dwordx4 v[144:147], v1, s[32:35], s84 offen offset:2048 sc1
    s_waitcnt vmcnt(9)
    v_mfma_f32_32x32x16_bf16 v[192:207], v[40:43], v[108:111], v[192:207]
    buffer_load_dwordx4 v[148:151], v1, s[32:35], s85 offen offset:2048 sc1
    v_mfma_f32_32x32x16_bf16 v[208:223], v[44:47], v[108:111], v[208:223]
    s_waitcnt vmcnt(9)
    v_mfma_f32_32x32x16_bf16 v[176:191], v[52:55], v[112:115], v[176:191]
    buffer_load_dwordx4 v[152:155], v1, s[32:35], s84 offen offset:3072 sc1
    s_waitcnt vmcnt(9)
    v_mfma_f32_32x32x16_bf16 v[192:207], v[48:51], v[116:119], v[192:207]
    buffer_load_dwordx4 v[156:159], v1, s[32:35], s85 offen offset:3072 sc1
    v_mfma_f32_32x32x16_bf16 v[208:223], v[52:55], v[116:119], v[208:223]
    s_waitcnt vmcnt(9)
    v_mfma_f32_32x32x16_bf16 v[176:191], v[60:63], v[120:123], v[176:191]
    s_waitcnt vmcnt(8)
    v_mfma_f32_32x32x16_bf16 v[192:207], v[56:59], v[124:127], v[192:207]
    v_mfma_f32_32x32x16_bf16 v[208:223], v[60:63], v[124:127], v[208:223]
    s_waitcnt vmcnt(7)
    v_mfma_f32_32x32x16_bf16 v[176:191], v[68:71], v[128:131], v[176:191]
    s_waitcnt vmcnt(6)
    v_mfma_f32_32x32x16_bf16 v[192:207], v[64:67], v[132:135], v[192:207]
    v_mfma_f32_32x32x16_bf16 v[208:223], v[68:71], v[132:135], v[208:223]
    s_waitcnt vmcnt(5)
    v_mfma_f32_32x32x16_bf16 v[176:191], v[76:79], v[136:139], v[176:191]
    s_waitcnt vmcnt(4)
    v_mfma_f32_32x32x16_bf16 v[192:207], v[72:75], v[140:143], v[192:207]
    v_mfma_f32_32x32x16_bf16 v[208:223], v[76:79], v[140:143], v[208:223]
    s_waitcnt vmcnt(3)
    v_mfma_f32_32x32x16_bf16 v[176:191], v[84:87], v[144:147], v[176:191]
    s_waitcnt vmcnt(2)
    v_mfma_f32_32x32x16_bf16 v[192:207], v[80:83], v[148:151], v[192:207]
    v_mfma_f32_32x32x16_bf16 v[208:223], v[84:87], v[148:151], v[208:223]
    s_waitcnt vmcnt(1)
    v_mfma_f32_32x32x16_bf16 v[176:191], v[92:95], v[152:155], v[176:191]
    s_waitcnt vmcnt(0)
    v_mfma_f32_32x32x16_bf16 v[192:207], v[88:91], v[156:159], v[192:207]
    v_mfma_f32_32x32x16_bf16 v[208:223], v[92:95], v[156:159], v[208:223]
    v_mfma_f32_32x32x16_bf16 v[160:175], v[32:35], v[96:99], v[240:255]
    v_mfma_f32_32x32x16_bf16 v[160:175], v[40:43], v[104:107], v[160:175]
    v_mfma_f32_32x32x16_bf16 v[160:175], v[48:51], v[112:115], v[160:175]
    s_nop 5
    ds_write_b128 v6, v[176:179] offset:0
    ds_write_b128 v6, v[180:183] offset:1024
    v_mfma_f32_32x32x16_bf16 v[160:175], v[56:59], v[120:123], v[160:175]
    ds_write_b128 v6, v[184:187] offset:2048
    ds_write_b128 v6, v[188:191] offset:3072
    v_mfma_f32_32x32x16_bf16 v[160:175], v[64:67], v[128:131], v[160:175]
    ds_write_b128 v7, v[192:195] offset:0
    ds_write_b128 v7, v[196:199] offset:1024
    v_mfma_f32_32x32x16_bf16 v[160:175], v[72:75], v[136:139], v[160:175]
    ds_write_b128 v7, v[200:203] offset:2048
    ds_write_b128 v7, v[204:207] offset:3072
    v_mfma_f32_32x32x16_bf16 v[160:175], v[80:83], v[144:147], v[160:175]
    ds_write_b128 v8, v[208:211] offset:0
    ds_write_b128 v8, v[212:215] offset:1024
    v_mfma_f32_32x32x16_bf16 v[160:175], v[88:91], v[152:155], v[160:175]
    ds_write_b128 v8, v[216:219] offset:2048
    ds_write_b128 v8, v[220:223] offset:3072
    s_waitcnt lgkmcnt(0)
    s_branch L_padskip15
L_pad15:
    s_setpc_b64 s[98:99]
L_padskip15:
    s_barrier
    ds_read_b128 v[32:35], v9 offset:0
    ds_read_b128 v[48:51], v9 offset:4096
    ds_read_b128 v[64:67], v9 offset:8192
    ds_read_b128 v[36:39], v9 offset:1024
    ds_read_b128 v[52:55], v9 offset:5120
    ds_read_b128 v[68:71], v9 offset:9216
    ds_read_b128 v[40:43], v9 offset:2048
    ds_read_b128 v[56:59], v9 offset:6144
    ds_read_b128 v[72:75], v9 offset:10240
    ds_read_b128 v[44:47], v9 offset:3072
    ds_read_b128 v[60:63], v9 offset:7168
    ds_read_b128 v[76:79], v9 offset:11264
    s_waitcnt lgkmcnt(10)
    v_pk_add_f32 v[32:33], v[32:33], v[48:49]
    s_waitcnt lgkmcnt(9)
    v_pk_add_f32 v[160:161], v[160:161], v[64:65]
    v_pk_add_f32 v[160:161], v[160:161], v[32:33]
    v_pk_add_f32 v[34:35], v[34:35], v[50:51]
    v_pk_add_f32 v[162:163], v[162:163], v[66:67]
    v_pk_add_f32 v[162:163], v[162:163], v[34:35]
    s_waitcnt lgkmcnt(7)
    v_pk_add_f32 v[36:37], v[36:37], v[52:53]
    s_waitcnt lgkmcnt(6)
    v_pk_add_f32 v[164:165], v[164:165], v[68:69]
    v_pk_add_f32 v[164:165], v[164:165], v[36:37]
    v_pk_add_f32 v[38:39], v[38:39], v[54:55]
    v_pk_add_f32 v[166:167], v[166:167], v[70:71]
    v_pk_add_f32 v[166:167], v[166:167], v[38:39]
    s_waitcnt lgkmcnt(4)
    v_pk_add_f32 v[40:41], v[40:41], v[56:57]
    s_waitcnt lgkmcnt(3)
    v_pk_add_f32 v[168:169], v[168:169], v[72:73]
    v_pk_add_f32 v[168:169], v[168:169], v[40:41]
    v_pk_add_f32 v[42:43], v[42:43], v[58:59]
    v_pk_add_f32 v[170:171], v[170:171], v[74:75]
    v_pk_add_f32 v[170:171], v[170:171], v[42:43]
    s_waitcnt lgkmcnt(1)
    v_pk_add_f32 v[44:45], v[44:45], v[60:61]
    s_waitcnt lgkmcnt(0)
    v_pk_add_f32 v[172:173], v[172:173], v[76:77]
    v_pk_add_f32 v[172:173], v[172:173], v[44:45]
    v_pk_add_f32 v[46:47], v[46:47], v[62:63]
    v_pk_add_f32 v[174:175], v[174:175], v[78:79]
    v_pk_add_f32 v[174:175], v[174:175], v[46:47]
    v_cvt_pk_bf16_f32 v96, v160, v161
    v_cvt_pk_bf16_f32 v97, v162, v163
    v_cvt_pk_bf16_f32 v98, v164, v165
    v_cvt_pk_bf16_f32 v99, v166, v167
    v_cvt_pk_bf16_f32 v100, v168, v169
    v_cvt_pk_bf16_f32 v101, v170, v171
    v_cvt_pk_bf16_f32 v102, v172, v173
    v_cvt_pk_bf16_f32 v103, v174, v175
    buffer_store_dwordx4 v[96:99], v10, s[32:35], s68 offen offset:0
    buffer_store_dwordx4 v[100:103], v10, s[32:35], s68 offen offset:512
    v_mov_b32 v24, s57
    v_dot2_f32_bf16 v22, v96, v24, 0
    v_dot2_f32_bf16 v23, v96, v96, 0
    v_dot2_f32_bf16 v22, v97, v24, v22
    v_dot2_f32_bf16 v23, v97, v97, v23
    v_dot2_f32_bf16 v22, v98, v24, v22
    v_dot2_f32_bf16 v23, v98, v98, v23
    v_dot2_f32_bf16 v22, v99, v24, v22
    v_dot2_f32_bf16 v23, v99, v99, v23
    v_dot2_f32_bf16 v22, v100, v24, v22
    v_dot2_f32_bf16 v23, v100, v100, v23
    v_dot2_f32_bf16 v22, v101, v24, v22
    v_dot2_f32_bf16 v23, v101, v101, v23
    v_dot2_f32_bf16 v22, v102, v24, v22
    v_dot2_f32_bf16 v23, v102, v102, v23
    v_dot2_f32_bf16 v22, v103, v24, v22
    v_dot2_f32_bf16 v23, v103, v103, v23
    s_nop 1
    v_mov_b32 v24, v22
    v_mov_b32 v25, v23
    s_nop 0
    v_permlane32_swap_b32 v22, v24
    v_permlane32_swap_b32 v23, v25
    v_add_f32 v22, v22, v24
    v_add_f32 v23, v23, v25
    s_mov_b32 exec_hi, 0
    buffer_store_dwordx2 v[22:23], v3, s[32:35], s69 offen
    s_mov_b64 exec, -1
    s_waitcnt vmcnt(0)
    s_mov_b64 exec, 1
    s_cmp_lg_u32 s50, 0
    s_cbranch_scc0 L_pubslow_81
    buffer_store_dwordx2 v[12:13], off, s[32:35], s70 offset:0
L_pubback_82:
    s_mov_b64 exec, -1
    v_lshlrev_b32 v240, 16, v96
    v_and_b32 v241, 0xffff0000, v96
    v_lshlrev_b32 v242, 16, v97
    v_and_b32 v243, 0xffff0000, v97
    v_lshlrev_b32 v244, 16, v98
    v_and_b32 v245, 0xffff0000, v98
    v_lshlrev_b32 v246, 16, v99
    v_and_b32 v247, 0xffff0000, v99
    v_lshlrev_b32 v248, 16, v100
    v_and_b32 v249, 0xffff0000, v100
    v_lshlrev_b32 v250, 16, v101
    v_and_b32 v251, 0xffff0000, v101
    v_lshlrev_b32 v252, 16, v102
    v_and_b32 v253, 0xffff0000, v102
    v_lshlrev_b32 v254, 16, v103
    v_and_b32 v255, 0xffff0000, v103
L_p3join_75:
    s_barrier
    s_mul_i32 s72, s43, 100352
    s_mul_i32 s73, s44, 11264
    s_add_u32 s72, s72, s73
    s_add_u32 m0, s73, 112640
    s_add_u32 s65, s72, 2480128
    buffer_load_dwordx4 v1, s[32:35], s65 offen offset:0 sc1 lds
    buffer_load_dwordx4 v1, s[32:35], s65 offen offset:1024 sc1 lds
    buffer_load_dwordx4 v1, s[32:35], s65 offen offset:2048 sc1 lds
    buffer_load_dwordx4 v1, s[32:35], s65 offen offset:3072 sc1 lds
    s_add_u32 m0, s73, 116736
    s_add_u32 s65, s72, 2484224
    buffer_load_dwordx4 v1, s[32:35], s65 offen offset:0 sc1 lds
    buffer_load_dwordx4 v1, s[32:35], s65 offen offset:1024 sc1 lds
    buffer_load_dwordx4 v1, s[32:35], s65 offen offset:2048 sc1 lds
    buffer_load_dwordx4 v1, s[32:35], s65 offen offset:3072 sc1 lds
    s_add_u32 m0, s73, 120832
    s_add_u32 s65, s72, 2488320
    buffer_load_dwordx4 v1, s[32:35], s65 offen offset:0 sc1 lds
    buffer_load_dwordx4 v1, s[32:35], s65 offen offset:1024 sc1 lds
    buffer_load_dwordx4 v1, s[32:35], s65 offen offset:2048 sc1 lds
    s_mul_i32 s85, s52, 128
    s_add_u32 s85, s85, s47
    s_add_u32 s85, s85, 1328128
    s_mov_b64 exec, 0x3fff
    buffer_load_dwordx2 v[30:31], v3, s[32:35], s85 offen offset:0 sc1
    s_mov_b64 exec, -1
    s_add_u32 s63, s47, 786432
    s_add_u32 s64, s71, 1015808
    s_cmp_lg_u32 s50, 0
    s_cselect_b32 s63, s64, s63
    s_mul_i32 s80, s52, 28672
    s_add_u32 s80, s80, s63
    s_add_u32 s81, s80, 8192
    s_add_u32 s82, s80, 16384
    s_add_u32 s83, s80, 24576
    s_mul_i32 s84, s52, 3584
    s_add_u32 s84, s84, s47
    s_add_u32 s84, s84, 1245184
    s_lshl_b32 s60, s52, 4
    s_add_u32 s60, s60, s43
    s_mul_i32 s86, s60, 7168
    s_add_u32 s86, s86, s47
    s_add_u32 s86, s86, 1376256
    s_add_u32 s87, s86, 4096
    s_mul_i32 s88, s60, 8
    s_add_u32 s88, s88, s47
    s_add_u32 s88, s88, 1331200
    v_lshrrev_b32 v11, 4, v0
    v_lshlrev_b32 v11, 4, v11
    v_add_u32 v11, 162304, v11
    v_lshrrev_b32 v17, 5, v0
    v_lshlrev_b32 v17, 10, v17
    v_bfe_u32 v18, v0, 4, 1
    v_lshl_add_u32 v17, v18, 9, v17
    v_and_b32 v16, 15, v0
    v_lshl_add_u32 v17, v16, 4, v17
    v_lshlrev_b32 v18, 3, v18
    v_lshl_add_u32 v18, v16, 4, v18
    v_lshrrev_b32 v16, 5, v0
    v_lshl_add_u32 v18, v16, 9, v18
    v_add_u32 v28, 4096, v1
    v_add_u32 v19, 57344, v2
    s_min_u32 s72, s45, 3
    s_lshl_b32 s60, s72, 3
    s_add_u32 s60, s60, s44
    s_mul_i32 s89, s60, 32
    s_add_u32 s89, s89, s47
    s_add_u32 s89, s89, 1331200
    s_xor_b32 s60, s58, 0
    s_lshl_b32 s61, s72, 1
    s_add_u32 s60, s60, s61
    s_lshl_b32 s60, s60, 2
    s_add_u32 s60, s60, s44
    s_mul_i32 s62, s60, 28672
    s_add_u32 s62, s62, s47
    s_add_u32 s62, s62, 1376256
    s_add_u32 s60, 0, 0
    s_and_b32 s60, s60, 3
    s_mul_i32 s60, s60, 7168
    s_add_u32 s76, s62, s60
    s_add_u32 s60, 0, 1
    s_and_b32 s60, s60, 3
    s_mul_i32 s60, s60, 7168
    s_add_u32 s78, s62, s60
    s_add_u32 s60, 0, 2
    s_and_b32 s60, s60, 3
    s_mul_i32 s60, s60, 7168
    s_add_u32 s92, s62, s60
    s_add_u32 s60, 0, 3
    s_and_b32 s60, s60, 3
    s_mul_i32 s60, s60, 7168
    s_add_u32 s94, s62, s60
    s_xor_b32 s60, s58, 1
    s_lshl_b32 s61, s72, 1
    s_add_u32 s60, s60, s61
    s_lshl_b32 s60, s60, 2
    s_add_u32 s60, s60, s44
    s_mul_i32 s62, s60, 28672
    s_add_u32 s62, s62, s47
    s_add_u32 s62, s62, 1376256
    s_add_u32 s60, 0, 0
    s_and_b32 s60, s60, 3
    s_mul_i32 s60, s60, 7168
    s_add_u32 s77, s62, s60
    s_add_u32 s60, 0, 1
    s_and_b32 s60, s60, 3
    s_mul_i32 s60, s60, 7168
    s_add_u32 s79, s62, s60
    s_add_u32 s60, 0, 2
    s_and_b32 s60, s60, 3
    s_mul_i32 s60, s60, 7168
    s_add_u32 s93, s62, s60
    s_add_u32 s60, 0, 3
    s_and_b32 s60, s60, 3
    s_mul_i32 s60, s60, 7168
    s_add_u32 s95, s62, s60
    s_lshl_b32 s60, s72, 1
    s_add_u32 s60, s60, s58
    s_mul_i32 s90, s60, 3584
    s_add_u32 s90, s90, s47
    s_add_u32 s90, s90, 1245184
    v_lshlrev_b32 v16, 7, v0
    ds_read_b128 v[200:203], v2 offset:0
    ds_read_b128 v[204:207], v2 offset:1024
    ds_read_b128 v[208:211], v2 offset:2048
    ds_read_b128 v[212:215], v2 offset:3072
    s_branch L_padskip16
L_pad16:
    s_setpc_b64 s[98:99]
L_padskip16:
    s_mov_b64 exec, 0x3fff
    s_mov_b32 s66, 0
L_poll_83:
    buffer_load_dwordx2 v[236:237], v3, s[32:35], s85 offen sc1
    s_add_u32 s66, s66, 1
    s_cmp_gt_u32 s66, 65536
    s_cbranch_scc1 L_pollout_84
    s_waitcnt vmcnt(1)
    v_cmp_ne_u64 vcc, s[48:49], v[30:31]
    s_nop 0
    s_cbranch_vccz L_pollout_84
    buffer_load_dwordx2 v[30:31], v3, s[32:35], s85 offen sc1
    s_waitcnt vmcnt(1)
    v_cmp_ne_u64 vcc, s[48:49], v[236:237]
    s_nop 0
    s_cbranch_vccnz L_poll_83
L_pollout_84:
    s_mov_b64 exec, -1
    s_cmp_lg_u32 s50, 0
    s_cbranch_scc0 L_acq_85
L_acqback_86:
    buffer_load_dwordx4 v[32:35], v1, s[32:35], s80 offen offset:0 sc1
    buffer_load_dwordx4 v[36:39], v1, s[32:35], s80 offen offset:1024 sc1
    buffer_load_dwordx4 v[40:43], v1, s[32:35], s80 offen offset:2048 sc1
    buffer_load_dwordx4 v[44:47], v1, s[32:35], s80 offen offset:3072 sc1
    buffer_load_dwordx4 v[48:51], v28, s[32:35], s80 offen offset:0 sc1
    buffer_load_dwordx4 v[52:55], v28, s[32:35], s80 offen offset:1024 sc1
    buffer_load_dwordx4 v[56:59], v28, s[32:35], s80 offen offset:2048 sc1
    buffer_load_dwordx4 v[60:63], v28, s[32:35], s80 offen offset:3072 sc1
    s_barrier
    s_waitcnt vmcnt(6) lgkmcnt(2)
    v_mfma_f32_16x16x32_bf16 v[144:147], v[200:203], v[32:35], 0
    ds_read_b128 v[216:219], v2 offset:4096
    v_mfma_f32_16x16x32_bf16 v[148:151], v[200:203], v[36:39], 0
    buffer_load_dwordx4 v[64:67], v1, s[32:35], s81 offen offset:0 sc1
    v_mfma_f32_16x16x32_bf16 v[152:155], v[204:207], v[32:35], 0
    ds_read_b128 v[220:223], v2 offset:5120
    v_mfma_f32_16x16x32_bf16 v[156:159], v[204:207], v[36:39], 0
    s_waitcnt lgkmcnt(2)
    v_mfma_f32_16x16x32_bf16 v[160:163], v[208:211], v[32:35], 0
    ds_read_b128 v[200:203], v2 offset:6144
    v_mfma_f32_16x16x32_bf16 v[164:167], v[208:211], v[36:39], 0
    buffer_load_dwordx4 v[68:71], v1, s[32:35], s81 offen offset:1024 sc1
    v_mfma_f32_16x16x32_bf16 v[168:171], v[212:215], v[32:35], 0
    ds_read_b128 v[204:207], v2 offset:7168
    v_mfma_f32_16x16x32_bf16 v[172:175], v[212:215], v[36:39], 0
    s_waitcnt vmcnt(6) lgkmcnt(2)
    v_mfma_f32_16x16x32_bf16 v[144:147], v[216:219], v[40:43], v[144:147]
    ds_read_b128 v[208:211], v2 offset:8192
    v_mfma_f32_16x16x32_bf16 v[148:151], v[216:219], v[44:47], v[148:151]
    buffer_load_dwordx4 v[72:75], v1, s[32:35], s81 offen offset:2048 sc1
    v_mfma_f32_16x16x32_bf16 v[152:155], v[220:223], v[40:43], v[152:155]
    ds_read_b128 v[212:215], v2 offset:9216
    v_mfma_f32_16x16x32_bf16 v[156:159], v[220:223], v[44:47], v[156:159]
    s_waitcnt lgkmcnt(2)
    v_mfma_f32_16x16x32_bf16 v[160:163], v[200:203], v[40:43], v[160:163]
    ds_read_b128 v[216:219], v2 offset:10240
    v_mfma_f32_16x16x32_bf16 v[164:167], v[200:203], v[44:47], v[164:167]
    buffer_load_dwordx4 v[76:79], v1, s[32:35], s81 offen offset:3072 sc1
    v_mfma_f32_16x16x32_bf16 v[168:171], v[204:207], v[40:43], v[168:171]
    ds_read_b128 v[220:223], v2 offset:11264
    v_mfma_f32_16x16x32_bf16 v[172:175], v[204:207], v[44:47], v[172:175]
    s_waitcnt vmcnt(6) lgkmcnt(2)
    v_mfma_f32_16x16x32_bf16 v[144:147], v[208:211], v[48:51], v[144:147]
    ds_read_b128 v[200:203], v2 offset:12288
    v_mfma_f32_16x16x32_bf16 v[148:151], v[208:211], v[52:55], v[148:151]
    buffer_load_dwordx4 v[80:83], v28, s[32:35], s81 offen offset:0 sc1
    v_mfma_f32_16x16x32_bf16 v[152:155], v[212:215], v[48:51], v[152:155]
    ds_read_b128 v[204:207], v2 offset:13312
    v_mfma_f32_16x16x32_bf16 v[156:159], v[212:215], v[52:55], v[156:159]
    s_waitcnt lgkmcnt(2)
    v_mfma_f32_16x16x32_bf16 v[160:163], v[216:219], v[48:51], v[160:163]
    ds_read_b128 v[208:211], v2 offset:14336
    v_mfma_f32_16x16x32_bf16 v[164:167], v[216:219], v[52:55], v[164:167]
    buffer_load_dwordx4 v[84:87], v28, s[32:35], s81 offen offset:1024 sc1
    v_mfma_f32_16x16x32_bf16 v[168:171], v[220:223], v[48:51], v[168:171]
    ds_read_b128 v[212:215], v2 offset:15360
    v_mfma_f32_16x16x32_bf16 v[172:175], v[220:223], v[52:55], v[172:175]
    s_waitcnt vmcnt(6) lgkmcnt(2)
    v_mfma_f32_16x16x32_bf16 v[144:147], v[200:203], v[56:59], v[144:147]
    ds_read_b128 v[216:219], v2 offset:16384
    v_mfma_f32_16x16x32_bf16 v[148:151], v[200:203], v[60:63], v[148:151]
    buffer_load_dwordx4 v[88:91], v28, s[32:35], s81 offen offset:2048 sc1
    v_mfma_f32_16x16x32_bf16 v[152:155], v[204:207], v[56:59], v[152:155]
    ds_read_b128 v[220:223], v2 offset:17408
    v_mfma_f32_16x16x32_bf16 v[156:159], v[204:207], v[60:63], v[156:159]
    s_waitcnt lgkmcnt(2)
    v_mfma_f32_16x16x32_bf16 v[160:163], v[208:211], v[56:59], v[160:163]
    ds_read_b128 v[200:203], v2 offset:18432
    v_mfma_f32_16x16x32_bf16 v[164:167], v[208:211], v[60:63], v[164:167]
    buffer_load_dwordx4 v[92:95], v28, s[32:35], s81 offen offset:3072 sc1
    v_mfma_f32_16x16x32_bf16 v[168:171], v[212:215], v[56:59], v[168:171]
    ds_read_b128 v[204:207], v2 offset:19456
    v_mfma_f32_16x16x32_bf16 v[172:175], v[212:215], v[60:63], v[172:175]
    s_waitcnt vmcnt(6) lgkmcnt(2)
    v_mfma_f32_16x16x32_bf16 v[144:147], v[216:219], v[64:67], v[144:147]
    ds_read_b128 v[208:211], v2 offset:20480
    v_mfma_f32_16x16x32_bf16 v[148:151], v[216:219], v[68:71], v[148:151]
    buffer_load_dwordx4 v[96:99], v1, s[32:35], s82 offen offset:0 sc1
    v_mfma_f32_16x16x32_bf16 v[152:155], v[220:223], v[64:67], v[152:155]
    ds_read_b128 v[212:215], v2 offset:21504
    v_mfma_f32_16x16x32_bf16 v[156:159], v[220:223], v[68:71], v[156:159]
    s_waitcnt lgkmcnt(2)
    v_mfma_f32_16x16x32_bf16 v[160:163], v[200:203], v[64:67], v[160:163]
    ds_read_b128 v[216:219], v2 offset:22528
    v_mfma_f32_16x16x32_bf16 v[164:167], v[200:203], v[68:71], v[164:167]
    buffer_load_dwordx4 v[100:103], v1, s[32:35], s82 offen offset:1024 sc1
    v_mfma_f32_16x16x32_bf16 v[168:171], v[204:207], v[64:67], v[168:171]
    ds_read_b128 v[220:223], v2 offset:23552
    v_mfma_f32_16x16x32_bf16 v[172:175], v[204:207], v[68:71], v[172:175]
    s_waitcnt vmcnt(6) lgkmcnt(2)
    v_mfma_f32_16x16x32_bf16 v[144:147], v[208:211], v[72:75], v[144:147]
    ds_read_b128 v[200:203], v2 offset:24576
    v_mfma_f32_16x16x32_bf16 v[148:151], v[208:211], v[76:79], v[148:151]
    buffer_load_dwordx4 v[104:107], v1, s[32:35], s82 offen offset:2048 sc1
    v_mfma_f32_16x16x32_bf16 v[152:155], v[212:215], v[72:75], v[152:155]
    ds_read_b128 v[204:207], v2 offset:25600
    v_mfma_f32_16x16x32_bf16 v[156:159], v[212:215], v[76:79], v[156:159]
    s_waitcnt lgkmcnt(2)
    v_mfma_f32_16x16x32_bf16 v[160:163], v[216:219], v[72:75], v[160:163]
    ds_read_b128 v[208:211], v2 offset:26624
    v_mfma_f32_16x16x32_bf16 v[164:167], v[216:219], v[76:79], v[164:167]
    buffer_load_dwordx4 v[108:111], v1, s[32:35], s82 offen offset:3072 sc1
    v_mfma_f32_16x16x32_bf16 v[168:171], v[220:223], v[72:75], v[168:171]
    ds_read_b128 v[212:215], v2 offset:27648
    v_mfma_f32_16x16x32_bf16 v[172:175], v[220:223], v[76:79], v[172:175]
    s_waitcnt vmcnt(6) lgkmcnt(2)
    v_mfma_f32_16x16x32_bf16 v[144:147], v[200:203], v[80:83], v[144:147]
    ds_read_b128 v[216:219], v2 offset:28672
    v_mfma_f32_16x16x32_bf16 v[148:151], v[200:203], v[84:87], v[148:151]
    buffer_load_dwordx4 v[112:115], v28, s[32:35], s82 offen offset:0 sc1
    v_mfma_f32_16x16x32_bf16 v[152:155], v[204:207], v[80:83], v[152:155]
    ds_read_b128 v[220:223], v2 offset:29696
    v_mfma_f32_16x16x32_bf16 v[156:159], v[204:207], v[84:87], v[156:159]
    s_waitcnt lgkmcnt(2)
    v_mfma_f32_16x16x32_bf16 v[160:163], v[208:211], v[80:83], v[160:163]
    ds_read_b128 v[200:203], v2 offset:30720
    v_mfma_f32_16x16x32_bf16 v[164:167], v[208:211], v[84:87], v[164:167]
    buffer_load_dwordx4 v[116:119], v28, s[32:35], s82 offen offset:1024 sc1
    v_mfma_f32_16x16x32_bf16 v[168:171], v[212:215], v[80:83], v[168:171]
    ds_read_b128 v[204:207], v2 offset:31744
    v_mfma_f32_16x16x32_bf16 v[172:175], v[212:215], v[84:87], v[172:175]
    buffer_load_dwordx2 v[224:225], v4, s[32:35], s84 offen offset:0 sc1
    s_waitcnt vmcnt(7) lgkmcnt(2)
    v_mfma_f32_16x16x32_bf16 v[144:147], v[216:219], v[88:91], v[144:147]
    ds_read_b128 v[208:211], v2 offset:32768
    v_mfma_f32_16x16x32_bf16 v[148:151], v[216:219], v[92:95], v[148:151]
    buffer_load_dwordx4 v[120:123], v28, s[32:35], s82 offen offset:2048 sc1
    v_mfma_f32_16x16x32_bf16 v[152:155], v[220:223], v[88:91], v[152:155]
    ds_read_b128 v[212:215], v2 offset:33792
    v_mfma_f32_16x16x32_bf16 v[156:159], v[220:223], v[92:95], v[156:159]
    buffer_load_dwordx2 v[226:227], v4, s[32:35], s84 offen offset:256 sc1
    s_waitcnt lgkmcnt(2)
    v_mfma_f32_16x16x32_bf16 v[160:163], v[200:203], v[88:91], v[160:163]
    ds_read_b128 v[216:219], v2 offset:34816
    v_mfma_f32_16x16x32_bf16 v[164:167], v[200:203], v[92:95], v[164:167]
    buffer_load_dwordx4 v[124:127], v28, s[32:35], s82 offen offset:3072 sc1
    v_mfma_f32_16x16x32_bf16 v[168:171], v[204:207], v[88:91], v[168:171]
    ds_read_b128 v[220:223], v2 offset:35840
    v_mfma_f32_16x16x32_bf16 v[172:175], v[204:207], v[92:95], v[172:175]
    buffer_load_dwordx2 v[228:229], v4, s[32:35], s84 offen offset:512 sc1
    s_waitcnt vmcnt(9) lgkmcnt(2)
    v_mfma_f32_16x16x32_bf16 v[144:147], v[208:211], v[96:99], v[144:147]
    ds_read_b128 v[200:203], v2 offset:36864
    v_mfma_f32_16x16x32_bf16 v[148:151], v[208:211], v[100:103], v[148:151]
    buffer_load_dwordx4 v[128:131], v1, s[32:35], s83 offen offset:0 sc1
    v_mfma_f32_16x16x32_bf16 v[152:155], v[212:215], v[96:99], v[152:155]
    ds_read_b128 v[204:207], v2 offset:37888
    v_mfma_f32_16x16x32_bf16 v[156:159], v[212:215], v[100:103], v[156:159]
    buffer_load_dwordx2 v[230:231], v4, s[32:35], s84 offen offset:768 sc1
    s_waitcnt lgkmcnt(2)
    v_mfma_f32_16x16x32_bf16 v[160:163], v[216:219], v[96:99], v[160:163]
    ds_read_b128 v[208:211], v2 offset:38912
    v_mfma_f32_16x16x32_bf16 v[164:167], v[216:219], v[100:103], v[164:167]
    buffer_load_dwordx4 v[132:135], v1, s[32:35], s83 offen offset:1024 sc1
    v_mfma_f32_16x16x32_bf16 v[168:171], v[220:223], v[96:99], v[168:171]
    ds_read_b128 v[212:215], v2 offset:39936
    v_mfma_f32_16x16x32_bf16 v[172:175], v[220:223], v[100:103], v[172:175]
    buffer_load_dwordx2 v[232:233], v4, s[32:35], s84 offen offset:1024 sc1
    s_waitcnt vmcnt(11) lgkmcnt(2)
    v_mfma_f32_16x16x32_bf16 v[144:147], v[200:203], v[104:107], v[144:147]
    ds_read_b128 v[216:219], v2 offset:40960
    v_mfma_f32_16x16x32_bf16 v[148:151], v[200:203], v[108:111], v[148:151]
    buffer_load_dwordx4 v[136:139], v1, s[32:35], s83 offen offset:2048 sc1
    v_mfma_f32_16x16x32_bf16 v[152:155], v[204:207], v[104:107], v[152:155]
    ds_read_b128 v[220:223], v2 offset:41984
    v_mfma_f32_16x16x32_bf16 v[156:159], v[204:207], v[108:111], v[156:159]
    buffer_load_dwordx2 v[234:235], v4, s[32:35], s84 offen offset:1280 sc1
    s_waitcnt lgkmcnt(2)
    v_mfma_f32_16x16x32_bf16 v[160:163], v[208:211], v[104:107], v[160:163]
    ds_read_b128 v[200:203], v2 offset:43008
    v_mfma_f32_16x16x32_bf16 v[164:167], v[208:211], v[108:111], v[164:167]
    buffer_load_dwordx4 v[140:143], v1, s[32:35], s83 offen offset:3072 sc1
    v_mfma_f32_16x16x32_bf16 v[168:171], v[212:215], v[104:107], v[168:171]
    ds_read_b128 v[204:207], v2 offset:44032
    v_mfma_f32_16x16x32_bf16 v[172:175], v[212:215], v[108:111], v[172:175]
    buffer_load_dwordx2 v[236:237], v4, s[32:35], s84 offen offset:1536 sc1
    s_waitcnt vmcnt(13) lgkmcnt(2)
    v_mfma_f32_16x16x32_bf16 v[144:147], v[216:219], v[112:115], v[144:147]
    ds_read_b128 v[208:211], v2 offset:45056
    v_mfma_f32_16x16x32_bf16 v[148:151], v[216:219], v[116:119], v[148:151]
    v_mfma_f32_16x16x32_bf16 v[152:155], v[220:223], v[112:115], v[152:155]
    ds_read_b128 v[212:215], v2 offset:46080
    v_mfma_f32_16x16x32_bf16 v[156:159], v[220:223], v[116:119], v[156:159]
    s_waitcnt lgkmcnt(2)
    v_mfma_f32_16x16x32_bf16 v[160:163], v[200:203], v[112:115], v[160:163]
    ds_read_b128 v[216:219], v2 offset:47104
    v_mfma_f32_16x16x32_bf16 v[164:167], v[200:203], v[116:119], v[164:167]
    v_mfma_f32_16x16x32_bf16 v[168:171], v[204:207], v[112:115], v[168:171]
    ds_read_b128 v[220:223], v2 offset:48128
    v_mfma_f32_16x16x32_bf16 v[172:175], v[204:207], v[116:119], v[172:175]
    s_waitcnt vmcnt(9) lgkmcnt(2)
    v_mfma_f32_16x16x32_bf16 v[144:147], v[208:211], v[120:123], v[144:147]
    ds_read_b128 v[200:203], v2 offset:49152
    v_add_f32 v224, v224, v226
    v_mfma_f32_16x16x32_bf16 v[148:151], v[208:211], v[124:127], v[148:151]
    v_add_f32 v225, v225, v227
    s_waitcnt vmcnt(8)
    v_add_f32 v224, v224, v228
    v_mfma_f32_16x16x32_bf16 v[152:155], v[212:215], v[120:123], v[152:155]
    ds_read_b128 v[204:207], v2 offset:50176
    v_add_f32 v225, v225, v229
    v_mfma_f32_16x16x32_bf16 v[156:159], v[212:215], v[124:127], v[156:159]
    s_waitcnt vmcnt(6)
    v_add_f32 v224, v224, v230
    s_waitcnt lgkmcnt(2)
    v_mfma_f32_16x16x32_bf16 v[160:163], v[216:219], v[120:123], v[160:163]
    ds_read_b128 v[208:211], v2 offset:51200
    v_add_f32 v225, v225, v231
    v_mfma_f32_16x16x32_bf16 v[164:167], v[216:219], v[124:127], v[164:167]
    s_waitcnt vmcnt(4)
    v_add_f32 v224, v224, v232
    v_add_f32 v225, v225, v233
    v_mfma_f32_16x16x32_bf16 v[168:171], v[220:223], v[120:123], v[168:171]
    ds_read_b128 v[212:215], v2 offset:52224
    s_waitcnt vmcnt(2)
    v_add_f32 v224, v224, v234
    v_mfma_f32_16x16x32_bf16 v[172:175], v[220:223], v[124:127], v[172:175]
    v_add_f32 v225, v225, v235
    s_waitcnt lgkmcnt(2)
    v_mfma_f32_16x16x32_bf16 v[144:147], v[200:203], v[128:131], v[144:147]
    ds_read_b128 v[216:219], v2 offset:53248
    s_waitcnt vmcnt(0)
    v_add_f32 v224, v224, v236
    v_mfma_f32_16x16x32_bf16 v[148:151], v[200:203], v[132:135], v[148:151]
    v_add_f32 v225, v225, v237
    v_mov_b32 v226, v224
    v_mfma_f32_16x16x32_bf16 v[152:155], v[204:207], v[128:131], v[152:155]
    ds_read_b128 v[220:223], v2 offset:54272
    v_mov_b32 v227, v225
    v_mfma_f32_16x16x32_bf16 v[156:159], v[204:207], v[132:135], v[156:159]
    s_nop 0
    s_waitcnt lgkmcnt(2)
    v_mfma_f32_16x16x32_bf16 v[160:163], v[208:211], v[128:131], v[160:163]
    ds_read_b128 v[200:203], v2 offset:55296
    v_mfma_f32_16x16x32_bf16 v[164:167], v[208:211], v[132:135], v[164:167]
    v_permlane32_swap_b32 v224, v226
    v_mfma_f32_16x16x32_bf16 v[168:171], v[212:215], v[128:131], v[168:171]
    ds_read_b128 v[204:207], v2 offset:56320
    v_mfma_f32_16x16x32_bf16 v[172:175], v[212:215], v[132:135], v[172:175]
    s_waitcnt lgkmcnt(2)
    v_mfma_f32_16x16x32_bf16 v[144:147], v[216:219], v[136:139], v[144:147]
    ds_read_b128 v[208:211], v19 offset:0
    v_mfma_f32_16x16x32_bf16 v[148:151], v[216:219], v[140:143], v[148:151]
    v_permlane32_swap_b32 v225, v227
    v_mfma_f32_16x16x32_bf16 v[152:155], v[220:223], v[136:139], v[152:155]
    ds_read_b128 v[212:215], v19 offset:1024
    v_add_f32 v224, v224, v226
    v_mfma_f32_16x16x32_bf16 v[156:159], v[220:223], v[140:143], v[156:159]
    v_add_f32 v225, v225, v227
    s_waitcnt lgkmcnt(2)
    v_mfma_f32_16x16x32_bf16 v[160:163], v[200:203], v[136:139], v[160:163]
    ds_read_b128 v[216:219], v19 offset:2048
    v_mul_f32 v14, 0xbb124925, v224
    v_mfma_f32_16x16x32_bf16 v[164:167], v[200:203], v[140:143], v[164:167]
    v_mul_f32 v225, 0x3b124925, v225
    v_fma_f32 v225, -v14, v14, v225
    v_mfma_f32_16x16x32_bf16 v[168:171], v[204:207], v[136:139], v[168:171]
    ds_read_b128 v[220:223], v19 offset:3072
    v_max_f32 v225, 0, v225
    v_mfma_f32_16x16x32_bf16 v[172:175], v[204:207], v[140:143], v[172:175]
    v_add_f32 v225, 0x3727c5ac, v225
    v_rsq_f32 v15, v225
    v_mov_b32 v15, v14
    s_nop 0
    s_nop 0
    v_permlane16_swap_b32 v14, v15
    s_branch L_padskip17
L_pad17:
    s_setpc_b64 s[98:99]
L_padskip17:
    ds_read_b128 v[224:227], v11 offset:0
    ds_read_b128 v[228:231], v11 offset:64
    ds_read_b128 v[232:235], v11 offset:128
    ds_read_b128 v[236:239], v11 offset:192
    s_waitcnt lgkmcnt(3)
    v_pk_fma_f32 v[144:145], v[224:225], v[14:15], v[144:145] op_sel:[0,0,0] op_sel_hi:[1,0,1]
    v_pk_fma_f32 v[146:147], v[226:227], v[14:15], v[146:147] op_sel:[0,0,0] op_sel_hi:[1,0,1]
    s_waitcnt lgkmcnt(2)
    v_pk_fma_f32 v[152:153], v[228:229], v[14:15], v[152:153] op_sel:[0,0,0] op_sel_hi:[1,0,1]
    v_pk_fma_f32 v[154:155], v[230:231], v[14:15], v[154:155] op_sel:[0,0,0] op_sel_hi:[1,0,1]
    v_cvt_pk_bf16_f32 v20, v144, v145
    v_cvt_pk_bf16_f32 v21, v146, v147
    v_cvt_pk_bf16_f32 v22, v152, v153
    v_cvt_pk_bf16_f32 v23, v154, v155
    v_pk_max_i16 v20, v20, 0
    v_pk_max_i16 v21, v21, 0
    v_pk_max_i16 v22, v22, 0
    v_pk_max_i16 v23, v23, 0
    buffer_store_dwordx4 v[20:23], v17, s[32:35], s86 offen offset:0 sc1
    v_pk_fma_f32 v[148:149], v[224:225], v[14:15], v[148:149] op_sel:[0,1,0] op_sel_hi:[1,1,1]
    v_pk_fma_f32 v[150:151], v[226:227], v[14:15], v[150:151] op_sel:[0,1,0] op_sel_hi:[1,1,1]
    v_pk_fma_f32 v[156:157], v[228:229], v[14:15], v[156:157] op_sel:[0,1,0] op_sel_hi:[1,1,1]
    v_pk_fma_f32 v[158:159], v[230:231], v[14:15], v[158:159] op_sel:[0,1,0] op_sel_hi:[1,1,1]
    v_cvt_pk_bf16_f32 v24, v148, v149
    v_cvt_pk_bf16_f32 v25, v150, v151
    v_cvt_pk_bf16_f32 v26, v156, v157
    v_cvt_pk_bf16_f32 v27, v158, v159
    v_pk_max_i16 v24, v24, 0
    v_pk_max_i16 v25, v25, 0
    v_pk_max_i16 v26, v26, 0
    v_pk_max_i16 v27, v27, 0
    buffer_store_dwordx4 v[24:27], v17, s[32:35], s86 offen offset:256 sc1
    s_waitcnt lgkmcnt(1)
    v_pk_fma_f32 v[160:161], v[232:233], v[14:15], v[160:161] op_sel:[0,0,0] op_sel_hi:[1,0,1]
    v_pk_fma_f32 v[162:163], v[234:235], v[14:15], v[162:163] op_sel:[0,0,0] op_sel_hi:[1,0,1]
    s_waitcnt lgkmcnt(0)
    v_pk_fma_f32 v[168:169], v[236:237], v[14:15], v[168:169] op_sel:[0,0,0] op_sel_hi:[1,0,1]
    v_pk_fma_f32 v[170:171], v[238:239], v[14:15], v[170:171] op_sel:[0,0,0] op_sel_hi:[1,0,1]
    v_cvt_pk_bf16_f32 v20, v160, v161
    v_cvt_pk_bf16_f32 v21, v162, v163
    v_cvt_pk_bf16_f32 v22, v168, v169
    v_cvt_pk_bf16_f32 v23, v170, v171
    v_pk_max_i16 v20, v20, 0
    v_pk_max_i16 v21, v21, 0
    v_pk_max_i16 v22, v22, 0
    v_pk_max_i16 v23, v23, 0
    buffer_store_dwordx4 v[20:23], v17, s[32:35], s86 offen offset:2048 sc1
    v_pk_fma_f32 v[164:165], v[232:233], v[14:15], v[164:165] op_sel:[0,1,0] op_sel_hi:[1,1,1]
    v_pk_fma_f32 v[166:167], v[234:235], v[14:15], v[166:167] op_sel:[0,1,0] op_sel_hi:[1,1,1]
    v_pk_fma_f32 v[172:173], v[236:237], v[14:15], v[172:173] op_sel:[0,1,0] op_sel_hi:[1,1,1]
    v_pk_fma_f32 v[174:175], v[238:239], v[14:15], v[174:175] op_sel:[0,1,0] op_sel_hi:[1,1,1]
    v_cvt_pk_bf16_f32 v24, v164, v165
    v_cvt_pk_bf16_f32 v25, v166, v167
    v_cvt_pk_bf16_f32 v26, v172, v173
    v_cvt_pk_bf16_f32 v27, v174, v175
    v_pk_max_i16 v24, v24, 0
    v_pk_max_i16 v25, v25, 0
    v_pk_max_i16 v26, v26, 0
    v_pk_max_i16 v27, v27, 0
    buffer_store_dwordx4 v[24:27], v17, s[32:35], s86 offen offset:2304 sc1
    v_mfma_f32_16x16x32_bf16 v[176:179], v[208:211], v[32:35], 0
    ds_read_b128 v[200:203], v19 offset:4096
    v_mfma_f32_16x16x32_bf16 v[180:183], v[208:211], v[36:39], 0
    v_mfma_f32_16x16x32_bf16 v[184:187], v[212:215], v[32:35], 0
    ds_read_b128 v[204:207], v19 offset:5120
    v_mfma_f32_16x16x32_bf16 v[188:191], v[212:215], v[36:39], 0
    v_mfma_f32_16x16x32_bf16 v[192:195], v[216:219], v[32:35], 0
    ds_read_b128 v[208:211], v19 offset:6144
    v_mfma_f32_16x16x32_bf16 v[196:199], v[216:219], v[36:39], 0
    v_mfma_f32_16x16x32_bf16 v[176:179], v[220:223], v[40:43], v[176:179]
    ds_read_b128 v[212:215], v19 offset:7168
    v_mfma_f32_16x16x32_bf16 v[180:183], v[220:223], v[44:47], v[180:183]
    s_waitcnt lgkmcnt(2)
    v_mfma_f32_16x16x32_bf16 v[184:187], v[200:203], v[40:43], v[184:187]
    ds_read_b128 v[216:219], v19 offset:8192
    v_mfma_f32_16x16x32_bf16 v[188:191], v[200:203], v[44:47], v[188:191]
    v_mfma_f32_16x16x32_bf16 v[192:195], v[204:207], v[40:43], v[192:195]
    ds_read_b128 v[220:223], v19 offset:9216
    v_mfma_f32_16x16x32_bf16 v[196:199], v[204:207], v[44:47], v[196:199]
    s_waitcnt lgkmcnt(2)
    v_mfma_f32_16x16x32_bf16 v[176:179], v[208:211], v[48:51], v[176:179]
    ds_read_b128 v[200:203], v19 offset:10240
    v_mfma_f32_16x16x32_bf16 v[180:183], v[208:211], v[52:55], v[180:183]
    v_mfma_f32_16x16x32_bf16 v[184:187], v[212:215], v[48:51], v[184:187]
    ds_read_b128 v[204:207], v19 offset:11264
    v_mfma_f32_16x16x32_bf16 v[188:191], v[212:215], v[52:55], v[188:191]
    s_waitcnt lgkmcnt(2)
    v_mfma_f32_16x16x32_bf16 v[192:195], v[216:219], v[48:51], v[192:195]
    ds_read_b128 v[208:211], v19 offset:12288
    v_mfma_f32_16x16x32_bf16 v[196:199], v[216:219], v[52:55], v[196:199]
    v_mfma_f32_16x16x32_bf16 v[176:179], v[220:223], v[56:59], v[176:179]
    ds_read_b128 v[212:215], v19 offset:13312
    v_mfma_f32_16x16x32_bf16 v[180:183], v[220:223], v[60:63], v[180:183]
    s_waitcnt vmcnt(0)
    s_mov_b64 exec, 1
    s_cmp_lg_u32 s50, 0
    s_cbranch_scc0 L_pubslow_87
    buffer_store_dwordx2 v[12:13], off, s[32:35], s88 offset:0
L_pubback_88:
    s_mov_b64 exec, -1
    s_waitcnt lgkmcnt(2)
    v_mfma_f32_16x16x32_bf16 v[184:187], v[200:203], v[56:59], v[184:187]
    ds_read_b128 v[216:219], v19 offset:14336
    v_mfma_f32_16x16x32_bf16 v[188:191], v[200:203], v[60:63], v[188:191]
    v_mfma_f32_16x16x32_bf16 v[192:195], v[204:207], v[56:59], v[192:195]
    ds_read_b128 v[220:223], v19 offset:15360
    v_mfma_f32_16x16x32_bf16 v[196:199], v[204:207], v[60:63], v[196:199]
    s_waitcnt lgkmcnt(2)
    v_mfma_f32_16x16x32_bf16 v[176:179], v[208:211], v[64:67], v[176:179]
    ds_read_b128 v[200:203], v19 offset:16384
    v_mfma_f32_16x16x32_bf16 v[180:183], v[208:211], v[68:71], v[180:183]
    v_mfma_f32_16x16x32_bf16 v[184:187], v[212:215], v[64:67], v[184:187]
    ds_read_b128 v[204:207], v19 offset:17408
    v_mfma_f32_16x16x32_bf16 v[188:191], v[212:215], v[68:71], v[188:191]
    s_waitcnt lgkmcnt(2)
    v_mfma_f32_16x16x32_bf16 v[192:195], v[216:219], v[64:67], v[192:195]
    ds_read_b128 v[208:211], v19 offset:18432
    v_mfma_f32_16x16x32_bf16 v[196:199], v[216:219], v[68:71], v[196:199]
    v_mfma_f32_16x16x32_bf16 v[176:179], v[220:223], v[72:75], v[176:179]
    ds_read_b128 v[212:215], v19 offset:19456
    v_mfma_f32_16x16x32_bf16 v[180:183], v[220:223], v[76:79], v[180:183]
    s_waitcnt lgkmcnt(2)
    v_mfma_f32_16x16x32_bf16 v[184:187], v[200:203], v[72:75], v[184:187]
    ds_read_b128 v[216:219], v19 offset:20480
    v_mfma_f32_16x16x32_bf16 v[188:191], v[200:203], v[76:79], v[188:191]
    v_mfma_f32_16x16x32_bf16 v[192:195], v[204:207], v[72:75], v[192:195]
    ds_read_b128 v[220:223], v19 offset:21504
    v_mfma_f32_16x16x32_bf16 v[196:199], v[204:207], v[76:79], v[196:199]
    s_waitcnt lgkmcnt(2)
    v_mfma_f32_16x16x32_bf16 v[176:179], v[208:211], v[80:83], v[176:179]
    ds_read_b128 v[200:203], v19 offset:22528
    v_mfma_f32_16x16x32_bf16 v[180:183], v[208:211], v[84:87], v[180:183]
    v_mfma_f32_16x16x32_bf16 v[184:187], v[212:215], v[80:83], v[184:187]
    ds_read_b128 v[204:207], v19 offset:23552
    v_mfma_f32_16x16x32_bf16 v[188:191], v[212:215], v[84:87], v[188:191]
    s_waitcnt lgkmcnt(2)
    v_mfma_f32_16x16x32_bf16 v[192:195], v[216:219], v[80:83], v[192:195]
    ds_read_b128 v[208:211], v19 offset:24576
    v_mfma_f32_16x16x32_bf16 v[196:199], v[216:219], v[84:87], v[196:199]
    v_mfma_f32_16x16x32_bf16 v[176:179], v[220:223], v[88:91], v[176:179]
    ds_read_b128 v[212:215], v19 offset:25600
    v_mfma_f32_16x16x32_bf16 v[180:183], v[220:223], v[92:95], v[180:183]
    s_waitcnt lgkmcnt(2)
    v_mfma_f32_16x16x32_bf16 v[184:187], v[200:203], v[88:91], v[184:187]
    ds_read_b128 v[216:219], v19 offset:26624
    v_mfma_f32_16x16x32_bf16 v[188:191], v[200:203], v[92:95], v[188:191]
    v_mfma_f32_16x16x32_bf16 v[192:195], v[204:207], v[88:91], v[192:195]
    ds_read_b128 v[220:223], v19 offset:27648
    v_mfma_f32_16x16x32_bf16 v[196:199], v[204:207], v[92:95], v[196:199]
    s_waitcnt lgkmcnt(2)
    v_mfma_f32_16x16x32_bf16 v[176:179], v[208:211], v[96:99], v[176:179]
    ds_read_b128 v[200:203], v19 offset:28672
    v_mfma_f32_16x16x32_bf16 v[180:183], v[208:211], v[100:103], v[180:183]
    v_mfma_f32_16x16x32_bf16 v[184:187], v[212:215], v[96:99], v[184:187]
    ds_read_b128 v[204:207], v19 offset:29696
    v_mfma_f32_16x16x32_bf16 v[188:191], v[212:215], v[100:103], v[188:191]
    s_waitcnt lgkmcnt(2)
    v_mfma_f32_16x16x32_bf16 v[192:195], v[216:219], v[96:99], v[192:195]
    ds_read_b128 v[208:211], v19 offset:30720
    v_mfma_f32_16x16x32_bf16 v[196:199], v[216:219], v[100:103], v[196:199]
    v_mfma_f32_16x16x32_bf16 v[176:179], v[220:223], v[104:107], v[176:179]
    ds_read_b128 v[212:215], v19 offset:31744
    v_mfma_f32_16x16x32_bf16 v[180:183], v[220:223], v[108:111], v[180:183]
    s_waitcnt lgkmcnt(2)
    v_mfma_f32_16x16x32_bf16 v[184:187], v[200:203], v[104:107], v[184:187]
    ds_read_b128 v[216:219], v19 offset:32768
    v_mfma_f32_16x16x32_bf16 v[188:191], v[200:203], v[108:111], v[188:191]
    s_mov_b64 exec, 0xff
    buffer_load_dwordx2 v[30:31], v5, s[32:35], s89 offen offset:0 sc1
    s_mov_b64 exec, -1
    v_mfma_f32_16x16x32_bf16 v[192:195], v[204:207], v[104:107], v[192:195]
    ds_read_b128 v[220:223], v19 offset:33792
    v_mfma_f32_16x16x32_bf16 v[196:199], v[204:207], v[108:111], v[196:199]
    ds_read_b128 v[224:227], v11 offset:256
    ds_read_b128 v[228:231], v11 offset:320
    s_waitcnt lgkmcnt(4)
    v_mfma_f32_16x16x32_bf16 v[176:179], v[208:211], v[112:115], v[176:179]
    ds_read_b128 v[200:203], v19 offset:34816
    v_mfma_f32_16x16x32_bf16 v[180:183], v[208:211], v[116:119], v[180:183]
    ds_read_b128 v[232:235], v11 offset:384
    v_mfma_f32_16x16x32_bf16 v[184:187], v[212:215], v[112:115], v[184:187]
    ds_read_b128 v[204:207], v19 offset:35840
    v_mfma_f32_16x16x32_bf16 v[188:191], v[212:215], v[116:119], v[188:191]
    s_waitcnt vmcnt(0)
    s_mov_b64 exec, 0xff
    v_cmp_ne_u64 vcc, s[48:49], v[30:31]
    s_mov_b64 exec, -1
    s_or_b64 vcc, vcc, s[54:55]
    s_cbranch_scc1 L_peek_89
L_peekback_90:
    s_waitcnt lgkmcnt(5)
    v_mfma_f32_16x16x32_bf16 v[192:195], v[216:219], v[112:115], v[192:195]
    ds_read_b128 v[208:211], v19 offset:36864
    v_mfma_f32_16x16x32_bf16 v[196:199], v[216:219], v[116:119], v[196:199]
    buffer_load_dwordx4 v[32:35], v1, s[32:35], s76 offen offset:0 sc1
    v_mfma_f32_16x16x32_bf16 v[176:179], v[220:223], v[120:123], v[176:179]
    ds_read_b128 v[212:215], v19 offset:37888
    v_mfma_f32_16x16x32_bf16 v[180:183], v[220:223], v[124:127], v[180:183]
    buffer_load_dwordx4 v[36:39], v1, s[32:35], s77 offen offset:0 sc1
    s_waitcnt lgkmcnt(2)
    v_mfma_f32_16x16x32_bf16 v[184:187], v[200:203], v[120:123], v[184:187]
    ds_read_b128 v[216:219], v19 offset:38912
    v_mfma_f32_16x16x32_bf16 v[188:191], v[200:203], v[124:127], v[188:191]
    buffer_load_dwordx4 v[40:43], v1, s[32:35], s76 offen offset:1024 sc1
    v_mfma_f32_16x16x32_bf16 v[192:195], v[204:207], v[120:123], v[192:195]
    ds_read_b128 v[220:223], v19 offset:39936
    v_mfma_f32_16x16x32_bf16 v[196:199], v[204:207], v[124:127], v[196:199]
    buffer_load_dwordx4 v[44:47], v1, s[32:35], s77 offen offset:1024 sc1
    s_waitcnt lgkmcnt(2)
    v_mfma_f32_16x16x32_bf16 v[176:179], v[208:211], v[128:131], v[176:179]
    ds_read_b128 v[200:203], v19 offset:40960
    v_mfma_f32_16x16x32_bf16 v[180:183], v[208:211], v[132:135], v[180:183]
    buffer_load_dwordx4 v[48:51], v1, s[32:35], s76 offen offset:2048 sc1
    v_mfma_f32_16x16x32_bf16 v[184:187], v[212:215], v[128:131], v[184:187]
    ds_read_b128 v[204:207], v19 offset:41984
    v_mfma_f32_16x16x32_bf16 v[188:191], v[212:215], v[132:135], v[188:191]
    buffer_load_dwordx4 v[52:55], v1, s[32:35], s77 offen offset:2048 sc1
    s_waitcnt lgkmcnt(2)
    v_mfma_f32_16x16x32_bf16 v[192:195], v[216:219], v[128:131], v[192:195]
    v_mfma_f32_16x16x32_bf16 v[196:199], v[216:219], v[132:135], v[196:199]
    buffer_load_dwordx4 v[56:59], v1, s[32:35], s76 offen offset:3072 sc1
    v_mfma_f32_16x16x32_bf16 v[176:179], v[220:223], v[136:139], v[176:179]
    v_mfma_f32_16x16x32_bf16 v[180:183], v[220:223], v[140:143], v[180:183]
    buffer_load_dwordx4 v[60:63], v1, s[32:35], s77 offen offset:3072 sc1
    s_waitcnt lgkmcnt(0)
    v_mfma_f32_16x16x32_bf16 v[184:187], v[200:203], v[136:139], v[184:187]
    v_mfma_f32_16x16x32_bf16 v[188:191], v[200:203], v[140:143], v[188:191]
    buffer_load_dwordx4 v[64:67], v1, s[32:35], s78 offen offset:0 sc1
    v_mfma_f32_16x16x32_bf16 v[192:195], v[204:207], v[136:139], v[192:195]
    v_mfma_f32_16x16x32_bf16 v[196:199], v[204:207], v[140:143], v[196:199]
    buffer_load_dwordx4 v[68:71], v1, s[32:35], s79 offen offset:0 sc1
    v_pk_fma_f32 v[176:177], v[224:225], v[14:15], v[176:177] op_sel:[0,0,0] op_sel_hi:[1,0,1]
    v_pk_fma_f32 v[178:179], v[226:227], v[14:15], v[178:179] op_sel:[0,0,0] op_sel_hi:[1,0,1]
    s_nop 0
    v_pk_fma_f32 v[184:185], v[228:229], v[14:15], v[184:185] op_sel:[0,0,0] op_sel_hi:[1,0,1]
    v_pk_fma_f32 v[186:187], v[230:231], v[14:15], v[186:187] op_sel:[0,0,0] op_sel_hi:[1,0,1]
    v_cvt_pk_bf16_f32 v20, v176, v177
    v_cvt_pk_bf16_f32 v21, v178, v179
    v_cvt_pk_bf16_f32 v22, v184, v185
    v_cvt_pk_bf16_f32 v23, v186, v187
    v_pk_max_i16 v20, v20, 0
    v_pk_max_i16 v21, v21, 0
    v_pk_max_i16 v22, v22, 0
    v_pk_max_i16 v23, v23, 0
    buffer_store_dwordx4 v[20:23], v17, s[32:35], s87 offen offset:0 sc1
    v_pk_fma_f32 v[180:181], v[224:225], v[14:15], v[180:181] op_sel:[0,1,0] op_sel_hi:[1,1,1]
    v_pk_fma_f32 v[182:183], v[226:227], v[14:15], v[182:183] op_sel:[0,1,0] op_sel_hi:[1,1,1]
    v_pk_fma_f32 v[188:189], v[228:229], v[14:15], v[188:189] op_sel:[0,1,0] op_sel_hi:[1,1,1]
    v_pk_fma_f32 v[190:191], v[230:231], v[14:15], v[190:191] op_sel:[0,1,0] op_sel_hi:[1,1,1]
    v_cvt_pk_bf16_f32 v24, v180, v181
    v_cvt_pk_bf16_f32 v25, v182, v183
    v_cvt_pk_bf16_f32 v26, v188, v189
    v_cvt_pk_bf16_f32 v27, v190, v191
    v_pk_max_i16 v24, v24, 0
    v_pk_max_i16 v25, v25, 0
    v_pk_max_i16 v26, v26, 0
    v_pk_max_i16 v27, v27, 0
    buffer_store_dwordx4 v[24:27], v17, s[32:35], s87 offen offset:256 sc1
    v_pk_fma_f32 v[192:193], v[232:233], v[14:15], v[192:193] op_sel:[0,0,0] op_sel_hi:[1,0,1]
    v_pk_fma_f32 v[194:195], v[234:235], v[14:15], v[194:195] op_sel:[0,0,0] op_sel_hi:[1,0,1]
    v_cvt_pk_bf16_f32 v20, v192, v193
    v_cvt_pk_bf16_f32 v21, v194, v195
    v_pk_max_i16 v20, v20, 0
    v_pk_max_i16 v21, v21, 0
    buffer_store_dwordx2 v[20:21], v18, s[32:35], s87 offen offset:2048 sc1
    v_pk_fma_f32 v[196:197], v[232:233], v[14:15], v[196:197] op_sel:[0,1,0] op_sel_hi:[1,1,1]
    v_pk_fma_f32 v[198:199], v[234:235], v[14:15], v[198:199] op_sel:[0,1,0] op_sel_hi:[1,1,1]
    v_cvt_pk_bf16_f32 v24, v196, v197
    v_cvt_pk_bf16_f32 v25, v198, v199
    v_pk_max_i16 v24, v24, 0
    v_pk_max_i16 v25, v25, 0
    buffer_store_dwordx2 v[24:25], v18, s[32:35], s87 offen offset:2304 sc1
    s_branch L_padskip18
L_pad18:
    s_setpc_b64 s[98:99]
L_padskip18:
    s_cmp_ge_u32 s41, 28
    s_cbranch_scc1 L_p5skip_94
    s_barrier
    s_waitcnt vmcnt(13)
    v_mfma_f32_32x32x16_bf16 v[160:175], a[0:3], v[32:35], 0
    buffer_load_dwordx4 v[72:75], v1, s[32:35], s78 offen offset:1024 sc1
    v_mfma_f32_32x32x16_bf16 v[176:191], a[4:7], v[32:35], 0
    buffer_load_dwordx4 v[76:79], v1, s[32:35], s79 offen offset:1024 sc1
    s_waitcnt vmcnt(14)
    v_mfma_f32_32x32x16_bf16 v[192:207], a[0:3], v[36:39], 0
    v_mfma_f32_32x32x16_bf16 v[208:223], a[4:7], v[36:39], 0
    s_waitcnt vmcnt(13)
    v_mfma_f32_32x32x16_bf16 v[160:175], a[8:11], v[40:43], v[160:175]
    buffer_load_dwordx4 v[80:83], v1, s[32:35], s78 offen offset:2048 sc1
    v_mfma_f32_32x32x16_bf16 v[176:191], a[12:15], v[40:43], v[176:191]
    buffer_load_dwordx4 v[84:87], v1, s[32:35], s79 offen offset:2048 sc1
    s_waitcnt vmcnt(14)
    v_mfma_f32_32x32x16_bf16 v[192:207], a[8:11], v[44:47], v[192:207]
    v_mfma_f32_32x32x16_bf16 v[208:223], a[12:15], v[44:47], v[208:223]
    s_waitcnt vmcnt(13)
    v_mfma_f32_32x32x16_bf16 v[160:175], a[16:19], v[48:51], v[160:175]
    buffer_load_dwordx4 v[88:91], v1, s[32:35], s78 offen offset:3072 sc1
    v_mfma_f32_32x32x16_bf16 v[176:191], a[20:23], v[48:51], v[176:191]
    buffer_load_dwordx4 v[92:95], v1, s[32:35], s79 offen offset:3072 sc1
    s_waitcnt vmcnt(14)
    v_mfma_f32_32x32x16_bf16 v[192:207], a[16:19], v[52:55], v[192:207]
    v_mfma_f32_32x32x16_bf16 v[208:223], a[20:23], v[52:55], v[208:223]
    s_waitcnt vmcnt(13)
    v_mfma_f32_32x32x16_bf16 v[160:175], a[24:27], v[56:59], v[160:175]
    buffer_load_dwordx4 v[96:99], v1, s[32:35], s92 offen offset:0 sc1
    v_mfma_f32_32x32x16_bf16 v[176:191], a[28:31], v[56:59], v[176:191]
    buffer_load_dwordx4 v[100:103], v1, s[32:35], s93 offen offset:0 sc1
    s_waitcnt vmcnt(14)
    v_mfma_f32_32x32x16_bf16 v[192:207], a[24:27], v[60:63], v[192:207]
    v_mfma_f32_32x32x16_bf16 v[208:223], a[28:31], v[60:63], v[208:223]
    s_waitcnt vmcnt(8)
    s_mov_b64 exec, 1
    s_cmp_lg_u32 s50, 0
    s_cbranch_scc0 L_pubslow_98
    buffer_store_dwordx2 v[12:13], off, s[32:35], s88 offset:1024
L_pubback_99:
    s_mov_b64 exec, -1
    v_mfma_f32_32x32x16_bf16 v[160:175], a[56:59], v[64:67], v[160:175]
    buffer_load_dwordx4 v[104:107], v1, s[32:35], s92 offen offset:1024 sc1
    v_mfma_f32_32x32x16_bf16 v[176:191], a[60:63], v[64:67], v[176:191]
    buffer_load_dwordx4 v[108:111], v1, s[32:35], s93 offen offset:1024 sc1
    v_mfma_f32_32x32x16_bf16 v[192:207], a[56:59], v[68:71], v[192:207]
    v_mfma_f32_32x32x16_bf16 v[208:223], a[60:63], v[68:71], v[208:223]
    s_waitcnt vmcnt(10)
    v_mfma_f32_32x32x16_bf16 v[160:175], a[64:67], v[72:75], v[160:175]
    buffer_load_dwordx4 v[112:115], v1, s[32:35], s92 offen offset:2048 sc1
    v_mfma_f32_32x32x16_bf16 v[176:191], a[68:71], v[72:75], v[176:191]
    buffer_load_dwordx4 v[116:119], v1, s[32:35], s93 offen offset:2048 sc1
    s_waitcnt vmcnt(11)
    v_mfma_f32_32x32x16_bf16 v[192:207], a[64:67], v[76:79], v[192:207]
    v_mfma_f32_32x32x16_bf16 v[208:223], a[68:71], v[76:79], v[208:223]
    s_waitcnt vmcnt(10)
    v_mfma_f32_32x32x16_bf16 v[160:175], a[72:75], v[80:83], v[160:175]
    buffer_load_dwordx4 v[120:123], v1, s[32:35], s92 offen offset:3072 sc1
    v_mfma_f32_32x32x16_bf16 v[176:191], a[76:79], v[80:83], v[176:191]
    buffer_load_dwordx4 v[124:127], v1, s[32:35], s93 offen offset:3072 sc1
    s_waitcnt vmcnt(11)
    v_mfma_f32_32x32x16_bf16 v[192:207], a[72:75], v[84:87], v[192:207]
    v_mfma_f32_32x32x16_bf16 v[208:223], a[76:79], v[84:87], v[208:223]
    s_waitcnt vmcnt(10)
    v_mfma_f32_32x32x16_bf16 v[160:175], a[80:83], v[88:91], v[160:175]
    buffer_load_dwordx4 v[128:131], v1, s[32:35], s94 offen offset:0 sc1
    v_mfma_f32_32x32x16_bf16 v[176:191], a[84:87], v[88:91], v[176:191]
    buffer_load_dwordx4 v[132:135], v1, s[32:35], s95 offen offset:0 sc1
    s_waitcnt vmcnt(11)
    v_mfma_f32_32x32x16_bf16 v[192:207], a[80:83], v[92:95], v[192:207]
    v_mfma_f32_32x32x16_bf16 v[208:223], a[84:87], v[92:95], v[208:223]
    s_waitcnt vmcnt(10)
    v_mfma_f32_32x32x16_bf16 v[160:175], a[112:115], v[96:99], v[160:175]
    buffer_load_dwordx4 v[136:139], v1, s[32:35], s94 offen offset:1024 sc1
    v_mfma_f32_32x32x16_bf16 v[176:191], a[116:119], v[96:99], v[176:191]
    buffer_load_dwordx4 v[140:143], v1, s[32:35], s95 offen offset:1024 sc1
    s_waitcnt vmcnt(11)
    v_mfma_f32_32x32x16_bf16 v[192:207], a[112:115], v[100:103], v[192:207]
    v_mfma_f32_32x32x16_bf16 v[208:223], a[116:119], v[100:103], v[208:223]
    s_mov_b64 exec, 0xff
    buffer_load_dwordx2 v[30:31], v5, s[32:35], s89 offen offset:1024 sc1
    s_mov_b64 exec, -1
    s_waitcnt vmcnt(10)
    v_mfma_f32_32x32x16_bf16 v[160:175], a[120:123], v[104:107], v[160:175]
    buffer_load_dwordx4 v[144:147], v1, s[32:35], s94 offen offset:2048 sc1
    v_mfma_f32_32x32x16_bf16 v[176:191], a[124:127], v[104:107], v[176:191]
    buffer_load_dwordx4 v[148:151], v1, s[32:35], s95 offen offset:2048 sc1
    s_waitcnt vmcnt(11)
    v_mfma_f32_32x32x16_bf16 v[192:207], a[120:123], v[108:111], v[192:207]
    v_mfma_f32_32x32x16_bf16 v[208:223], a[124:127], v[108:111], v[208:223]
    s_waitcnt vmcnt(10)
    v_mfma_f32_32x32x16_bf16 v[160:175], a[128:131], v[112:115], v[160:175]
    buffer_load_dwordx4 v[152:155], v1, s[32:35], s94 offen offset:3072 sc1
    v_mfma_f32_32x32x16_bf16 v[176:191], a[132:135], v[112:115], v[176:191]
    buffer_load_dwordx4 v[156:159], v1, s[32:35], s95 offen offset:3072 sc1
    s_waitcnt vmcnt(11)
    v_mfma_f32_32x32x16_bf16 v[192:207], a[128:131], v[116:119], v[192:207]
    v_mfma_f32_32x32x16_bf16 v[208:223], a[132:135], v[116:119], v[208:223]
    s_waitcnt vmcnt(10)
    v_mfma_f32_32x32x16_bf16 v[160:175], a[136:139], v[120:123], v[160:175]
    s_waitcnt vmcnt(4)
    s_mov_b64 exec, 0xff
    v_cmp_ne_u64 vcc, s[48:49], v[30:31]
    s_mov_b64 exec, -1
    s_or_b64 vcc, vcc, s[54:55]
    s_cbranch_scc1 L_peek_100
L_peekback_101:
    buffer_load_dwordx4 v[32:35], v28, s[32:35], s76 offen offset:0 sc1
    v_mfma_f32_32x32x16_bf16 v[176:191], a[140:143], v[120:123], v[176:191]
    buffer_load_dwordx4 v[36:39], v28, s[32:35], s77 offen offset:0 sc1
    v_mfma_f32_32x32x16_bf16 v[192:207], a[136:139], v[124:127], v[192:207]
    v_mfma_f32_32x32x16_bf16 v[208:223], a[140:143], v[124:127], v[208:223]
    v_mfma_f32_32x32x16_bf16 v[160:175], a[168:171], v[128:131], v[160:175]
    buffer_load_dwordx4 v[40:43], v28, s[32:35], s76 offen offset:1024 sc1
    v_mfma_f32_32x32x16_bf16 v[176:191], a[172:175], v[128:131], v[176:191]
    buffer_load_dwordx4 v[44:47], v28, s[32:35], s77 offen offset:1024 sc1
    v_mfma_f32_32x32x16_bf16 v[192:207], a[168:171], v[132:135], v[192:207]
    v_mfma_f32_32x32x16_bf16 v[208:223], a[172:175], v[132:135], v[208:223]
    v_mfma_f32_32x32x16_bf16 v[160:175], a[176:179], v[136:139], v[160:175]
    buffer_load_dwordx4 v[48:51], v28, s[32:35], s76 offen offset:2048 sc1
    v_mfma_f32_32x32x16_bf16 v[176:191], a[180:183], v[136:139], v[176:191]
    buffer_load_dwordx4 v[52:55], v28, s[32:35], s77 offen offset:2048 sc1
    v_mfma_f32_32x32x16_bf16 v[192:207], a[176:179], v[140:143], v[192:207]
    v_mfma_f32_32x32x16_bf16 v[208:223], a[180:183], v[140:143], v[208:223]
    s_waitcnt vmcnt(9)
    v_mfma_f32_32x32x16_bf16 v[176:191], a[188:191], v[144:147], v[176:191]
    buffer_load_dwordx4 v[56:59], v28, s[32:35], s78 offen offset:0 sc1
    s_waitcnt vmcnt(9)
    v_mfma_f32_32x32x16_bf16 v[192:207], a[184:187], v[148:151], v[192:207]
    buffer_load_dwordx4 v[60:63], v28, s[32:35], s79 offen offset:0 sc1
    v_mfma_f32_32x32x16_bf16 v[208:223], a[188:191], v[148:151], v[208:223]
    s_waitcnt vmcnt(9)
    v_mfma_f32_32x32x16_bf16 v[176:191], a[196:199], v[152:155], v[176:191]
    buffer_load_dwordx4 v[64:67], v28, s[32:35], s78 offen offset:1024 sc1
    s_waitcnt vmcnt(9)
    v_mfma_f32_32x32x16_bf16 v[192:207], a[192:195], v[156:159], v[192:207]
    buffer_load_dwordx4 v[68:71], v28, s[32:35], s79 offen offset:1024 sc1
    v_mfma_f32_32x32x16_bf16 v[208:223], a[196:199], v[156:159], v[208:223]
    s_waitcnt vmcnt(9)
    v_mfma_f32_32x32x16_bf16 v[176:191], a[36:39], v[32:35], v[176:191]
    buffer_load_dwordx4 v[72:75], v28, s[32:35], s78 offen offset:2048 sc1
    s_waitcnt vmcnt(9)
    v_mfma_f32_32x32x16_bf16 v[192:207], a[32:35], v[36:39], v[192:207]
    buffer_load_dwordx4 v[76:79], v28, s[32:35], s79 offen offset:2048 sc1
    v_mfma_f32_32x32x16_bf16 v[208:223], a[36:39], v[36:39], v[208:223]
    s_waitcnt vmcnt(9)
    v_mfma_f32_32x32x16_bf16 v[176:191], a[44:47], v[40:43], v[176:191]
    buffer_load_dwordx4 v[80:83], v28, s[32:35], s92 offen offset:0 sc1
    s_waitcnt vmcnt(9)
    v_mfma_f32_32x32x16_bf16 v[192:207], a[40:43], v[44:47], v[192:207]
    buffer_load_dwordx4 v[84:87], v28, s[32:35], s93 offen offset:0 sc1
    v_mfma_f32_32x32x16_bf16 v[208:223], a[44:47], v[44:47], v[208:223]
    s_waitcnt vmcnt(9)
    v_mfma_f32_32x32x16_bf16 v[176:191], a[52:55], v[48:51], v[176:191]
    buffer_load_dwordx4 v[88:91], v28, s[32:35], s92 offen offset:1024 sc1
    s_waitcnt vmcnt(9)
    v_mfma_f32_32x32x16_bf16 v[192:207], a[48:51], v[52:55], v[192:207]
    buffer_load_dwordx4 v[92:95], v28, s[32:35], s93 offen offset:1024 sc1
    v_mfma_f32_32x32x16_bf16 v[208:223], a[52:55], v[52:55], v[208:223]
    s_waitcnt vmcnt(9)
    v_mfma_f32_32x32x16_bf16 v[176:191], a[92:95], v[56:59], v[176:191]
    buffer_load_dwordx4 v[96:99], v28, s[32:35], s92 offen offset:2048 sc1
    s_waitcnt vmcnt(9)
    v_mfma_f32_32x32x16_bf16 v[192:207], a[88:91], v[60:63], v[192:207]
    buffer_load_dwordx4 v[100:103], v28, s[32:35], s93 offen offset:2048 sc1
    v_mfma_f32_32x32x16_bf16 v[208:223], a[92:95], v[60:63], v[208:223]
    s_waitcnt vmcnt(9)
    v_mfma_f32_32x32x16_bf16 v[176:191], a[100:103], v[64:67], v[176:191]
    buffer_load_dwordx4 v[104:107], v28, s[32:35], s94 offen offset:0 sc1
    s_waitcnt vmcnt(9)
    v_mfma_f32_32x32x16_bf16 v[192:207], a[96:99], v[68:71], v[192:207]
    buffer_load_dwordx4 v[108:111], v28, s[32:35], s95 offen offset:0 sc1
    v_mfma_f32_32x32x16_bf16 v[208:223], a[100:103], v[68:71], v[208:223]
    s_waitcnt vmcnt(9)
    v_mfma_f32_32x32x16_bf16 v[176:191], a[108:111], v[72:75], v[176:191]
    buffer_load_dwordx4 v[112:115], v28, s[32:35], s94 offen offset:1024 sc1
    s_waitcnt vmcnt(9)
    v_mfma_f32_32x32x16_bf16 v[192:207], a[104:107], v[76:79], v[192:207]
    buffer_load_dwordx4 v[116:119], v28, s[32:35], s95 offen offset:1024 sc1
    v_mfma_f32_32x32x16_bf16 v[208:223], a[108:111], v[76:79], v[208:223]
    s_waitcnt vmcnt(9)
    v_mfma_f32_32x32x16_bf16 v[176:191], a[148:151], v[80:83], v[176:191]
    buffer_load_dwordx4 v[120:123], v28, s[32:35], s94 offen offset:2048 sc1
    s_waitcnt vmcnt(9)
    v_mfma_f32_32x32x16_bf16 v[192:207], a[144:147], v[84:87], v[192:207]
    buffer_load_dwordx4 v[124:127], v28, s[32:35], s95 offen offset:2048 sc1
    v_mfma_f32_32x32x16_bf16 v[208:223], a[148:151], v[84:87], v[208:223]
    s_waitcnt vmcnt(9)
    v_mfma_f32_32x32x16_bf16 v[176:191], a[156:159], v[88:91], v[176:191]
    buffer_load_dwordx2 v[224:225], v4, s[32:35], s90 offen offset:0 sc1
    s_waitcnt vmcnt(9)
    v_mfma_f32_32x32x16_bf16 v[192:207], a[152:155], v[92:95], v[192:207]
    buffer_load_dwordx2 v[226:227], v4, s[32:35], s90 offen offset:256 sc1
    v_mfma_f32_32x32x16_bf16 v[208:223], a[156:159], v[92:95], v[208:223]
    buffer_load_dwordx2 v[228:229], v4, s[32:35], s90 offen offset:512 sc1
    s_waitcnt vmcnt(10)
    v_mfma_f32_32x32x16_bf16 v[176:191], a[164:167], v[96:99], v[176:191]
    buffer_load_dwordx2 v[230:231], v4, s[32:35], s90 offen offset:768 sc1
    s_waitcnt vmcnt(10)
    v_mfma_f32_32x32x16_bf16 v[192:207], a[160:163], v[100:103], v[192:207]
    buffer_load_dwordx2 v[232:233], v4, s[32:35], s90 offen offset:1024 sc1
    v_mfma_f32_32x32x16_bf16 v[208:223], a[164:167], v[100:103], v[208:223]
    buffer_load_dwordx2 v[234:235], v4, s[32:35], s90 offen offset:1280 sc1
    s_waitcnt vmcnt(11)
    v_mfma_f32_32x32x16_bf16 v[176:191], a[204:207], v[104:107], v[176:191]
    buffer_load_dwordx2 v[236:237], v4, s[32:35], s90 offen offset:1536 sc1
    s_waitcnt vmcnt(11)
    v_mfma_f32_32x32x16_bf16 v[192:207], a[200:203], v[108:111], v[192:207]
    v_mfma_f32_32x32x16_bf16 v[208:223], a[204:207], v[108:111], v[208:223]
    s_waitcnt vmcnt(10)
    v_mfma_f32_32x32x16_bf16 v[176:191], a[212:215], v[112:115], v[176:191]
    s_waitcnt vmcnt(9)
    v_mfma_f32_32x32x16_bf16 v[192:207], a[208:211], v[116:119], v[192:207]
    v_mfma_f32_32x32x16_bf16 v[208:223], a[212:215], v[116:119], v[208:223]
    s_waitcnt vmcnt(8)
    v_mfma_f32_32x32x16_bf16 v[176:191], a[220:223], v[120:123], v[176:191]
    s_waitcnt vmcnt(7)
    v_mfma_f32_32x32x16_bf16 v[192:207], a[216:219], v[124:127], v[192:207]
    v_mfma_f32_32x32x16_bf16 v[208:223], a[220:223], v[124:127], v[208:223]
    v_mfma_f32_32x32x16_bf16 v[160:175], a[184:187], v[144:147], v[160:175]
    s_waitcnt vmcnt(5)
    v_add_f32 v224, v224, v226
    v_add_f32 v225, v225, v227
    s_waitcnt vmcnt(4)
    v_add_f32 v224, v224, v228
    v_add_f32 v225, v225, v229
    s_waitcnt vmcnt(3)
    v_add_f32 v224, v224, v230
    v_mfma_f32_32x32x16_bf16 v[160:175], a[192:195], v[152:155], v[160:175]
    v_add_f32 v225, v225, v231
    s_waitcnt vmcnt(2)
    v_add_f32 v224, v224, v232
    v_add_f32 v225, v225, v233
    s_waitcnt vmcnt(1)
    v_add_f32 v224, v224, v234
    v_add_f32 v225, v225, v235
    v_mfma_f32_32x32x16_bf16 v[160:175], a[32:35], v[32:35], v[160:175]
    ds_write_b128 v6, v[176:179] offset:0
    s_waitcnt vmcnt(0)
    v_add_f32 v224, v224, v236
    v_add_f32 v225, v225, v237
    v_mov_b32 v226, v224
    v_mov_b32 v227, v225
    v_mfma_f32_32x32x16_bf16 v[160:175], a[40:43], v[40:43], v[160:175]
    ds_write_b128 v6, v[180:183] offset:1024
    s_nop 0
    v_permlane32_swap_b32 v224, v226
    v_mfma_f32_32x32x16_bf16 v[160:175], a[48:51], v[48:51], v[160:175]
    ds_write_b128 v6, v[184:187] offset:2048
    v_permlane32_swap_b32 v225, v227
    v_add_f32 v224, v224, v226
    v_add_f32 v225, v225, v227
    v_mfma_f32_32x32x16_bf16 v[160:175], a[88:91], v[56:59], v[160:175]
    ds_write_b128 v6, v[188:191] offset:3072
    v_mul_f32 v14, 0xbb124925, v224
    v_mul_f32 v225, 0x3b124925, v225
    v_fma_f32 v225, -v14, v14, v225
    v_max_f32 v225, 0, v225
    v_mfma_f32_32x32x16_bf16 v[160:175], a[96:99], v[64:67], v[160:175]
    ds_write_b128 v7, v[192:195] offset:0
    v_add_f32 v225, 0x3727c5ac, v225
    v_rsq_f32 v15, v225
    v_mfma_f32_32x32x16_bf16 v[160:175], a[104:107], v[72:75], v[160:175]
    ds_write_b128 v7, v[196:199] offset:1024
    v_mfma_f32_32x32x16_bf16 v[160:175], a[144:147], v[80:83], v[160:175]
    ds_write_b128 v7, v[200:203] offset:2048
    v_mfma_f32_32x32x16_bf16 v[160:175], a[152:155], v[88:91], v[160:175]
    ds_write_b128 v7, v[204:207] offset:3072
    v_mfma_f32_32x32x16_bf16 v[160:175], a[160:163], v[96:99], v[160:175]
    ds_write_b128 v8, v[208:211] offset:0
    v_mfma_f32_32x32x16_bf16 v[160:175], a[200:203], v[104:107], v[160:175]
    ds_write_b128 v8, v[212:215] offset:1024
    v_mfma_f32_32x32x16_bf16 v[160:175], a[208:211], v[112:115], v[160:175]
    ds_write_b128 v8, v[216:219] offset:2048
    v_mfma_f32_32x32x16_bf16 v[160:175], a[216:219], v[120:123], v[160:175]
    ds_write_b128 v8, v[220:223] offset:3072
    s_waitcnt lgkmcnt(0)
    s_branch L_padskip19
L_pad19:
    s_setpc_b64 s[98:99]
L_padskip19:
    s_barrier
    ds_read_b128 v[32:35], v9 offset:0
    ds_read_b128 v[48:51], v9 offset:4096
    ds_read_b128 v[64:67], v9 offset:8192
    ds_read_b128 v[36:39], v9 offset:1024
    ds_read_b128 v[52:55], v9 offset:5120
    ds_read_b128 v[68:71], v9 offset:9216
    ds_read_b128 v[40:43], v9 offset:2048
    ds_read_b128 v[56:59], v9 offset:6144
    ds_read_b128 v[72:75], v9 offset:10240
    ds_read_b128 v[44:47], v9 offset:3072
    ds_read_b128 v[60:63], v9 offset:7168
    ds_read_b128 v[76:79], v9 offset:11264
    s_waitcnt lgkmcnt(10)
    v_pk_add_f32 v[32:33], v[32:33], v[48:49]
    s_waitcnt lgkmcnt(9)
    v_pk_add_f32 v[160:161], v[160:161], v[64:65]
    v_pk_add_f32 v[160:161], v[160:161], v[32:33]
    v_pk_add_f32 v[34:35], v[34:35], v[50:51]
    v_pk_add_f32 v[162:163], v[162:163], v[66:67]
    v_pk_add_f32 v[162:163], v[162:163], v[34:35]
    s_waitcnt lgkmcnt(7)
    v_pk_add_f32 v[36:37], v[36:37], v[52:53]
    s_waitcnt lgkmcnt(6)
    v_pk_add_f32 v[164:165], v[164:165], v[68:69]
    v_pk_add_f32 v[164:165], v[164:165], v[36:37]
    v_pk_add_f32 v[38:39], v[38:39], v[54:55]
    v_pk_add_f32 v[166:167], v[166:167], v[70:71]
    v_pk_add_f32 v[166:167], v[166:167], v[38:39]
    s_waitcnt lgkmcnt(4)
    v_pk_add_f32 v[40:41], v[40:41], v[56:57]
    s_waitcnt lgkmcnt(3)
    v_pk_add_f32 v[168:169], v[168:169], v[72:73]
    v_pk_add_f32 v[168:169], v[168:169], v[40:41]
    v_pk_add_f32 v[42:43], v[42:43], v[58:59]
    v_pk_add_f32 v[170:171], v[170:171], v[74:75]
    v_pk_add_f32 v[170:171], v[170:171], v[42:43]
    s_waitcnt lgkmcnt(1)
    v_pk_add_f32 v[44:45], v[44:45], v[60:61]
    s_waitcnt lgkmcnt(0)
    v_pk_add_f32 v[172:173], v[172:173], v[76:77]
    v_pk_add_f32 v[172:173], v[172:173], v[44:45]
    v_pk_add_f32 v[46:47], v[46:47], v[62:63]
    v_pk_add_f32 v[174:175], v[174:175], v[78:79]
    v_pk_add_f32 v[174:175], v[174:175], v[46:47]
    v_pk_fma_f32 v[160:161], v[160:161], v[14:15], v[240:241] op_sel:[0,1,0] op_sel_hi:[1,1,1]
    v_cvt_pk_bf16_f32 v96, v160, v161
    v_pk_fma_f32 v[162:163], v[162:163], v[14:15], v[242:243] op_sel:[0,1,0] op_sel_hi:[1,1,1]
    v_cvt_pk_bf16_f32 v97, v162, v163
    v_pk_fma_f32 v[164:165], v[164:165], v[14:15], v[244:245] op_sel:[0,1,0] op_sel_hi:[1,1,1]
    v_cvt_pk_bf16_f32 v98, v164, v165
    v_pk_fma_f32 v[166:167], v[166:167], v[14:15], v[246:247] op_sel:[0,1,0] op_sel_hi:[1,1,1]
    v_cvt_pk_bf16_f32 v99, v166, v167
    v_pk_fma_f32 v[168:169], v[168:169], v[14:15], v[248:249] op_sel:[0,1,0] op_sel_hi:[1,1,1]
    v_cvt_pk_bf16_f32 v100, v168, v169
    v_pk_fma_f32 v[170:171], v[170:171], v[14:15], v[250:251] op_sel:[0,1,0] op_sel_hi:[1,1,1]
    v_cvt_pk_bf16_f32 v101, v170, v171
    v_pk_fma_f32 v[172:173], v[172:173], v[14:15], v[252:253] op_sel:[0,1,0] op_sel_hi:[1,1,1]
    v_cvt_pk_bf16_f32 v102, v172, v173
    v_pk_fma_f32 v[174:175], v[174:175], v[14:15], v[254:255] op_sel:[0,1,0] op_sel_hi:[1,1,1]
    v_cvt_pk_bf16_f32 v103, v174, v175
    v_and_b32 v20, 31, v0
    v_mul_u32_u24 v20, 896, v20
    v_lshrrev_b32 v21, 5, v0
    v_lshl_add_u32 v20, v21, 4, v20
    v_permlane32_swap_b32 v96, v98
    v_permlane32_swap_b32 v97, v99
    buffer_store_dwordx4 v[96:99], v20, s[28:31], s53 offen offset:0
    v_permlane32_swap_b32 v100, v102
    v_permlane32_swap_b32 v101, v103
    buffer_store_dwordx4 v[100:103], v20, s[28:31], s53 offen offset:32
    s_cmp_lg_u32 s2, 221
    s_cbranch_scc1 L_fin
    s_mov_b32 s60, 0
    s_mov_b64 exec, 1
    buffer_store_dwordx2 v[12:13], off, s[32:35], s60 sc1
    s_mov_b64 exec, -1
L_fin:
L_end:
    s_endpgm
L_peek_18:
    s_mov_b32 exec_hi, 0x3f
    s_mov_b32 s66, 0
L_poll_21:
    buffer_load_dwordx2 v[30:31], v236, s[32:35], 0 offen offset:0 sc1
    s_add_u32 s66, s66, 1
    s_cmp_gt_u32 s66, 65536
    s_cbranch_scc1 L_pollout_22
    s_waitcnt vmcnt(0)
    v_cmp_ne_u64 vcc, s[48:49], v[30:31]
    s_nop 0
    s_cbranch_vccnz L_poll_21
L_pollout_22:
    s_mov_b64 exec, -1
    s_cmp_lg_u32 s50, 0
    s_cbranch_scc1 L_peekback_19
    buffer_inv sc1
    s_waitcnt vmcnt(0)
    s_branch L_peekback_19
L_null_25:
    v_add_u32 v17, s93, v1
    v_mov_b32 v20, 0
    v_mov_b32 v21, 0
    v_mov_b32 v22, 0
    v_mov_b32 v23, 0
    ds_write_b128 v17, v[20:23] offset:0
    ds_write_b128 v17, v[20:23] offset:2048
    ds_write_b128 v17, v[20:23] offset:3072
    s_mov_b32 exec_lo, 0
    v_mov_b32 v23, 0xf1490000
    s_mov_b64 exec, -1
    ds_write_b128 v17, v[20:23] offset:1024
    s_branch L_nullback_26
L_null_27:
    v_add_u32 v17, s94, v1
    v_mov_b32 v20, 0
    v_mov_b32 v21, 0
    v_mov_b32 v22, 0
    v_mov_b32 v23, 0
    ds_write_b128 v17, v[20:23] offset:0
    ds_write_b128 v17, v[20:23] offset:2048
    ds_write_b128 v17, v[20:23] offset:3072
    s_mov_b32 exec_lo, 0
    v_mov_b32 v23, 0xf1490000
    s_mov_b64 exec, -1
    ds_write_b128 v17, v[20:23] offset:1024
    s_branch L_nullback_28
L_pubslow_29:
    buffer_wbl2 sc1
    s_waitcnt vmcnt(0)
    buffer_store_dwordx2 v[12:13], off, s[32:35], s81 offset:0 sc1
    s_branch L_pubback_30
L_acq_35:
    buffer_inv sc1
    s_waitcnt vmcnt(0)
    s_branch L_acqback_36
L_pubslow_37:
    buffer_wbl2 sc1
    s_waitcnt vmcnt(0)
    buffer_store_dwordx2 v[12:13], off, s[32:35], s70 offset:0 sc1
    s_branch L_pubback_38
L_p3idle_32:
    v_lshlrev_b32 v16, 7, v0
    s_lshl_b32 s60, s46, 2
    s_add_u32 s60, s60, s44
    s_mul_i32 s61, s60, 100352
    s_branch L_p3join_31
L_acq_41:
    buffer_inv sc1
    s_waitcnt vmcnt(0)
    s_branch L_acqback_42
L_pubslow_43:
    buffer_wbl2 sc1
    s_waitcnt vmcnt(0)
    buffer_store_dwordx2 v[12:13], off, s[32:35], s88 offset:0 sc1
    s_branch L_pubback_44
L_peek_45:
    s_mov_b64 exec, 0xff
    s_mov_b32 s66, 0
L_poll_48:
    buffer_load_dwordx2 v[30:31], v5, s[32:35], s89 offen offset:0 sc1
    s_add_u32 s66, s66, 1
    s_cmp_gt_u32 s66, 65536
    s_cbranch_scc1 L_pollout_49
    s_waitcnt vmcnt(0)
    v_cmp_ne_u64 vcc, s[48:49], v[30:31]
    s_nop 0
    s_cbranch_vccnz L_poll_48
L_pollout_49:
    s_mov_b64 exec, -1
    s_cmp_lg_u32 s50, 0
    s_cbranch_scc1 L_peekback_46
    buffer_inv sc1
    s_waitcnt vmcnt(0)
    s_branch L_peekback_46
L_pubslow_52:
    buffer_wbl2 sc1
    s_waitcnt vmcnt(0)
    buffer_store_dwordx2 v[12:13], off, s[32:35], s88 offset:1024 sc1
    s_branch L_pubback_53
L_p5skip_50:
    s_waitcnt vmcnt(0)
    s_mov_b64 exec, 1
    s_cmp_lg_u32 s50, 0
    s_cbranch_scc0 L_pubslow_52
    buffer_store_dwordx2 v[12:13], off, s[32:35], s88 offset:1024
L_pubback_53:
    s_mov_b64 exec, -1
    s_lshl_b32 s60, s46, 2
    s_add_u32 s60, s60, s44
    s_mul_i32 s61, s60, 28672
    s_mul_i32 s61, s60, 100352
    s_branch L_p5join_51
L_pubslow_54:
    buffer_wbl2 sc1
    s_waitcnt vmcnt(0)
    buffer_store_dwordx2 v[12:13], off, s[32:35], s88 offset:1024 sc1
    s_branch L_pubback_55
L_peek_56:
    s_mov_b64 exec, 0xff
    s_mov_b32 s66, 0
L_poll_59:
    buffer_load_dwordx2 v[30:31], v5, s[32:35], s89 offen offset:1024 sc1
    s_add_u32 s66, s66, 1
    s_cmp_gt_u32 s66, 65536
    s_cbranch_scc1 L_pollout_60
    s_waitcnt vmcnt(0)
    v_cmp_ne_u64 vcc, s[48:49], v[30:31]
    s_nop 0
    s_cbranch_vccnz L_poll_59
L_pollout_60:
    s_mov_b64 exec, -1
    s_cmp_lg_u32 s50, 0
    s_cbranch_scc1 L_peekback_57
    buffer_inv sc1
    s_waitcnt vmcnt(0)
    s_branch L_peekback_57
L_pubslow_61:
    buffer_wbl2 sc1
    s_waitcnt vmcnt(0)
    buffer_store_dwordx2 v[12:13], off, s[32:35], s70 offset:0 sc1
    s_branch L_pubback_62
L_acq_65:
    buffer_inv sc1
    s_waitcnt vmcnt(0)
    s_branch L_acqback_66
L_null_69:
    v_add_u32 v17, s93, v1
    v_mov_b32 v20, 0
    v_mov_b32 v21, 0
    v_mov_b32 v22, 0
    v_mov_b32 v23, 0
    ds_write_b128 v17, v[20:23] offset:0
    ds_write_b128 v17, v[20:23] offset:2048
    ds_write_b128 v17, v[20:23] offset:3072
    s_mov_b32 exec_lo, 0
    v_mov_b32 v23, 0xf1490000
    s_mov_b64 exec, -1
    ds_write_b128 v17, v[20:23] offset:1024
    s_branch L_nullback_70
L_null_71:
    v_add_u32 v17, s94, v1
    v_mov_b32 v20, 0
    v_mov_b32 v21, 0
    v_mov_b32 v22, 0
    v_mov_b32 v23, 0
    ds_write_b128 v17, v[20:23] offset:0
    ds_write_b128 v17, v[20:23] offset:2048
    ds_write_b128 v17, v[20:23] offset:3072
    s_mov_b32 exec_lo, 0
    v_mov_b32 v23, 0xf1490000
    s_mov_b64 exec, -1
    ds_write_b128 v17, v[20:23] offset:1024
    s_branch L_nullback_72
L_pubslow_73:
    buffer_wbl2 sc1
    s_waitcnt vmcnt(0)
    buffer_store_dwordx2 v[12:13], off, s[32:35], s81 offset:0 sc1
    s_branch L_pubback_74
L_acq_79:
    buffer_inv sc1
    s_waitcnt vmcnt(0)
    s_branch L_acqback_80
L_pubslow_81:
    buffer_wbl2 sc1
    s_waitcnt vmcnt(0)
    buffer_store_dwordx2 v[12:13], off, s[32:35], s70 offset:0 sc1
    s_branch L_pubback_82
L_p3idle_76:
    v_lshlrev_b32 v16, 7, v0
    s_lshl_b32 s60, s46, 2
    s_add_u32 s60, s60, s44
    s_mul_i32 s61, s60, 100352
    s_branch L_p3join_75
L_acq_85:
    buffer_inv sc1
    s_waitcnt vmcnt(0)
    s_branch L_acqback_86
L_pubslow_87:
    buffer_wbl2 sc1
    s_waitcnt vmcnt(0)
    buffer_store_dwordx2 v[12:13], off, s[32:35], s88 offset:0 sc1
    s_branch L_pubback_88
L_peek_89:
    s_mov_b64 exec, 0xff
    s_mov_b32 s66, 0
L_poll_92:
    buffer_load_dwordx2 v[30:31], v5, s[32:35], s89 offen offset:0 sc1
    s_add_u32 s66, s66, 1
    s_cmp_gt_u32 s66, 65536
    s_cbranch_scc1 L_pollout_93
    s_waitcnt vmcnt(0)
    v_cmp_ne_u64 vcc, s[48:49], v[30:31]
    s_nop 0
    s_cbranch_vccnz L_poll_92
L_pollout_93:
    s_mov_b64 exec, -1
    s_cmp_lg_u32 s50, 0
    s_cbranch_scc1 L_peekback_90
    buffer_inv sc1
    s_waitcnt vmcnt(0)
    s_branch L_peekback_90
L_pubslow_96:
    buffer_wbl2 sc1
    s_waitcnt vmcnt(0)
    buffer_store_dwordx2 v[12:13], off, s[32:35], s88 offset:1024 sc1
    s_branch L_pubback_97
L_p5skip_94:
    s_waitcnt vmcnt(0)
    s_mov_b64 exec, 1
    s_cmp_lg_u32 s50, 0
    s_cbranch_scc0 L_pubslow_96
    buffer_store_dwordx2 v[12:13], off, s[32:35], s88 offset:1024
L_pubback_97:
    s_mov_b64 exec, -1
    s_branch L_fin
L_pubslow_98:
    buffer_wbl2 sc1
    s_waitcnt vmcnt(0)
    buffer_store_dwordx2 v[12:13], off, s[32:35], s88 offset:1024 sc1
    s_branch L_pubback_99
L_peek_100:
    s_mov_b64 exec, 0xff
    s_mov_b32 s66, 0
L_poll_103:
    buffer_load_dwordx2 v[30:31], v5, s[32:35], s89 offen offset:1024 sc1
    s_add_u32 s66, s66, 1
    s_cmp_gt_u32 s66, 65536
    s_cbranch_scc1 L_pollout_104
    s_waitcnt vmcnt(0)
    v_cmp_ne_u64 vcc, s[48:49], v[30:31]
    s_nop 0
    s_cbranch_vccnz L_poll_103
L_pollout_104:
    s_mov_b64 exec, -1
    s_cmp_lg_u32 s50, 0
    s_cbranch_scc1 L_peekback_101
    buffer_inv sc1
    s_waitcnt vmcnt(0)
    s_branch L_peekback_101
L_codeend:
.fill 64, 4, 0xbf800000
.section .rodata,"a"
.p2align 6
.amdhsa_kernel interleave_layers__sliding_block__dense_activation_relu__prompt_kernel
  .amdhsa_next_free_vgpr 512
  .amdhsa_next_free_sgpr 102
  .amdhsa_accum_offset 256
  .amdhsa_group_segment_fixed_size 0
  .amdhsa_kernarg_size 72
  .amdhsa_user_sgpr_count 2
  .amdhsa_user_sgpr_kernarg_segment_ptr 1
  .amdhsa_system_sgpr_workgroup_id_x 1
  .amdhsa_float_denorm_mode_32 3
.end_amdhsa_kernel
```
